```python
import torch

def _softmax(x, axis=-1):
    return torch.softmax(x, dim=axis)
def _gelu(x):
    return torch.nn.functional.gelu(x, approximate="tanh")
def _silu(x):
    return torch.nn.functional.silu(x)
def _sigmoid(x):
    return torch.sigmoid(x)
def _layernorm(x, axis=-1, eps=1e-5):
    m = x.mean(dim=axis, keepdim=True)
    v = x.var(dim=axis, keepdim=True, unbiased=False)
    return (x - m) / torch.sqrt(v + eps)
def _scatter_add(tgt, idx, src, axis=0):
    return tgt.clone().index_add_(axis, idx, src)
def _segment_sum(src, seg, n):
    out = torch.zeros((n,) + src.shape[1:], dtype=src.dtype)
    return out.index_add_(0, seg, src)
def _pad(x, pw):
    flat = tuple(v for pair in reversed(pw) for v in pair)
    return torch.nn.functional.pad(x, flat)

kernel_name = 'sequential_preLN__softmax_full_mha__dense_activation_gelu__prompt'

def setup_inputs():

    _w = (lambda a: (lambda t: t.to(torch.bfloat16) if t.is_floating_point() else t)(torch.as_tensor(a)))
    def _A_setup():
        B, S, D = 1, 2048, 448
        return {
            "x": _w((lambda *s: torch.randn(*s, dtype=torch.bfloat16) * 0.05)(B, S, D)),
            "wqkv": _w((lambda *s: torch.randn(*s, dtype=torch.bfloat16) * 0.05)(D, 3 * D)),
            "wo": _w((lambda *s: torch.randn(*s, dtype=torch.bfloat16) * 0.05)(D, D)),
        }
    _A_in = _A_setup()

    def _B_setup():
        B, S, D, F = 1, 2048, 448, 1792
        return {
            "x": _w((lambda *s: torch.randn(*s, dtype=torch.bfloat16) * 0.05)(B, S, D)),
            "w1": _w((lambda *s: torch.randn(*s, dtype=torch.bfloat16) * 0.8)(D, F) * (D ** -0.5)),
            "b1": _w((lambda *s: torch.randn(*s, dtype=torch.bfloat16) * 12.8)(F) * 0.01),
            "w2": _w((lambda *s: torch.randn(*s, dtype=torch.bfloat16) * 0.8)(F, D) * (F ** -0.5)),
            "b2": _w((lambda *s: torch.randn(*s, dtype=torch.bfloat16) * 12.8)(D) * 0.01),
        }
    _B_in = _B_setup()

    return {
        "A_x": _A_in["x"],
        "A_wqkv": _A_in["wqkv"],
        "A_wo": _A_in["wo"],
        "B_x": _B_in["x"],
        "B_w1": _B_in["w1"],
        "B_b1": _B_in["b1"],
        "B_w2": _B_in["w2"],
        "B_b2": _B_in["b2"],
    }

def reference(A_x, A_wqkv, A_wo, B_x, B_w1, B_b1, B_w2, B_b2):
    def _A_ref(x, wqkv, wo):
        B, S, D = x.shape
        H = 16; Dh = D // H
        qkv = (lambda x, *d: x.permute(*d))((x @ wqkv).reshape(B, S, 3, H, Dh), 2, 0, 3, 1, 4)
        q, k, v = qkv[0], qkv[1], qkv[2]
        scale = Dh ** -0.5
        scores = torch.einsum("bhqd,bhkd->bhqk", q, k) * scale
        p = _softmax(scores, axis=-1)
        o = torch.einsum("bhqk,bhkd->bhqd", p, v)
        return (lambda x, *d: x.permute(*d))(o, 0, 2, 1, 3).reshape(B, S, D) @ wo

    def _B_ref(x, w1, b1, w2, b2):
        h = torch.einsum("bsd,df->bsf", x, w1) + b1
        h = _gelu(h)
        return torch.einsum("bsf,fd->bsd", h, w2) + b2

    x = A_x
    h = x + _A_ref(_layernorm(x, axis=-1), A_wqkv, A_wo)
    h2 = h + _B_ref(_layernorm(h, axis=-1), B_w1, B_b1, B_w2, B_b2)
    return h2
```

```asm
; @launch kernel=sequential_preLN__softmax_full_mha__dense_activation_gelu__prompt_kernel grid=(256,1,1) block=(256,1,1) lds=163840
.amdgcn_target "amdgcn-amd-amdhsa--gfx950"
.text
.globl sequential_preLN__softmax_full_mha__dense_activation_gelu__prompt_kernel
.p2align 8
.type sequential_preLN__softmax_full_mha__dense_activation_gelu__prompt_kernel,@function
sequential_preLN__softmax_full_mha__dense_activation_gelu__prompt_kernel:
code_begin:
    s_cmp_ge_u32 s2, 256
    s_cbranch_scc1 P_end
    s_load_dwordx16 s[12:27], s[0:1], 0
    s_load_dwordx2 s[8:9], s[0:1], 80
    s_load_dwordx2 s[32:33], s[0:1], 64
    v_lshrrev_b32 v24, 6, v0
    v_lshrrev_b32 v25, 2, v0
    v_lshlrev_b32 v26, 4, v0
    v_readfirstlane_b32 s3, v24
    v_and_b32 v0, 63, v0
    v_and_b32 v26, 48, v26
    v_and_b32 v27, 1, v25
    v_mul_u32_u24 v205, 448, v25
    v_mul_u32_u24 v29, 400, v27
    v_sub_u32 v205, v205, v29
    v_add_u32 v205, v205, v26
    v_mul_u32_u24 v29, 85984, v27
    v_lshl_add_u32 v204, v25, 5, v26
    v_add_u32 v204, v204, v29
    v_mov_b32 v29, 0x7f000000
    v_cmp_gt_u32 vcc, 42, v25
    s_nop 1
    v_cndmask_b32 v205, v29, v205, vcc
    v_cndmask_b32 v204, v29, v204, vcc
    v_lshrrev_b32 v25, 2, v0
    v_mul_u32_u24 v25, 896, v25
    v_add_u32 v216, v25, v26
    v_add_u32 v217, 13312, v216
    v_add_u32 v218, 26624, v216
    s_lshr_b32 s43, s2, 3
    s_and_b32 s66, s2, 7
    s_mul_i32 s71, s43, 37632
    s_mul_i32 s67, s66, 112
    s_add_u32 s71, s71, s67
    s_add_u32 s70, s71, 18816
    s_mul_i32 s75, s66, 172032
    s_mul_i32 s67, s43, 2688
    s_add_u32 s75, s75, s67
    s_mov_b32 s69, 0x1173000
    s_mov_b32 s30, 0x126000
    s_mov_b32 s31, 0x20000
    s_mov_b32 s10, 0x1180000
    s_mov_b32 s11, 0x20000
    v_lshrrev_b32 v24, 3, v0
    v_lshrrev_b32 v25, 4, v0
    v_xor_b32 v26, v0, v25
    v_and_b32 v26, 7, v26
    v_lshlrev_b32 v26, 4, v26
    v_mul_u32_u24 v24, 896, v24
    v_add_u32 v220, v24, v26
    v_xor_b32 v221, 64, v220
    v_add_u32 v222, 12288, v220
    v_add_u32 v223, 18432, v221
    v_add_u32 v221, 6144, v221
    s_and_b32 s49, s43, 15
    s_lshl_b32 s68, s49, 2
    s_add_u32 s68, s68, s3
    s_mul_i32 s52, s68, 28672
    s_mul_i32 s60, s3, 28672
    s_add_u32 s60, s60, 49152
    s_lshl_b32 s66, s66, 1
    s_lshr_b32 s67, s43, 4
    s_add_u32 s65, s66, s67
    s_lshl_b32 s68, s65, 6
    s_add_u32 s68, s68, s3
    s_lshl_b32 s68, s68, 12
    s_add_u32 s68, s68, 0x200000
    s_mov_b32 s46, 0x40000
    s_mov_b32 s47, 0x20000
    s_lshl_b32 s48, s49, 14
    s_mul_i32 s4, s65, 56
    s_and_b32 s4, s4, -16
    s_mul_i32 s67, s3, 43008
    s_add_u32 s4, s4, s67
    s_mul_i32 s72, s3, 3072
    v_lshlrev_b32 v1, 4, v0
    v_lshlrev_b32 v230, 6, v0
    v_mov_b32 v8, -1
    v_mov_b32 v9, -1
    v_mov_b32 v10, -1
    v_mov_b32 v11, -1
    s_waitcnt lgkmcnt(0)
    s_mov_b64 s[28:29], s[14:15]
    buffer_load_dword v19, off, s[8:11], s69 sc1
    s_mov_b32 s14, 0x1c0000
    s_mov_b32 s15, 0x20000
    s_add_u32 s44, s8, s68
    s_addc_u32 s45, s9, 0
    buffer_store_dwordx4 v[8:11], v1, s[44:47], s48 offen offset:0
    buffer_store_dwordx4 v[8:11], v1, s[44:47], s48 offen offset:1024
    buffer_store_dwordx4 v[8:11], v1, s[44:47], s48 offen offset:2048
    buffer_store_dwordx4 v[8:11], v1, s[44:47], s48 offen offset:3072
    buffer_load_dwordx4 v[196:199], v205, s[28:31], s71 offen
    buffer_load_dwordx4 v[200:203], v205, s[28:31], s70 offen
    s_lshl_b32 s67, s43, 2
    s_add_u32 s67, s67, s3
    s_getpc_b64 s[70:71]
pf_A:
    s_min_u32 s67, s67, (code_end-code_begin)>>10
    s_lshl_b32 s67, s67, 10
    s_add_u32 s67, s67, 0x100000-(pf_A-code_begin)
    s_add_u32 s70, s70, s67
    s_addc_u32 s71, s71, 0
    s_sub_u32 s70, s70, 0x100000
    s_subb_u32 s71, s71, 0
    global_load_dwordx4 v[244:247], v1, s[70:71]
    v_min_u32 v24, 47, v0
    s_add_u32 m0, s60, 0
    s_nop 0
    buffer_load_dwordx4 v220, s[12:15], s52 offen offset:0 lds
    v_lshlrev_b32 v24, 6, v24
    s_bitcmp1_b32 s43, 4
    s_cselect_b32 s66, 4, 60
    s_add_u32 s66, s66, s72
    buffer_load_dwordx4 v221, s[12:15], s52 offen offset:1024 lds
    v_add_u32 v189, s66, v24
    v_min_u32 v24, 15, v0
    v_mul_u32_u24 v24, 192, v24
    v_add3_u32 v219, v24, 60, s66
    buffer_load_dwordx4 v222, s[12:15], s52 offen offset:2048 lds
    v_mov_b32 v206, 0x3f80
    s_mov_b32 s41, 0x10000
    s_getreg_b32 s73, hwreg(HW_REG_XCC_ID, 0, 3)
    v_and_b32 v24, 31, v0
    buffer_load_dwordx4 v223, s[12:15], s52 offen offset:3072 lds
    s_add_u32 s52, s52, 128
    v_lshrrev_b32 v25, 5, v0
    v_bfe_u32 v26, v0, 1, 3
    v_xor_b32 v26, v26, v25
    v_lshlrev_b32 v24, 7, v24
    s_add_u32 m0, s72, 0
    s_nop 0
    buffer_load_dwordx4 v216, s[28:31], s4 offen offset:0 lds
    v_add_u32 v24, s60, v24
    v_xor_b32 v27, 0, v26
    v_lshl_add_u32 v224, v27, 4, v24
    v_xor_b32 v27, 2, v26
    buffer_load_dwordx4 v217, s[28:31], s4 offen offset:1024 lds
    v_lshl_add_u32 v225, v27, 4, v24
    v_xor_b32 v27, 4, v26
    v_lshl_add_u32 v226, v27, 4, v24
    v_xor_b32 v27, 6, v26
    buffer_load_dwordx4 v218, s[28:31], s4 offen offset:2048 lds
    s_add_u32 s4, s4, 172032
    v_lshl_add_u32 v227, v27, 4, v24
    v_bfe_u32 v24, v0, 2, 2
    v_lshl_add_u32 v26, v25, 3, v24
    v_mul_u32_u24 v26, 192, v26
    v_and_b32 v27, 3, v0
    v_lshlrev_b32 v27, 3, v27
    v_and_b32 v28, 16, v0
    v_lshl_add_u32 v27, v28, 1, v27
    v_lshl_add_u32 v29, v25, 2, v24
    s_lshr_b32 s66, s43, 1
    s_and_b32 s66, s66, 8
    v_add_u32 v28, s66, v27
    v_and_b32 v28, 63, v28
    v_add_u32 v228, v26, v28
    s_cmp_eq_u32 s3, 3
    s_cselect_b32 s67, 0, s3
    s_lshl_b32 s67, s67, 6
    v_add_u32 v229, s67, v228
    v_lshrrev_b32 v24, 4, v0
    v_xor_b32 v24, v24, v0
    v_and_b32 v24, 1, v24
    v_add_u32 v24, -1, v24
    v_and_b32 v32, 0x3f803f80, v24
    v_and_b32 v33, 0x3f803f80, v24
    v_and_b32 v34, 0x3f803f80, v24
    v_and_b32 v35, 0x3f803f80, v24
    v_mul_u32_u24 v29, 72, v29
    v_add3_u32 v18, v29, v27, s60
    s_mov_b32 s18, 0x62000
    s_mov_b32 s19, 0x20000
    s_mov_b64 s[36:37], s[22:23]
    s_mov_b64 s[38:39], s[26:27]
    s_mov_b32 s22, 0x188000
    s_mov_b32 s23, 0x20000
    s_waitcnt vmcnt(14)
    v_add_u32 v19, 0x9e3779b9, v19
    s_mov_b32 exec_lo, 0x08080808
    s_mov_b32 exec_hi, 0x08080808
    s_waitcnt vmcnt(9)
    v_mov_b32 v198, 0x3f80
    v_and_b32 v199, 0xbfffbfff, v19
    s_waitcnt vmcnt(8)
    v_mov_b32 v202, 0x3f80
    v_and_b32 v203, 0xbfffbfff, v19
    s_lshl_b64 exec, exec, 1
    v_mov_b32 v196, 0x3f80
    v_and_b32 v197, 0xbfffbfff, v19
    v_mov_b32 v200, 0x3f80
    v_and_b32 v201, 0xbfffbfff, v19
    s_mov_b64 exec, -1
    buffer_store_dwordx4 v[196:199], v204, s[8:11], s75 offen offset:0
    buffer_store_dwordx4 v[200:203], v204, s[8:11], s75 offen offset:1344
    v_readfirstlane_b32 s40, v19
    v_not_b32 v193, v19
    v_and_b32 v193, 0xbfffbfff, v193
    s_add_u32 m0, s60, 4096
    s_nop 0
    buffer_load_dwordx4 v220, s[12:15], s52 offen offset:0 lds
    s_mov_b32 s26, 0x188000
    s_mov_b32 s27, 0x20000
    s_mov_b32 s34, 0x1c0000
    s_mov_b32 s35, 0x20000
    s_lshl_b32 s78, s2, 2
    s_add_u32 s78, s78, s3
    v_lshl_add_u32 v184, v0, 10, s78
    v_lshlrev_b32 v184, 7, v184
    v_subrev_u32 v185, 0x62000, v184
    v_subrev_u32 v186, 0x1ea000, v184
    v_and_b32 v24, 31, v0
    v_mul_u32_u24 v231, 72, v24
    v_lshl_add_u32 v231, v25, 3, v231
    v_add_u32 v231, s60, v231
    buffer_load_dwordx4 v221, s[12:15], s52 offen offset:1024 lds
    v_lshlrev_b32 v191, 4, v25
    v_add_u32 v191, 106496, v191
    s_cmp_eq_u32 s3, 3
    s_cselect_b32 s78, 0, s3
    s_lshl_b32 s78, s78, 7
    s_add_u32 s78, s78, 106496
    v_and_b32 v24, 15, v0
    v_lshl_add_u32 v192, v24, 2, s78
    s_and_b32 s78, s2, 7
    s_lshl_b32 s79, s78, 1
    s_mul_i32 s100, s43, 37
    s_lshr_b32 s100, s100, 8
    s_mul_i32 s101, s100, 7
    s_sub_u32 s101, s43, s101
    buffer_load_dwordx4 v222, s[12:15], s52 offen offset:2048 lds
    s_lshr_b32 s1, s100, 1
    s_mul_i32 s0, s1, 14
    s_sub_u32 s0, s43, s0
    s_lshl_b32 s53, s101, 7
    s_mul_i32 s55, s3, 57344
    s_lshl_b32 s0, s0, 8
    s_add_u32 s55, s55, s0
    s_mul_i32 s51, s3, 12288
    s_mul_i32 s74, s3, 114688
    s_add_u32 s74, s74, s53
    s_mul_i32 s54, s3, 100352
    s_add_u32 s54, s54, s53
    s_lshl_b32 s56, s3, 12
    s_add_u32 s56, s56, 49152
    buffer_load_dwordx4 v223, s[12:15], s52 offen offset:3072 lds
    s_add_u32 s52, s52, 128
    v_lshrrev_b32 v236, 3, v0
    v_bfe_u32 v237, v0, 4, 1
    v_lshlrev_b32 v237, 2, v237
    v_and_b32 v238, 7, v0
    v_xor_b32 v237, v237, v238
    v_lshlrev_b32 v237, 4, v237
    v_mul_u32_u24 v236, 896, v236
    v_add_u32 v2, v236, v237
    v_lshrrev_b32 v236, 4, v0
    v_lshlrev_b32 v237, 2, v236
    v_and_b32 v238, 15, v0
    v_xor_b32 v237, v237, v238
    v_lshlrev_b32 v237, 4, v237
    v_mul_u32_u24 v236, 3584, v236
    s_add_u32 m0, s72, 12288
    s_nop 0
    buffer_load_dwordx4 v216, s[28:31], s4 offen offset:0 lds
    v_add_u32 v3, v236, v237
    v_add_u32 v13, 6144, v2
    v_add_u32 v252, 13312, v3
    v_add_u32 v14, 12288, v2
    v_add_u32 v253, 26624, v3
    v_add_u32 v15, 18432, v2
    v_add_u32 v254, 39936, v3
    v_bfe_u32 v236, v0, 2, 2
    v_lshrrev_b32 v237, 5, v0
    v_lshl_add_u32 v238, v237, 2, v236
    v_lshlrev_b32 v238, 7, v238
    v_and_b32 v239, 3, v0
    v_lshlrev_b32 v239, 3, v239
    v_and_b32 v240, 16, v0
    buffer_load_dwordx4 v217, s[28:31], s4 offen offset:1024 lds
    v_lshl_add_u32 v239, v240, 1, v239
    v_and_b32 v240, 8, v0
    v_lshl_add_u32 v239, v240, 3, v239
    s_and_b32 s78, s3, 1
    s_lshl_b32 s78, s78, 6
    s_lshr_b32 s1, s3, 1
    s_lshl_b32 s79, s1, 5
    s_add_u32 s78, s78, s79
    v_xor_b32 v239, s78, v239
    v_add3_u32 v4, v238, v239, s51
    v_xor_b32 v5, 64, v4
    s_add_u32 s78, s56, 0
    v_add3_u32 v242, v238, v239, s78
    v_xor_b32 v243, 64, v242
    buffer_load_dwordx4 v218, s[28:31], s4 offen offset:2048 lds
    v_add_u32 v6, s51, v1
    v_and_b32 v236, 31, v0
    v_lshlrev_b32 v236, 6, v236
    v_lshl_add_u32 v12, v237, 11, v236
    s_and_b32 s78, s2, 7
    s_lshl_b32 s79, s78, 1
    s_mul_i32 s100, s43, 37
    s_lshr_b32 s100, s100, 8
    s_mul_i32 s101, s100, 7
    s_sub_u32 s101, s43, s101
    s_lshr_b32 s1, s100, 1
    s_mul_i32 s0, s1, 14
    s_sub_u32 s0, s43, s0
    s_mov_b32 s64, s0
    s_mul_i32 s29, s65, 86016
    s_add_u32 s29, s29, s72
    ds_write_b32 v189, v193 offset:24576
    ds_write_b32 v189, v193 offset:36864
    s_and_b32 s31, s40, 0xbfffbfff
    s_mov_b32 s70, 6
    s_mov_b32 s69, 0x200000
    s_add_u32 m0, s60, 8192
    s_nop 0
    buffer_load_dwordx4 v220, s[12:15], s52 offen offset:0 lds
    s_lshl_b32 s61, s78, 2
    s_add_u32 s61, s61, s100
    s_lshl_b32 s62, s101, 1
    s_and_b32 s0, s3, 1
    s_add_u32 s62, s62, s0
    s_add_u32 s79, s79, s1
    s_lshl_b32 s63, s79, 2
    s_add_u32 s63, s63, s3
    s_lshl_b32 s101, s49, 2
    s_add_u32 s0, s101, s3
    s_lshl_b32 s50, s0, 4
    s_add_u32 s50, s50, s65
    s_lshl_b32 s50, s50, 11
    s_add_u32 s50, s50, 0x600000
    buffer_load_dwordx4 v221, s[12:15], s52 offen offset:1024 lds
    s_lshr_b32 s1, s3, 1
    s_mul_i32 s57, s61, 56
    s_lshl_b32 s0, s62, 1
    s_add_u32 s57, s57, s0
    s_add_u32 s57, s57, s1
    s_lshl_b32 s57, s57, 10
    s_add_u32 s57, s57, 0x800000
    s_mul_i32 s58, s63, 14
    s_add_u32 s58, s58, s64
    s_lshl_b32 s58, s58, 13
    s_add_u32 s58, s58, 0xa00000
    s_lshl_b32 s59, s61, 12
    s_lshr_b32 s0, s53, 4
    s_add_u32 s59, s59, s0
    buffer_load_dwordx4 v222, s[12:15], s52 offen offset:2048 lds
    s_add_u32 s59, s59, 0x1100000
    s_cmp_lg_u32 s3, 0
    s_cselect_b32 s59, 0x7f000000, s59
    s_cmp_ge_u32 s43, 28
    s_cselect_b32 s57, 0x7f000000, s57
    s_cselect_b32 s58, 0x7f000000, s58
    s_cselect_b32 s59, 0x7f000000, s59
    s_lshr_b32 s78, s3, 1
    buffer_load_dwordx4 v223, s[12:15], s52 offen offset:3072 lds
    s_add_u32 s52, s52, 128
    s_waitcnt vmcnt(13)
    ds_write_b32 v219, v206 offset:0
    s_waitcnt vmcnt(16) lgkmcnt(0)
    s_barrier
    ds_read_b128 v[36:39], v224 offset:0
    ds_read_b64_tr_b16 v[44:45], v228 offset:64
    ds_read_b64_tr_b16 v[46:47], v228 offset:832
    ds_read_b64_tr_b16 v[48:49], v228 offset:128
    ds_read_b64_tr_b16 v[50:51], v228 offset:896
    ds_read_b64_tr_b16 v[52:53], v228 offset:0
    ds_read_b64_tr_b16 v[54:55], v228 offset:768
    ds_read_b64_tr_b16 v[148:149], v229 offset:0
    ds_read_b64_tr_b16 v[150:151], v229 offset:768
    ds_read_b128 v[40:43], v225 offset:0
    ds_read_b64_tr_b16 v[56:57], v228 offset:3136
    ds_read_b64_tr_b16 v[58:59], v228 offset:3904
    ds_read_b64_tr_b16 v[60:61], v228 offset:3200
    ds_read_b64_tr_b16 v[62:63], v228 offset:3968
    ds_read_b64_tr_b16 v[64:65], v228 offset:3072
    ds_read_b64_tr_b16 v[66:67], v228 offset:3840
    ds_read_b64_tr_b16 v[152:153], v229 offset:3072
    ds_read_b64_tr_b16 v[154:155], v229 offset:3840
    s_waitcnt lgkmcnt(9)
    v_mfma_f32_32x32x16_bf16 v[116:131], v[36:39], v[36:39], 0
    s_add_u32 s71, s29, 24576
    s_add_u32 m0, s72, 24576
    s_nop 0
    buffer_load_dwordx4 v1, s[8:11], s71 offen offset:0 lds
    ds_read_b128 v[132:135], v226 offset:0
    ds_read_b64_tr_b16 v[136:137], v228 offset:6208
    s_lshl_b32 s30, s65, 2
    s_add_u32 s30, s30, s3
    v_mfma_f32_32x32x16_bf16 v[68:83], v[44:47], v[36:39], 0
    ds_read_b64_tr_b16 v[138:139], v228 offset:6976
    ds_read_b64_tr_b16 v[140:141], v228 offset:6272
    s_lshl_b32 s30, s30, 4
    s_add_u32 s30, s30, s49
    v_mfma_f32_32x32x16_bf16 v[84:99], v[48:51], v[36:39], 0
    buffer_load_dwordx4 v1, s[8:11], s71 offen offset:1024 lds
    ds_read_b64_tr_b16 v[142:143], v228 offset:7040
    ds_read_b64_tr_b16 v[144:145], v228 offset:6144
    s_lshl_b32 s30, s30, 2
    s_add_u32 s30, s30, 0x1170000
    v_mfma_f32_32x32x16_bf16 v[100:115], v[52:55], v[36:39], 0
    ds_read_b64_tr_b16 v[146:147], v228 offset:6912
    ds_read_b64_tr_b16 v[156:157], v229 offset:6144
    s_add_u32 s73, s73, s40
    v_mov_b32 v19, s73
    v_mfma_f32_16x16x32_bf16 v[20:23], v[32:35], v[148:151], 0
    ds_read_b64_tr_b16 v[158:159], v229 offset:6912
    v_mov_b32 v255, s40
    s_mul_i32 s4, s61, 57344
    s_waitcnt lgkmcnt(9)
    v_mfma_f32_32x32x16_bf16 v[116:131], v[40:43], v[40:43], v[116:131]
    buffer_load_dwordx4 v1, s[8:11], s71 offen offset:2048 lds
    ds_read_b128 v[36:39], v227 offset:0
    ds_read_b64_tr_b16 v[44:45], v228 offset:9280
    ds_read_b64_tr_b16 v[46:47], v228 offset:10048
    ds_read_b64_tr_b16 v[48:49], v228 offset:9344
    s_lshl_b32 s79, s62, 6
    s_lshl_b32 s100, s78, 5
    v_mfma_f32_32x32x16_bf16 v[68:83], v[56:59], v[40:43], v[68:83]
    ds_read_b64_tr_b16 v[50:51], v228 offset:10112
    ds_read_b64_tr_b16 v[52:53], v228 offset:9216
    s_add_u32 s79, s79, s100
    s_add_u32 s4, s4, s79
    v_mfma_f32_32x32x16_bf16 v[84:99], v[60:63], v[40:43], v[84:99]
    s_add_u32 s71, s29, 36864
    s_add_u32 m0, s72, 36864
    s_nop 0
    buffer_load_dwordx4 v1, s[8:11], s71 offen offset:0 lds
    ds_read_b64_tr_b16 v[54:55], v228 offset:9984
    ds_read_b64_tr_b16 v[148:149], v229 offset:9216
    s_add_u32 s5, s4, 28672
    v_and_b32 v238, 31, v0
    v_mfma_f32_32x32x16_bf16 v[100:115], v[64:67], v[40:43], v[100:115]
    ds_read_b64_tr_b16 v[150:151], v229 offset:9984
    ds_write_b32 v189, v193 offset:0
    v_lshrrev_b32 v237, 5, v0
    v_lshlrev_b32 v237, 4, v237
    v_mfma_f32_16x16x32_bf16 v[20:23], v[32:35], v[152:155], v[20:23]
    s_waitcnt vmcnt(8)
    ds_write_b32 v219, v206 offset:12288
    v_mul_u32_u24 v236, 896, v238
    v_add_u32 v236, v236, v237
    s_waitcnt lgkmcnt(11)
    v_mfma_f32_32x32x16_bf16 v[116:131], v[132:135], v[132:135], v[116:131]
    buffer_load_dwordx4 v1, s[8:11], s71 offen offset:1024 lds
    v_add_u32 v237, s79, v237
    s_lshl_b32 s79, s64, 8
    v_mfma_f32_32x32x16_bf16 v[68:83], v[136:139], v[132:135], v[68:83]
    s_waitcnt vmcnt(12) lgkmcnt(0)
    s_barrier
    ds_read_b128 v[40:43], v224 offset:4096
    ds_read_b64_tr_b16 v[56:57], v228 offset:12352
    ds_read_b64_tr_b16 v[58:59], v228 offset:13120
    s_lshl_b32 s100, s3, 6
    s_add_u32 s79, s79, s100
    v_mfma_f32_32x32x16_bf16 v[84:99], v[140:143], v[132:135], v[84:99]
    buffer_load_dwordx4 v1, s[8:11], s71 offen offset:2048 lds
    ds_read_b64_tr_b16 v[60:61], v228 offset:12416
    ds_read_b64_tr_b16 v[62:63], v228 offset:13184
    ds_read_b64_tr_b16 v[64:65], v228 offset:12288
    v_lshl_add_u32 v238, v238, 1, s79
    v_and_b32 v239, 15, v0
    v_mfma_f32_32x32x16_bf16 v[100:115], v[144:147], v[132:135], v[100:115]
    ds_read_b64_tr_b16 v[66:67], v228 offset:13056
    ds_read_b64_tr_b16 v[152:153], v229 offset:12288
    v_lshlrev_b32 v239, 2, v239
    s_lshr_b32 s6, s61, 1
    v_mfma_f32_16x16x32_bf16 v[20:23], v[32:35], v[156:159], v[20:23]
    ds_read_b64_tr_b16 v[154:155], v229 offset:13056
    s_min_u32 s6, s6, 15
    s_lshl_b32 s6, s6, 8
    v_mfma_f32_32x32x16_bf16 v[116:131], v[36:39], v[36:39], v[116:131]
    s_add_u32 m0, s60, 12288
    s_nop 0
    buffer_load_dwordx4 v220, s[12:15], s52 offen offset:0 lds
    ds_read_b128 v[132:135], v225 offset:4096
    ds_read_b64_tr_b16 v[136:137], v228 offset:15424
    s_add_u32 s6, s6, s100
    s_add_u32 s6, s6, 0x1171000
    v_mfma_f32_32x32x16_bf16 v[68:83], v[44:47], v[36:39], v[68:83]
    ds_read_b64_tr_b16 v[138:139], v228 offset:16192
    ds_read_b64_tr_b16 v[140:141], v228 offset:15488
    s_lshl_b32 s7, s61, 16
    s_lshl_b32 s100, s3, 13
    v_mfma_f32_32x32x16_bf16 v[84:99], v[48:51], v[36:39], v[84:99]
    buffer_load_dwordx4 v221, s[12:15], s52 offen offset:1024 lds
    ds_read_b64_tr_b16 v[142:143], v228 offset:16256
    ds_read_b64_tr_b16 v[144:145], v228 offset:15360
    s_add_u32 s7, s7, s100
    s_add_u32 s7, s7, 0x600000
    v_mfma_f32_32x32x16_bf16 v[100:115], v[52:55], v[36:39], v[100:115]
    ds_read_b64_tr_b16 v[146:147], v228 offset:16128
    ds_read_b64_tr_b16 v[156:157], v229 offset:15360
    v_and_b32 v17, 16, v0
    v_lshl_add_u32 v17, v17, 4, v239
    v_mfma_f32_16x16x32_bf16 v[20:23], v[32:35], v[148:151], v[20:23]
    ds_read_b64_tr_b16 v[158:159], v229 offset:16128
    s_waitcnt lgkmcnt(9)
    v_mfma_f32_32x32x16_bf16 v[116:131], v[40:43], v[40:43], v[116:131]
    buffer_load_dwordx4 v222, s[12:15], s52 offen offset:2048 lds
    ds_read_b128 v[36:39], v226 offset:4096
    ds_read_b64_tr_b16 v[44:45], v228 offset:18496
    v_mfma_f32_32x32x16_bf16 v[68:83], v[56:59], v[40:43], v[68:83]
    ds_read_b64_tr_b16 v[46:47], v228 offset:19264
    ds_read_b64_tr_b16 v[48:49], v228 offset:18560
    v_mfma_f32_32x32x16_bf16 v[84:99], v[60:63], v[40:43], v[84:99]
    buffer_load_dwordx4 v223, s[12:15], s52 offen offset:3072 lds
    s_add_u32 s52, s52, 128
    ds_read_b64_tr_b16 v[50:51], v228 offset:19328
    ds_read_b64_tr_b16 v[52:53], v228 offset:18432
    v_mfma_f32_32x32x16_bf16 v[100:115], v[64:67], v[40:43], v[100:115]
    ds_read_b64_tr_b16 v[54:55], v228 offset:19200
    ds_read_b64_tr_b16 v[148:149], v229 offset:18432
    v_mfma_f32_16x16x32_bf16 v[20:23], v[32:35], v[152:155], v[20:23]
    ds_read_b64_tr_b16 v[150:151], v229 offset:19200
    s_waitcnt lgkmcnt(9)
    v_mfma_f32_32x32x16_bf16 v[116:131], v[132:135], v[132:135], v[116:131]
    s_add_u32 s71, s29, 49152
    s_add_u32 m0, s72, 0
    s_nop 0
    buffer_load_dwordx4 v1, s[8:11], s71 offen offset:0 lds
    ds_read_b32 v188, v189 offset:24576
    ds_read_b128 v[40:43], v227 offset:4096
    ds_read_b64_tr_b16 v[56:57], v228 offset:21568
    ds_read_b64_tr_b16 v[58:59], v228 offset:22336
    v_mfma_f32_32x32x16_bf16 v[68:83], v[136:139], v[132:135], v[68:83]
    ds_read_b64_tr_b16 v[60:61], v228 offset:21632
    ds_read_b64_tr_b16 v[62:63], v228 offset:22400
    v_mfma_f32_32x32x16_bf16 v[84:99], v[140:143], v[132:135], v[84:99]
    buffer_load_dwordx4 v1, s[8:11], s71 offen offset:1024 lds
    ds_read_b64_tr_b16 v[64:65], v228 offset:21504
    ds_read_b64_tr_b16 v[66:67], v228 offset:22272
    v_mfma_f32_32x32x16_bf16 v[100:115], v[144:147], v[132:135], v[100:115]
    ds_read_b64_tr_b16 v[152:153], v229 offset:21504
    ds_read_b64_tr_b16 v[154:155], v229 offset:22272
    v_mfma_f32_16x16x32_bf16 v[20:23], v[32:35], v[156:159], v[20:23]
    ds_write_b32 v189, v193 offset:12288
    s_waitcnt lgkmcnt(11)
    v_mfma_f32_32x32x16_bf16 v[116:131], v[36:39], v[36:39], v[116:131]
    s_waitcnt lgkmcnt(10)
    v_cmp_ne_u32 vcc, s31, v188
    buffer_load_dwordx4 v1, s[8:11], s71 offen offset:2048 lds
    v_mfma_f32_32x32x16_bf16 v[68:83], v[44:47], v[36:39], v[68:83]
    s_cbranch_vccnz A_w2
A_w2_ok:
    s_waitcnt vmcnt(13)
    s_barrier
    ds_read_b128 v[132:135], v224 offset:8192
    ds_read_b64_tr_b16 v[136:137], v228 offset:24640
    ds_read_b64_tr_b16 v[138:139], v228 offset:25408
    v_mfma_f32_32x32x16_bf16 v[84:99], v[48:51], v[36:39], v[84:99]
    s_waitcnt vmcnt(36)
    buffer_store_dword v19, off, s[8:11], s30 sc1
    ds_read_b64_tr_b16 v[140:141], v228 offset:24704
    ds_read_b64_tr_b16 v[142:143], v228 offset:25472
    ds_read_b64_tr_b16 v[144:145], v228 offset:24576
    v_mfma_f32_32x32x16_bf16 v[100:115], v[52:55], v[36:39], v[100:115]
    ds_read_b64_tr_b16 v[146:147], v228 offset:25344
    ds_read_b64_tr_b16 v[156:157], v229 offset:24576
    v_mfma_f32_16x16x32_bf16 v[20:23], v[32:35], v[148:151], v[20:23]
    ds_read_b64_tr_b16 v[158:159], v229 offset:25344
    s_waitcnt lgkmcnt(10)
    v_mfma_f32_32x32x16_bf16 v[116:131], v[40:43], v[40:43], v[116:131]
    s_add_u32 m0, s60, 16384
    s_nop 0
    buffer_load_dwordx4 v220, s[12:15], s52 offen offset:0 lds
    ds_read_b128 v[36:39], v225 offset:8192
    ds_read_b64_tr_b16 v[44:45], v228 offset:27712
    v_mfma_f32_32x32x16_bf16 v[68:83], v[56:59], v[40:43], v[68:83]
    ds_read_b64_tr_b16 v[46:47], v228 offset:28480
    ds_read_b64_tr_b16 v[48:49], v228 offset:27776
    v_mfma_f32_32x32x16_bf16 v[84:99], v[60:63], v[40:43], v[84:99]
    buffer_load_dwordx4 v221, s[12:15], s52 offen offset:1024 lds
    ds_read_b64_tr_b16 v[50:51], v228 offset:28544
    ds_read_b64_tr_b16 v[52:53], v228 offset:27648
    v_mfma_f32_32x32x16_bf16 v[100:115], v[64:67], v[40:43], v[100:115]
    ds_read_b64_tr_b16 v[54:55], v228 offset:28416
    ds_read_b64_tr_b16 v[148:149], v229 offset:27648
    v_mfma_f32_16x16x32_bf16 v[20:23], v[32:35], v[152:155], v[20:23]
    ds_read_b64_tr_b16 v[150:151], v229 offset:28416
    s_waitcnt lgkmcnt(9)
    v_mfma_f32_32x32x16_bf16 v[116:131], v[132:135], v[132:135], v[116:131]
    buffer_load_dwordx4 v222, s[12:15], s52 offen offset:2048 lds
    ds_read_b128 v[40:43], v226 offset:8192
    ds_read_b64_tr_b16 v[56:57], v228 offset:30784
    v_mfma_f32_32x32x16_bf16 v[68:83], v[136:139], v[132:135], v[68:83]
    ds_read_b64_tr_b16 v[58:59], v228 offset:31552
    ds_read_b64_tr_b16 v[60:61], v228 offset:30848
    v_mfma_f32_32x32x16_bf16 v[84:99], v[140:143], v[132:135], v[84:99]
    buffer_load_dwordx4 v223, s[12:15], s52 offen offset:3072 lds
    s_add_u32 s52, s52, 128
    ds_read_b64_tr_b16 v[62:63], v228 offset:31616
    ds_read_b64_tr_b16 v[64:65], v228 offset:30720
    v_mfma_f32_32x32x16_bf16 v[100:115], v[144:147], v[132:135], v[100:115]
    ds_read_b64_tr_b16 v[66:67], v228 offset:31488
    ds_read_b64_tr_b16 v[152:153], v229 offset:30720
    v_mfma_f32_16x16x32_bf16 v[20:23], v[32:35], v[156:159], v[20:23]
    ds_read_b64_tr_b16 v[154:155], v229 offset:31488
    s_waitcnt lgkmcnt(9)
    v_mfma_f32_32x32x16_bf16 v[116:131], v[36:39], v[36:39], v[116:131]
    s_add_u32 m0, s60, 20480
    s_nop 0
    buffer_load_dwordx4 v220, s[12:15], s52 offen offset:0 lds
    ds_read_b32 v188, v189 offset:36864
    ds_read_b128 v[132:135], v227 offset:8192
    ds_read_b64_tr_b16 v[136:137], v228 offset:33856
    ds_read_b64_tr_b16 v[138:139], v228 offset:34624
    v_mfma_f32_32x32x16_bf16 v[68:83], v[44:47], v[36:39], v[68:83]
    ds_read_b64_tr_b16 v[140:141], v228 offset:33920
    ds_read_b64_tr_b16 v[142:143], v228 offset:34688
    v_mfma_f32_32x32x16_bf16 v[84:99], v[48:51], v[36:39], v[84:99]
    buffer_load_dwordx4 v221, s[12:15], s52 offen offset:1024 lds
    ds_read_b64_tr_b16 v[144:145], v228 offset:33792
    ds_read_b64_tr_b16 v[146:147], v228 offset:34560
    v_mfma_f32_32x32x16_bf16 v[100:115], v[52:55], v[36:39], v[100:115]
    ds_read_b64_tr_b16 v[156:157], v229 offset:33792
    ds_read_b64_tr_b16 v[158:159], v229 offset:34560
    v_mfma_f32_16x16x32_bf16 v[20:23], v[32:35], v[148:151], v[20:23]
    ds_write_b32 v189, v193 offset:24576
    s_waitcnt lgkmcnt(11)
    v_mfma_f32_32x32x16_bf16 v[116:131], v[40:43], v[40:43], v[116:131]
    s_waitcnt lgkmcnt(10)
    v_cmp_ne_u32 vcc, s31, v188
    buffer_load_dwordx4 v222, s[12:15], s52 offen offset:2048 lds
    v_mfma_f32_32x32x16_bf16 v[68:83], v[56:59], v[40:43], v[68:83]
    s_cbranch_vccnz A_w3
A_w3_ok:
    s_waitcnt vmcnt(11)
    s_barrier
    ds_read_b128 v[36:39], v224 offset:12288
    ds_read_b64_tr_b16 v[44:45], v228 offset:36928
    ds_read_b64_tr_b16 v[46:47], v228 offset:37696
    v_mfma_f32_32x32x16_bf16 v[84:99], v[60:63], v[40:43], v[84:99]
    buffer_load_dwordx4 v223, s[12:15], s52 offen offset:3072 lds
    s_add_u32 s52, s52, 128
    ds_read_b64_tr_b16 v[48:49], v228 offset:36992
    ds_read_b64_tr_b16 v[50:51], v228 offset:37760
    ds_read_b64_tr_b16 v[52:53], v228 offset:36864
    v_mfma_f32_32x32x16_bf16 v[100:115], v[64:67], v[40:43], v[100:115]
    ds_read_b64_tr_b16 v[54:55], v228 offset:37632
    ds_read_b64_tr_b16 v[148:149], v229 offset:36864
    v_mfma_f32_16x16x32_bf16 v[20:23], v[32:35], v[152:155], v[20:23]
    ds_read_b64_tr_b16 v[150:151], v229 offset:37632
    s_waitcnt lgkmcnt(10)
    v_mfma_f32_32x32x16_bf16 v[116:131], v[132:135], v[132:135], v[116:131]
    s_add_u32 s71, s29, 61440
    s_add_u32 m0, s72, 12288
    s_nop 0
    buffer_load_dwordx4 v1, s[8:11], s71 offen offset:0 lds
    ds_read_b128 v[40:43], v225 offset:12288
    ds_read_b64_tr_b16 v[56:57], v228 offset:40000
    v_mfma_f32_32x32x16_bf16 v[68:83], v[136:139], v[132:135], v[68:83]
    ds_read_b64_tr_b16 v[58:59], v228 offset:40768
    ds_read_b64_tr_b16 v[60:61], v228 offset:40064
    v_mfma_f32_32x32x16_bf16 v[84:99], v[140:143], v[132:135], v[84:99]
    buffer_load_dwordx4 v1, s[8:11], s71 offen offset:1024 lds
    ds_read_b64_tr_b16 v[62:63], v228 offset:40832
    ds_read_b64_tr_b16 v[64:65], v228 offset:39936
    v_mfma_f32_32x32x16_bf16 v[100:115], v[144:147], v[132:135], v[100:115]
    ds_read_b64_tr_b16 v[66:67], v228 offset:40704
    ds_read_b64_tr_b16 v[152:153], v229 offset:39936
    v_mfma_f32_16x16x32_bf16 v[20:23], v[32:35], v[156:159], v[20:23]
    ds_read_b64_tr_b16 v[154:155], v229 offset:40704
    s_waitcnt lgkmcnt(9)
    v_mfma_f32_32x32x16_bf16 v[116:131], v[36:39], v[36:39], v[116:131]
    buffer_load_dwordx4 v1, s[8:11], s71 offen offset:2048 lds
    ds_read_b128 v[132:135], v226 offset:12288
    ds_read_b64_tr_b16 v[136:137], v228 offset:43072
    v_mfma_f32_32x32x16_bf16 v[68:83], v[44:47], v[36:39], v[68:83]
    ds_read_b64_tr_b16 v[138:139], v228 offset:43840
    ds_read_b64_tr_b16 v[140:141], v228 offset:43136
    v_mfma_f32_32x32x16_bf16 v[84:99], v[48:51], v[36:39], v[84:99]
    s_add_u32 m0, s60, 24576
    s_nop 0
    buffer_load_dwordx4 v220, s[12:15], s52 offen offset:0 lds
    ds_read_b64_tr_b16 v[142:143], v228 offset:43904
    ds_read_b64_tr_b16 v[144:145], v228 offset:43008
    v_mfma_f32_32x32x16_bf16 v[100:115], v[52:55], v[36:39], v[100:115]
    ds_read_b64_tr_b16 v[146:147], v228 offset:43776
    ds_read_b64_tr_b16 v[156:157], v229 offset:43008
    v_mfma_f32_16x16x32_bf16 v[20:23], v[32:35], v[148:151], v[20:23]
    ds_read_b64_tr_b16 v[158:159], v229 offset:43776
    s_waitcnt lgkmcnt(9)
    v_mfma_f32_32x32x16_bf16 v[116:131], v[40:43], v[40:43], v[116:131]
    buffer_load_dwordx4 v221, s[12:15], s52 offen offset:1024 lds
    ds_read_b32 v188, v189 offset:0
    ds_read_b128 v[36:39], v227 offset:12288
    ds_read_b64_tr_b16 v[44:45], v228 offset:46144
    v_mfma_f32_32x32x16_bf16 v[68:83], v[56:59], v[40:43], v[68:83]
    ds_read_b64_tr_b16 v[46:47], v228 offset:46912
    ds_read_b64_tr_b16 v[48:49], v228 offset:46208
    v_mfma_f32_32x32x16_bf16 v[84:99], v[60:63], v[40:43], v[84:99]
    buffer_load_dwordx4 v222, s[12:15], s52 offen offset:2048 lds
    ds_read_b64_tr_b16 v[50:51], v228 offset:46976
    ds_read_b64_tr_b16 v[52:53], v228 offset:46080
    v_mfma_f32_32x32x16_bf16 v[100:115], v[64:67], v[40:43], v[100:115]
    ds_read_b64_tr_b16 v[54:55], v228 offset:46848
    ds_read_b64_tr_b16 v[148:149], v229 offset:46080
    v_mfma_f32_16x16x32_bf16 v[20:23], v[32:35], v[152:155], v[20:23]
    ds_read_b64_tr_b16 v[150:151], v229 offset:46848
    s_waitcnt lgkmcnt(10)
    v_mfma_f32_32x32x16_bf16 v[116:131], v[132:135], v[132:135], v[116:131]
    s_waitcnt lgkmcnt(9)
    v_cmp_ne_u32 vcc, s31, v188
    buffer_load_dwordx4 v223, s[12:15], s52 offen offset:3072 lds
    v_mfma_f32_32x32x16_bf16 v[68:83], v[136:139], v[132:135], v[68:83]
    s_cbranch_vccnz A_w4
A_w4_ok:
    s_waitcnt vmcnt(11)
    s_barrier
    ds_read_b128 v[40:43], v224 offset:16384
    ds_read_b64_tr_b16 v[56:57], v228 offset:64
    ds_read_b64_tr_b16 v[58:59], v228 offset:832
    v_mfma_f32_32x32x16_bf16 v[84:99], v[140:143], v[132:135], v[84:99]
    s_add_u32 s71, s29, 73728
    s_add_u32 m0, s72, 24576
    s_nop 0
    buffer_load_dwordx4 v1, s[8:11], s71 offen offset:0 lds
    ds_read_b64_tr_b16 v[60:61], v228 offset:128
    ds_read_b64_tr_b16 v[62:63], v228 offset:896
    ds_read_b64_tr_b16 v[64:65], v228 offset:0
    v_mfma_f32_32x32x16_bf16 v[100:115], v[144:147], v[132:135], v[100:115]
    ds_read_b64_tr_b16 v[66:67], v228 offset:768
    ds_read_b64_tr_b16 v[152:153], v229 offset:0
    v_mfma_f32_16x16x32_bf16 v[20:23], v[32:35], v[156:159], v[20:23]
    ds_read_b64_tr_b16 v[154:155], v229 offset:768
    s_waitcnt lgkmcnt(9)
    v_mfma_f32_32x32x16_bf16 v[116:131], v[36:39], v[36:39], v[116:131]
    buffer_load_dwordx4 v1, s[8:11], s71 offen offset:1024 lds
    ds_read_b128 v[132:135], v225 offset:16384
    ds_read_b64_tr_b16 v[136:137], v228 offset:3136
    v_mfma_f32_32x32x16_bf16 v[68:83], v[44:47], v[36:39], v[68:83]
    ds_read_b64_tr_b16 v[138:139], v228 offset:3904
    ds_read_b64_tr_b16 v[140:141], v228 offset:3200
    v_mfma_f32_32x32x16_bf16 v[84:99], v[48:51], v[36:39], v[84:99]
    buffer_load_dwordx4 v1, s[8:11], s71 offen offset:2048 lds
    ds_read_b64_tr_b16 v[142:143], v228 offset:3968
    ds_read_b64_tr_b16 v[144:145], v228 offset:3072
    v_mfma_f32_32x32x16_bf16 v[100:115], v[52:55], v[36:39], v[100:115]
    ds_read_b64_tr_b16 v[146:147], v228 offset:3840
    ds_read_b64_tr_b16 v[156:157], v229 offset:3072
    v_mfma_f32_16x16x32_bf16 v[20:23], v[32:35], v[148:151], v[20:23]
    ds_read_b64_tr_b16 v[158:159], v229 offset:3840
    s_waitcnt lgkmcnt(9)
    v_mfma_f32_32x32x16_bf16 v[116:131], v[40:43], v[40:43], v[116:131]
    ds_read_b128 v[36:39], v226 offset:16384
    ds_read_b64_tr_b16 v[44:45], v228 offset:6208
    v_mfma_f32_32x32x16_bf16 v[68:83], v[56:59], v[40:43], v[68:83]
    ds_read_b64_tr_b16 v[46:47], v228 offset:6976
    ds_read_b64_tr_b16 v[48:49], v228 offset:6272
    v_mfma_f32_32x32x16_bf16 v[84:99], v[60:63], v[40:43], v[84:99]
    ds_read_b64_tr_b16 v[50:51], v228 offset:7040
    ds_read_b64_tr_b16 v[52:53], v228 offset:6144
    v_mfma_f32_32x32x16_bf16 v[100:115], v[64:67], v[40:43], v[100:115]
    ds_read_b64_tr_b16 v[54:55], v228 offset:6912
    ds_read_b64_tr_b16 v[148:149], v229 offset:6144
    v_mfma_f32_16x16x32_bf16 v[20:23], v[32:35], v[152:155], v[20:23]
    ds_read_b64_tr_b16 v[150:151], v229 offset:6912
    s_waitcnt lgkmcnt(9)
    v_mfma_f32_32x32x16_bf16 v[116:131], v[132:135], v[132:135], v[116:131]
    ds_read_b32 v188, v189 offset:12288
    ds_read_b128 v[40:43], v227 offset:16384
    ds_read_b64_tr_b16 v[56:57], v228 offset:9280
    v_mfma_f32_32x32x16_bf16 v[68:83], v[136:139], v[132:135], v[68:83]
    ds_read_b64_tr_b16 v[58:59], v228 offset:10048
    ds_read_b64_tr_b16 v[60:61], v228 offset:9344
    v_mfma_f32_32x32x16_bf16 v[84:99], v[140:143], v[132:135], v[84:99]
    ds_read_b64_tr_b16 v[62:63], v228 offset:10112
    ds_read_b64_tr_b16 v[64:65], v228 offset:9216
    v_mfma_f32_32x32x16_bf16 v[100:115], v[144:147], v[132:135], v[100:115]
    ds_read_b64_tr_b16 v[66:67], v228 offset:9984
    ds_read_b64_tr_b16 v[152:153], v229 offset:9216
    v_mfma_f32_16x16x32_bf16 v[20:23], v[32:35], v[156:159], v[20:23]
    ds_read_b64_tr_b16 v[154:155], v229 offset:9984
    s_waitcnt lgkmcnt(10)
    v_mfma_f32_32x32x16_bf16 v[116:131], v[36:39], v[36:39], v[116:131]
    s_waitcnt lgkmcnt(9)
    v_cmp_ne_u32 vcc, s31, v188
    v_mfma_f32_32x32x16_bf16 v[68:83], v[44:47], v[36:39], v[68:83]
    s_cbranch_vccnz A_w5
A_w5_ok:
    s_waitcnt vmcnt(10)
    s_barrier
    ds_read_b128 v[132:135], v224 offset:20480
    ds_read_b64_tr_b16 v[136:137], v228 offset:12352
    ds_read_b64_tr_b16 v[138:139], v228 offset:13120
    v_mfma_f32_32x32x16_bf16 v[84:99], v[48:51], v[36:39], v[84:99]
    buffer_load_dword v184, v184, s[16:19], 0 offen
    ds_read_b64_tr_b16 v[140:141], v228 offset:12416
    ds_read_b64_tr_b16 v[142:143], v228 offset:13184
    ds_read_b64_tr_b16 v[144:145], v228 offset:12288
    v_mfma_f32_32x32x16_bf16 v[100:115], v[52:55], v[36:39], v[100:115]
    ds_read_b64_tr_b16 v[146:147], v228 offset:13056
    ds_read_b64_tr_b16 v[156:157], v229 offset:12288
    v_mfma_f32_16x16x32_bf16 v[20:23], v[32:35], v[148:151], v[20:23]
    ds_read_b64_tr_b16 v[158:159], v229 offset:13056
    s_waitcnt lgkmcnt(9)
    v_mfma_f32_32x32x16_bf16 v[116:131], v[40:43], v[40:43], v[116:131]
    buffer_load_dword v185, v185, s[20:23], 0 offen
    ds_read_b128 v[36:39], v225 offset:20480
    ds_read_b64_tr_b16 v[44:45], v228 offset:15424
    v_mfma_f32_32x32x16_bf16 v[68:83], v[56:59], v[40:43], v[68:83]
    ds_read_b64_tr_b16 v[46:47], v228 offset:16192
    ds_read_b64_tr_b16 v[48:49], v228 offset:15488
    v_mfma_f32_32x32x16_bf16 v[84:99], v[60:63], v[40:43], v[84:99]
    buffer_load_dword v186, v186, s[24:27], 0 offen
    ds_read_b64_tr_b16 v[50:51], v228 offset:16256
    ds_read_b64_tr_b16 v[52:53], v228 offset:15360
    v_mfma_f32_32x32x16_bf16 v[100:115], v[64:67], v[40:43], v[100:115]
    ds_read_b64_tr_b16 v[54:55], v228 offset:16128
    ds_read_b64_tr_b16 v[148:149], v229 offset:15360
    v_mfma_f32_16x16x32_bf16 v[20:23], v[32:35], v[152:155], v[20:23]
    ds_read_b64_tr_b16 v[150:151], v229 offset:16128
    s_waitcnt lgkmcnt(9)
    v_mfma_f32_32x32x16_bf16 v[116:131], v[132:135], v[132:135], v[116:131]
    ds_read_b128 v[40:43], v226 offset:20480
    ds_read_b64_tr_b16 v[56:57], v228 offset:18496
    v_mfma_f32_32x32x16_bf16 v[68:83], v[136:139], v[132:135], v[68:83]
    ds_read_b64_tr_b16 v[58:59], v228 offset:19264
    ds_read_b64_tr_b16 v[60:61], v228 offset:18560
    v_mfma_f32_32x32x16_bf16 v[84:99], v[140:143], v[132:135], v[84:99]
    ds_read_b64_tr_b16 v[62:63], v228 offset:19328
    ds_read_b64_tr_b16 v[64:65], v228 offset:18432
    v_mfma_f32_32x32x16_bf16 v[100:115], v[144:147], v[132:135], v[100:115]
    ds_read_b64_tr_b16 v[66:67], v228 offset:19200
    ds_read_b64_tr_b16 v[152:153], v229 offset:18432
    v_mfma_f32_16x16x32_bf16 v[20:23], v[32:35], v[156:159], v[20:23]
    ds_read_b64_tr_b16 v[154:155], v229 offset:19200
    s_waitcnt lgkmcnt(9)
    v_mfma_f32_32x32x16_bf16 v[116:131], v[36:39], v[36:39], v[116:131]
    ds_read_b32 v188, v189 offset:24576
    ds_read_b128 v[132:135], v227 offset:20480
    ds_read_b64_tr_b16 v[136:137], v228 offset:21568
    v_mfma_f32_32x32x16_bf16 v[68:83], v[44:47], v[36:39], v[68:83]
    ds_read_b64_tr_b16 v[138:139], v228 offset:22336
    ds_read_b64_tr_b16 v[140:141], v228 offset:21632
    v_mfma_f32_32x32x16_bf16 v[84:99], v[48:51], v[36:39], v[84:99]
    ds_read_b64_tr_b16 v[142:143], v228 offset:22400
    ds_read_b64_tr_b16 v[144:145], v228 offset:21504
    v_mfma_f32_32x32x16_bf16 v[100:115], v[52:55], v[36:39], v[100:115]
    ds_read_b64_tr_b16 v[146:147], v228 offset:22272
    ds_read_b64_tr_b16 v[156:157], v229 offset:21504
    v_mfma_f32_16x16x32_bf16 v[20:23], v[32:35], v[148:151], v[20:23]
    ds_read_b64_tr_b16 v[158:159], v229 offset:22272
    s_waitcnt lgkmcnt(10)
    v_mfma_f32_32x32x16_bf16 v[116:131], v[40:43], v[40:43], v[116:131]
    s_waitcnt lgkmcnt(9)
    v_cmp_ne_u32 vcc, s31, v188
    v_mfma_f32_32x32x16_bf16 v[68:83], v[56:59], v[40:43], v[68:83]
    s_cbranch_vccnz A_w6
A_w6_ok:
    s_waitcnt vmcnt(6)
    s_barrier
    ds_read_b128 v[36:39], v224 offset:24576
    ds_read_b64_tr_b16 v[44:45], v228 offset:24640
    ds_read_b64_tr_b16 v[46:47], v228 offset:25408
    v_mfma_f32_32x32x16_bf16 v[84:99], v[60:63], v[40:43], v[84:99]
    ds_read_b64_tr_b16 v[48:49], v228 offset:24704
    ds_read_b64_tr_b16 v[50:51], v228 offset:25472
    ds_read_b64_tr_b16 v[52:53], v228 offset:24576
    v_mfma_f32_32x32x16_bf16 v[100:115], v[64:67], v[40:43], v[100:115]
    ds_read_b64_tr_b16 v[54:55], v228 offset:25344
    ds_read_b64_tr_b16 v[148:149], v229 offset:24576
    v_mfma_f32_16x16x32_bf16 v[20:23], v[32:35], v[152:155], v[20:23]
    ds_read_b64_tr_b16 v[150:151], v229 offset:25344
    s_waitcnt lgkmcnt(9)
    v_mfma_f32_32x32x16_bf16 v[116:131], v[132:135], v[132:135], v[116:131]
    ds_read_b128 v[40:43], v225 offset:24576
    ds_read_b64_tr_b16 v[56:57], v228 offset:27712
    v_mfma_f32_32x32x16_bf16 v[68:83], v[136:139], v[132:135], v[68:83]
    ds_read_b64_tr_b16 v[58:59], v228 offset:28480
    ds_read_b64_tr_b16 v[60:61], v228 offset:27776
    v_mfma_f32_32x32x16_bf16 v[84:99], v[140:143], v[132:135], v[84:99]
    ds_read_b64_tr_b16 v[62:63], v228 offset:28544
    ds_read_b64_tr_b16 v[64:65], v228 offset:27648
    v_mfma_f32_32x32x16_bf16 v[100:115], v[144:147], v[132:135], v[100:115]
    ds_read_b64_tr_b16 v[66:67], v228 offset:28416
    ds_read_b64_tr_b16 v[152:153], v229 offset:27648
    v_mfma_f32_16x16x32_bf16 v[20:23], v[32:35], v[156:159], v[20:23]
    ds_read_b64_tr_b16 v[154:155], v229 offset:28416
    s_waitcnt lgkmcnt(9)
    v_mfma_f32_32x32x16_bf16 v[116:131], v[36:39], v[36:39], v[116:131]
    ds_read_b128 v[132:135], v226 offset:24576
    ds_read_b64_tr_b16 v[136:137], v228 offset:30784
    v_mfma_f32_32x32x16_bf16 v[68:83], v[44:47], v[36:39], v[68:83]
    ds_read_b64_tr_b16 v[138:139], v228 offset:31552
    ds_read_b64_tr_b16 v[140:141], v228 offset:30848
    v_mfma_f32_32x32x16_bf16 v[84:99], v[48:51], v[36:39], v[84:99]
    s_and_b32 s30, s30, 0xfffffec0
    buffer_load_dword v232, v17, s[8:11], s30 offen sc1
    ds_read_b64_tr_b16 v[142:143], v228 offset:31616
    ds_read_b64_tr_b16 v[144:145], v228 offset:30720
    v_mfma_f32_32x32x16_bf16 v[100:115], v[52:55], v[36:39], v[100:115]
    ds_read_b64_tr_b16 v[146:147], v228 offset:31488
    ds_read_b64_tr_b16 v[156:157], v229 offset:30720
    v_mfma_f32_16x16x32_bf16 v[20:23], v[32:35], v[148:151], v[20:23]
    ds_read_b64_tr_b16 v[158:159], v229 offset:31488
    s_waitcnt lgkmcnt(9)
    v_mfma_f32_32x32x16_bf16 v[116:131], v[40:43], v[40:43], v[116:131]
    ds_read_b128 v[36:39], v227 offset:24576
    ds_read_b64_tr_b16 v[44:45], v228 offset:33856
    v_mfma_f32_32x32x16_bf16 v[68:83], v[56:59], v[40:43], v[68:83]
    ds_read_b64_tr_b16 v[46:47], v228 offset:34624
    ds_read_b64_tr_b16 v[48:49], v228 offset:33920
    v_mfma_f32_32x32x16_bf16 v[84:99], v[60:63], v[40:43], v[84:99]
    ds_read_b64_tr_b16 v[50:51], v228 offset:34688
    ds_read_b64_tr_b16 v[52:53], v228 offset:33792
    v_mfma_f32_32x32x16_bf16 v[100:115], v[64:67], v[40:43], v[100:115]
    ds_read_b64_tr_b16 v[54:55], v228 offset:34560
    ds_read_b64_tr_b16 v[148:149], v229 offset:33792
    v_mfma_f32_16x16x32_bf16 v[20:23], v[32:35], v[152:155], v[20:23]
    ds_read_b64_tr_b16 v[150:151], v229 offset:34560
    s_waitcnt lgkmcnt(9)
    v_mfma_f32_16x16x32_bf16 v[20:23], v[32:35], v[156:159], v[20:23]
    v_mfma_f32_32x32x16_bf16 v[116:131], v[132:135], v[132:135], v[116:131]
    v_mfma_f32_32x32x16_bf16 v[68:83], v[136:139], v[132:135], v[68:83]
    s_waitcnt lgkmcnt(0)
    v_mfma_f32_16x16x32_bf16 v[20:23], v[32:35], v[148:151], v[20:23]
    v_mfma_f32_32x32x16_bf16 v[116:131], v[36:39], v[36:39], v[116:131]
    v_mfma_f32_32x32x16_bf16 v[68:83], v[44:47], v[36:39], v[68:83]
    v_mfma_f32_32x32x16_bf16 v[100:115], v[144:147], v[132:135], v[100:115]
    s_mov_b32 s42, 0xffff0000
    s_cmp_ge_u32 s43, 28
    s_cselect_b32 s18, 0, s18
    s_cselect_b32 s22, 0, s22
    s_cselect_b32 s26, 0, s26
    ds_write2_b32 v192, v20, v21 offset1:16
    v_mfma_f32_32x32x16_bf16 v[100:115], v[52:55], v[36:39], v[100:115]
    s_mov_b32 vcc_lo, 0xaaaaaaaa
    s_mov_b32 vcc_hi, 0xaaaaaaaa
    s_waitcnt vmcnt(0) lgkmcnt(0)
    s_barrier
    ds_read_b128 v[160:163], v191 offset:128
    ds_read_b128 v[164:167], v191 offset:160
    ds_read_b128 v[168:171], v191 offset:192
    ds_read_b128 v[172:175], v191 offset:224
    v_mfma_f32_32x32x16_bf16 v[84:99], v[140:143], v[132:135], v[84:99]
    v_cndmask_b32 v116, v116, v117, vcc
    v_cndmask_b32 v118, v118, v119, vcc
    v_cndmask_b32 v120, v120, v121, vcc
    v_cndmask_b32 v122, v122, v123, vcc
    v_cndmask_b32 v124, v124, v125, vcc
    v_cndmask_b32 v126, v126, v127, vcc
    v_cndmask_b32 v128, v128, v129, vcc
    v_cndmask_b32 v130, v130, v131, vcc
    ds_read_b128 v[144:147], v191 offset:0
    ds_read_b128 v[148:151], v191 offset:32
    ds_read_b128 v[152:155], v191 offset:64
    ds_read_b128 v[156:159], v191 offset:96
    v_mfma_f32_32x32x16_bf16 v[84:99], v[48:51], v[36:39], v[84:99]
    s_add_u32 m0, s51, 0
    s_nop 0
    buffer_load_dwordx4 v2, s[16:19], s54 offen offset:0 lds
    buffer_load_dwordx4 v13, s[16:19], s54 offen offset:1024 lds
    buffer_load_dwordx4 v14, s[16:19], s54 offen offset:2048 lds
    buffer_load_dwordx4 v15, s[16:19], s54 offen offset:3072 lds
    s_add_u32 s54, s54, 25088
    s_mov_b32 vcc_lo, 0xcccccccc
    s_mov_b32 vcc_hi, 0xcccccccc
    v_cndmask_b32 v116, v116, v118, vcc
    v_cndmask_b32 v120, v120, v122, vcc
    v_cndmask_b32 v124, v124, v126, vcc
    v_cndmask_b32 v128, v128, v130, vcc
    s_mov_b32 vcc_lo, 0xff00ff00
    s_mov_b32 vcc_hi, 0xff00ff00
    v_cndmask_b32 v116, v116, v120, vcc
    v_cndmask_b32 v124, v124, v128, vcc
    s_mov_b32 vcc_lo, 0xffff0000
    s_mov_b32 vcc_hi, 0xffff0000
    v_cndmask_b32 v116, v116, v124, vcc
    s_mov_b32 vcc_lo, 0x0f0f0f0f
    s_mov_b32 vcc_hi, 0xf0f0f0f0
    v_mov_b32 v22, v80
    v_cndmask_b32 v20, 0, v116, vcc
    v_mov_b32 v23, v80
    v_cndmask_b32 v21, 0, v116, vcc
    s_nop 0
    v_permlane32_swap_b32 v22, v23
    v_permlane32_swap_b32 v20, v21
    v_add_f32 v20, v20, v21
    v_mul_f32 v24, 0xbb124925, v23
    v_mul_f32 v20, 0x3b124925, v20
    v_fma_f32 v20, -v24, v24, v20
    ds_read_b128 v[128:131], v191 offset:256
    ds_read_b128 v[132:135], v191 offset:288
    ds_read_b128 v[136:139], v191 offset:320
    ds_read_b128 v[140:143], v191 offset:352
    v_max_f32 v20, 0, v20
    v_add_f32 v20, 0x3727c5ac, v20
    v_rsq_f32 v26, v20
    s_lshl_b32 s66, s3, 11
    s_add_u32 s66, s66, 139264
    v_add_u32 v31, s66, v1
    v_cmp_ne_u32 vcc, s73, v232
    v_xor_b32 v28, 2048, v31
    v_xor_b32 v29, 4096, v31
    v_xor_b32 v30, 6144, v31
    s_cmp_eq_u64 vcc, 0
    s_cselect_b32 s72, 1, 0
    s_waitcnt lgkmcnt(11)
    v_pk_fma_f32 v[68:69], v[160:161], v[24:25], v[68:69] op_sel_hi:[1,0,1]
    v_pk_fma_f32 v[70:71], v[162:163], v[24:25], v[70:71] op_sel_hi:[1,0,1]
    s_waitcnt lgkmcnt(10)
    v_pk_fma_f32 v[72:73], v[164:165], v[24:25], v[72:73] op_sel_hi:[1,0,1]
    v_pk_fma_f32 v[74:75], v[166:167], v[24:25], v[74:75] op_sel_hi:[1,0,1]
    s_waitcnt lgkmcnt(9)
    v_pk_fma_f32 v[76:77], v[168:169], v[24:25], v[76:77] op_sel_hi:[1,0,1]
    v_pk_fma_f32 v[78:79], v[170:171], v[24:25], v[78:79] op_sel_hi:[1,0,1]
    s_waitcnt lgkmcnt(8)
    v_pk_fma_f32 v[80:81], v[172:173], v[24:25], v[80:81] op_sel_hi:[1,0,1]
    v_pk_fma_f32 v[82:83], v[174:175], v[24:25], v[82:83] op_sel_hi:[1,0,1]
    v_mul_f32 v20, 0x3e8b97f6, v26
    v_pk_mul_f32 v[68:69], v[68:69], v[26:27] op_sel_hi:[1,0]
    v_pk_mul_f32 v[70:71], v[70:71], v[26:27] op_sel_hi:[1,0]
    v_pk_mul_f32 v[72:73], v[72:73], v[26:27] op_sel_hi:[1,0]
    v_pk_mul_f32 v[74:75], v[74:75], v[26:27] op_sel_hi:[1,0]
    v_pk_mul_f32 v[76:77], v[76:77], v[26:27] op_sel_hi:[1,0]
    v_pk_mul_f32 v[78:79], v[78:79], v[26:27] op_sel_hi:[1,0]
    v_pk_mul_f32 v[80:81], v[80:81], v[26:27] op_sel_hi:[1,0]
    v_pk_mul_f32 v[82:83], v[82:83], v[26:27] op_sel_hi:[1,0]
    v_cvt_pk_bf16_f32 v176, v68, v69
    v_cvt_pk_bf16_f32 v177, v70, v71
    v_cvt_pk_bf16_f32 v178, v72, v73
    v_cvt_pk_bf16_f32 v179, v74, v75
    v_cvt_pk_bf16_f32 v180, v76, v77
    v_cvt_pk_bf16_f32 v181, v78, v79
    v_cvt_pk_bf16_f32 v182, v80, v81
    v_cvt_pk_bf16_f32 v183, v82, v83
    s_mov_b32 exec_lo, 0
    v_mov_b32 v182, 0
    v_mov_b32 v183, 0
    s_mov_b32 exec_lo, -1
    s_cmp_eq_u32 s72, 0
    v_min_u32 v176, -2, v176
    v_min_u32 v180, -2, v180
    s_cbranch_scc1 A_sk
    buffer_store_dwordx4 v[176:179], v1, s[44:47], s48 offen offset:0
    buffer_store_dwordx4 v[180:183], v1, s[44:47], s48 offen offset:1024
A_sk_ok:
    s_waitcnt lgkmcnt(7)
    v_pk_fma_f32 v[100:101], v[144:145], v[24:25], v[100:101] op_sel_hi:[1,0,1]
    v_pk_fma_f32 v[102:103], v[146:147], v[24:25], v[102:103] op_sel_hi:[1,0,1]
    s_waitcnt lgkmcnt(6)
    v_pk_fma_f32 v[104:105], v[148:149], v[24:25], v[104:105] op_sel_hi:[1,0,1]
    v_pk_fma_f32 v[106:107], v[150:151], v[24:25], v[106:107] op_sel_hi:[1,0,1]
    s_waitcnt lgkmcnt(5)
    v_pk_fma_f32 v[108:109], v[152:153], v[24:25], v[108:109] op_sel_hi:[1,0,1]
    v_pk_fma_f32 v[110:111], v[154:155], v[24:25], v[110:111] op_sel_hi:[1,0,1]
    s_waitcnt lgkmcnt(4)
    v_pk_fma_f32 v[112:113], v[156:157], v[24:25], v[112:113] op_sel_hi:[1,0,1]
    v_pk_fma_f32 v[114:115], v[158:159], v[24:25], v[114:115] op_sel_hi:[1,0,1]
    v_pk_mul_f32 v[100:101], v[100:101], v[20:21] op_sel_hi:[1,0]
    v_pk_mul_f32 v[102:103], v[102:103], v[20:21] op_sel_hi:[1,0]
    v_pk_mul_f32 v[104:105], v[104:105], v[20:21] op_sel_hi:[1,0]
    v_pk_mul_f32 v[106:107], v[106:107], v[20:21] op_sel_hi:[1,0]
    v_pk_mul_f32 v[108:109], v[108:109], v[20:21] op_sel_hi:[1,0]
    v_pk_mul_f32 v[110:111], v[110:111], v[20:21] op_sel_hi:[1,0]
    v_pk_mul_f32 v[112:113], v[112:113], v[20:21] op_sel_hi:[1,0]
    v_pk_mul_f32 v[114:115], v[114:115], v[20:21] op_sel_hi:[1,0]
    v_cvt_pk_bf16_f32 v144, v100, v101
    v_cvt_pk_bf16_f32 v145, v102, v103
    v_cvt_pk_bf16_f32 v146, v104, v105
    v_cvt_pk_bf16_f32 v147, v106, v107
    v_cvt_pk_bf16_f32 v148, v108, v109
    v_cvt_pk_bf16_f32 v149, v110, v111
    v_cvt_pk_bf16_f32 v150, v112, v113
    v_cvt_pk_bf16_f32 v151, v114, v115
    s_mov_b32 exec_lo, 0
    v_mov_b32 v150, 0
    v_mov_b32 v151, 0
    s_mov_b32 exec_lo, -1
    ds_write_b128 v31, v[144:147] offset:0
    ds_write_b128 v31, v[148:151] offset:1024
    s_add_u32 m0, s51, 4096
    s_nop 0
    buffer_load_dwordx4 v2, s[16:19], s54 offen offset:0 lds
    buffer_load_dwordx4 v13, s[16:19], s54 offen offset:1024 lds
    buffer_load_dwordx4 v14, s[16:19], s54 offen offset:2048 lds
    buffer_load_dwordx4 v15, s[16:19], s54 offen offset:3072 lds
    s_add_u32 s54, s54, 25088
    s_waitcnt lgkmcnt(5)
    v_pk_fma_f32 v[84:85], v[128:129], v[24:25], v[84:85] op_sel_hi:[1,0,1]
    v_pk_fma_f32 v[86:87], v[130:131], v[24:25], v[86:87] op_sel_hi:[1,0,1]
    s_waitcnt lgkmcnt(4)
    v_pk_fma_f32 v[88:89], v[132:133], v[24:25], v[88:89] op_sel_hi:[1,0,1]
    v_pk_fma_f32 v[90:91], v[134:135], v[24:25], v[90:91] op_sel_hi:[1,0,1]
    s_waitcnt lgkmcnt(3)
    v_pk_fma_f32 v[92:93], v[136:137], v[24:25], v[92:93] op_sel_hi:[1,0,1]
    v_pk_fma_f32 v[94:95], v[138:139], v[24:25], v[94:95] op_sel_hi:[1,0,1]
    s_waitcnt lgkmcnt(2)
    v_pk_fma_f32 v[96:97], v[140:141], v[24:25], v[96:97] op_sel_hi:[1,0,1]
    v_pk_fma_f32 v[98:99], v[142:143], v[24:25], v[98:99] op_sel_hi:[1,0,1]
    v_pk_mul_f32 v[84:85], v[84:85], v[26:27] op_sel_hi:[1,0]
    v_pk_mul_f32 v[86:87], v[86:87], v[26:27] op_sel_hi:[1,0]
    v_pk_mul_f32 v[88:89], v[88:89], v[26:27] op_sel_hi:[1,0]
    v_pk_mul_f32 v[90:91], v[90:91], v[26:27] op_sel_hi:[1,0]
    v_pk_mul_f32 v[92:93], v[92:93], v[26:27] op_sel_hi:[1,0]
    v_pk_mul_f32 v[94:95], v[94:95], v[26:27] op_sel_hi:[1,0]
    v_pk_mul_f32 v[96:97], v[96:97], v[26:27] op_sel_hi:[1,0]
    v_pk_mul_f32 v[98:99], v[98:99], v[26:27] op_sel_hi:[1,0]
    v_cvt_pk_bf16_f32 v128, v84, v85
    v_cvt_pk_bf16_f32 v129, v86, v87
    v_cvt_pk_bf16_f32 v130, v88, v89
    v_cvt_pk_bf16_f32 v131, v90, v91
    v_cvt_pk_bf16_f32 v132, v92, v93
    v_cvt_pk_bf16_f32 v133, v94, v95
    v_cvt_pk_bf16_f32 v134, v96, v97
    v_cvt_pk_bf16_f32 v135, v98, v99
    s_mov_b32 exec_lo, 0
    v_mov_b32 v134, 0x3f80
    v_mov_b32 v135, 0
    s_mov_b32 exec_lo, -1
    ds_write_b64 v231, v[128:129] offset:16384
    ds_write_b64 v231, v[130:131] offset:16400
    ds_write_b64 v231, v[132:133] offset:16416
    ds_write_b64 v231, v[134:135] offset:16432
    ds_read_b64_tr_b16 v[208:209], v18 offset:16384
    ds_read_b64_tr_b16 v[210:211], v18 offset:16960
    ds_read_b64_tr_b16 v[212:213], v18 offset:17536
    ds_read_b64_tr_b16 v[214:215], v18 offset:18112
    s_waitcnt lgkmcnt(8)
    s_barrier
    ds_read_b128 a[208:211], v28 offset:0
    ds_read_b128 a[212:215], v28 offset:1024
    ds_read_b128 a[216:219], v29 offset:0
    ds_read_b128 a[220:223], v29 offset:1024
    ds_read_b128 a[224:227], v30 offset:0
    ds_read_b128 a[228:231], v30 offset:1024
    ds_read_b128 a[232:235], v31 offset:0
    ds_read_b128 a[236:239], v31 offset:1024
    s_cmp_eq_u32 s72, 0
    s_waitcnt lgkmcnt(8)
    v_min_u32 v208, -2, v208
    v_min_u32 v212, -2, v212
    s_cbranch_scc1 A_sv
    buffer_store_dwordx4 v[208:211], v1, s[44:47], s48 offen offset:2048
    buffer_store_dwordx4 v[212:215], v1, s[44:47], s48 offen offset:3072
A_sv_ok:
    s_cmp_eq_u32 s72, 0
    s_cbranch_scc1 B_t1
B_t1_ok:
    s_add_u32 s48, s48, 0x4000
    s_bitset0_b32 s48, 18
    buffer_load_dwordx4 v[184:187], v1, s[44:47], s48 offen offset:0 sc1
    buffer_load_dwordx4 v[188:191], v1, s[44:47], s48 offen offset:1024 sc1
    s_waitcnt lgkmcnt(7)
    v_mfma_f32_32x32x16_bf16 v[112:127], v[176:179], a[208:211], 0
    s_waitcnt lgkmcnt(6)
    v_mfma_f32_32x32x16_bf16 v[112:127], v[180:183], a[212:215], v[112:127]
    s_waitcnt lgkmcnt(5)
    v_mfma_f32_32x32x16_bf16 v[128:143], v[176:179], a[216:219], 0
    s_lshl_b32 s66, s49, 4
    buffer_load_dwordx4 v[216:219], v1, s[44:47], s48 offen offset:2048 sc1
    s_nop 7
    v_exp_f32 v144, v112
    v_exp_f32 v145, v113
    v_exp_f32 v146, v114
    v_exp_f32 v147, v115
    s_waitcnt lgkmcnt(4)
    v_mfma_f32_32x32x16_bf16 v[128:143], v[180:183], a[220:223], v[128:143]
    s_add_u32 s66, s66, s65
    v_exp_f32 v148, v116
    v_exp_f32 v149, v117
    v_exp_f32 v150, v118
    v_exp_f32 v151, v119
    v_cvt_pk_bf16_f32 v160, v144, v145
    v_cvt_pk_bf16_f32 v161, v146, v147
    v_exp_f32 v152, v120
    v_exp_f32 v153, v121
    v_exp_f32 v154, v122
    v_exp_f32 v155, v123
    v_cvt_pk_bf16_f32 v162, v148, v149
    v_cvt_pk_bf16_f32 v163, v150, v151
    v_exp_f32 v156, v124
    v_exp_f32 v157, v125
    v_exp_f32 v158, v126
    v_exp_f32 v159, v127
    v_cvt_pk_bf16_f32 v164, v152, v153
    v_cvt_pk_bf16_f32 v165, v154, v155
    s_waitcnt lgkmcnt(3)
    v_mfma_f32_32x32x16_bf16 v[112:127], v[176:179], a[224:227], 0
    s_lshl_b32 s66, s66, 2
    buffer_load_dwordx4 v[220:223], v1, s[44:47], s48 offen offset:3072 sc1
    v_exp_f32 v144, v128
    v_exp_f32 v145, v129
    v_exp_f32 v146, v130
    v_exp_f32 v147, v131
    v_cvt_pk_bf16_f32 v166, v156, v157
    v_cvt_pk_bf16_f32 v167, v158, v159
    s_waitcnt lgkmcnt(2)
    v_mfma_f32_32x32x16_bf16 v[112:127], v[180:183], a[228:231], v[112:127]
    s_add_u32 m0, s51, 8192
    s_nop 0
    buffer_load_dwordx4 v2, s[16:19], s54 offen offset:0 lds
    v_exp_f32 v148, v132
    v_exp_f32 v149, v133
    v_exp_f32 v150, v134
    v_exp_f32 v151, v135
    v_cvt_pk_bf16_f32 v168, v144, v145
    v_cvt_pk_bf16_f32 v169, v146, v147
    v_mfma_f32_32x32x16_bf16 v[48:63], v[208:211], v[160:163], 0
    s_add_u32 s48, s48, 0x4000
    buffer_load_dwordx4 v13, s[16:19], s54 offen offset:1024 lds
    v_exp_f32 v152, v136
    v_exp_f32 v153, v137
    v_exp_f32 v154, v138
    v_exp_f32 v155, v139
    v_cvt_pk_bf16_f32 v170, v148, v149
    v_cvt_pk_bf16_f32 v171, v150, v151
    v_mfma_f32_32x32x16_bf16 v[48:63], v[212:215], v[164:167], v[48:63]
    s_bitset0_b32 s48, 18
    buffer_load_dwordx4 v14, s[16:19], s54 offen offset:2048 lds
    v_exp_f32 v156, v140
    v_exp_f32 v157, v141
    v_exp_f32 v158, v142
    v_exp_f32 v159, v143
    v_cvt_pk_bf16_f32 v172, v152, v153
    v_cvt_pk_bf16_f32 v173, v154, v155
    s_waitcnt lgkmcnt(1)
    v_mfma_f32_32x32x16_bf16 v[128:143], v[176:179], a[232:235], 0
    s_waitcnt vmcnt(15)
    ds_read_b64_tr_b16 a[0:1], v4 offset:0
    ds_read_b64_tr_b16 a[2:3], v4 offset:1024
    ds_read_b64_tr_b16 a[4:5], v5 offset:0
    v_exp_f32 v144, v112
    v_exp_f32 v145, v113
    v_exp_f32 v146, v114
    v_exp_f32 v147, v115
    v_cvt_pk_bf16_f32 v174, v156, v157
    v_cvt_pk_bf16_f32 v175, v158, v159
    s_waitcnt lgkmcnt(3)
    v_mfma_f32_32x32x16_bf16 v[128:143], v[180:183], a[236:239], v[128:143]
    s_add_u32 s66, s66, s3
    buffer_load_dwordx4 v[192:195], v1, s[44:47], s48 offen offset:0 sc1
    v_exp_f32 v148, v116
    v_exp_f32 v149, v117
    v_exp_f32 v150, v118
    v_exp_f32 v151, v119
    v_cvt_pk_bf16_f32 v160, v144, v145
    v_cvt_pk_bf16_f32 v161, v146, v147
    v_mfma_f32_32x32x16_bf16 v[64:79], v[208:211], v[168:171], 0
    s_waitcnt vmcnt(6)
    v_max_u32 v7, v184, v188
    v_cmp_eq_u32 vcc, -1, v7
    v_exp_f32 v152, v120
    v_exp_f32 v153, v121
    v_exp_f32 v154, v122
    v_exp_f32 v155, v123
    v_cvt_pk_bf16_f32 v162, v148, v149
    v_cvt_pk_bf16_f32 v163, v150, v151
    v_mfma_f32_32x32x16_bf16 v[64:79], v[212:215], v[172:175], v[64:79]
    s_cbranch_vccnz B_r0
B_r0_ok:
    v_exp_f32 v156, v124
    v_exp_f32 v157, v125
    v_exp_f32 v158, v126
    v_exp_f32 v159, v127
    v_cvt_pk_bf16_f32 v164, v152, v153
    v_cvt_pk_bf16_f32 v165, v154, v155
    v_mfma_f32_32x32x16_bf16 v[112:127], v[184:187], a[208:211], 0
    s_lshl_b32 s66, s66, 2
    buffer_load_dwordx4 v[196:199], v1, s[44:47], s48 offen offset:1024 sc1
    v_exp_f32 v144, v128
    v_exp_f32 v145, v129
    v_exp_f32 v146, v130
    v_exp_f32 v147, v131
    v_cvt_pk_bf16_f32 v166, v156, v157
    v_cvt_pk_bf16_f32 v167, v158, v159
    v_mfma_f32_32x32x16_bf16 v[112:127], v[188:191], a[212:215], v[112:127]
    s_add_u32 s66, s66, 0x1171000
    buffer_load_dwordx4 v[224:227], v1, s[44:47], s48 offen offset:2048 sc1
    v_exp_f32 v148, v132
    v_exp_f32 v149, v133
    v_exp_f32 v150, v134
    v_exp_f32 v151, v135
    v_cvt_pk_bf16_f32 v168, v144, v145
    v_cvt_pk_bf16_f32 v169, v146, v147
    v_mfma_f32_32x32x16_bf16 v[80:95], v[208:211], v[160:163], 0
    s_add_u32 s68, s57, 28672
    ds_read_b64_tr_b16 a[6:7], v5 offset:1024
    ds_read_b64_tr_b16 a[8:9], v4 offset:2048
    ds_read_b64_tr_b16 a[10:11], v4 offset:3072
    v_exp_f32 v152, v136
    v_exp_f32 v153, v137
    v_exp_f32 v154, v138
    v_exp_f32 v155, v139
    v_cvt_pk_bf16_f32 v170, v148, v149
    v_cvt_pk_bf16_f32 v171, v150, v151
    v_mfma_f32_32x32x16_bf16 v[80:95], v[212:215], v[164:167], v[80:95]
    s_add_u32 s69, s58, 4096
    buffer_store_dwordx4 v[8:11], v1, s[8:11], s50 offen offset:0 sc1
    v_exp_f32 v156, v140
    v_exp_f32 v157, v141
    v_exp_f32 v158, v142
    v_exp_f32 v159, v143
    v_cvt_pk_bf16_f32 v172, v152, v153
    v_cvt_pk_bf16_f32 v173, v154, v155
    v_mfma_f32_32x32x16_bf16 v[128:143], v[184:187], a[216:219], 0
    buffer_load_dwordx4 v[228:231], v1, s[44:47], s48 offen offset:3072 sc1
    v_exp_f32 v144, v112
    v_exp_f32 v145, v113
    v_exp_f32 v146, v114
    v_exp_f32 v147, v115
    v_cvt_pk_bf16_f32 v174, v156, v157
    v_cvt_pk_bf16_f32 v175, v158, v159
    v_mfma_f32_32x32x16_bf16 v[128:143], v[188:191], a[220:223], v[128:143]
    s_barrier
    v_exp_f32 v148, v116
    v_exp_f32 v149, v117
    v_exp_f32 v150, v118
    v_exp_f32 v151, v119
    v_cvt_pk_bf16_f32 v160, v144, v145
    v_cvt_pk_bf16_f32 v161, v146, v147
    v_mfma_f32_32x32x16_bf16 v[96:111], v[208:211], v[168:171], 0
    s_add_u32 s48, s48, 0x4000
    buffer_load_dwordx4 v15, s[16:19], s54 offen offset:3072 lds
    v_exp_f32 v152, v120
    v_exp_f32 v153, v121
    v_exp_f32 v154, v122
    v_exp_f32 v155, v123
    v_cvt_pk_bf16_f32 v162, v148, v149
    v_cvt_pk_bf16_f32 v163, v150, v151
    v_mfma_f32_32x32x16_bf16 v[96:111], v[212:215], v[172:175], v[96:111]
    s_bitset0_b32 s48, 18
    ds_read_b64_tr_b16 a[12:13], v5 offset:2048
    ds_read_b64_tr_b16 a[14:15], v5 offset:3072
    v_exp_f32 v156, v124
    v_exp_f32 v157, v125
    v_exp_f32 v158, v126
    v_exp_f32 v159, v127
    v_cvt_pk_bf16_f32 v164, v152, v153
    v_cvt_pk_bf16_f32 v165, v154, v155
    v_mfma_f32_32x32x16_bf16 v[112:127], v[184:187], a[224:227], 0
    s_waitcnt vmcnt(5)
    v_max3_u32 v7, v216, v220, v192
    s_waitcnt vmcnt(4)
    v_max_u32 v7, v196, v7
    v_cmp_eq_u32 vcc, -1, v7
    v_exp_f32 v144, v128
    v_exp_f32 v145, v129
    v_exp_f32 v146, v130
    v_exp_f32 v147, v131
    v_cvt_pk_bf16_f32 v166, v156, v157
    v_cvt_pk_bf16_f32 v167, v158, v159
    v_mfma_f32_32x32x16_bf16 v[112:127], v[188:191], a[228:231], v[112:127]
    s_cbranch_vccnz B_r1
B_r1_ok:
    v_exp_f32 v148, v132
    v_exp_f32 v149, v133
    v_exp_f32 v150, v134
    v_exp_f32 v151, v135
    v_cvt_pk_bf16_f32 v168, v144, v145
    v_cvt_pk_bf16_f32 v169, v146, v147
    v_mfma_f32_32x32x16_bf16 v[48:63], v[216:219], v[160:163], v[48:63]
    s_waitcnt lgkmcnt(0)
    buffer_load_dwordx4 v[200:203], v1, s[44:47], s48 offen offset:0 sc1
    v_exp_f32 v152, v136
    v_exp_f32 v153, v137
    v_exp_f32 v154, v138
    v_exp_f32 v155, v139
    v_cvt_pk_bf16_f32 v170, v148, v149
    v_cvt_pk_bf16_f32 v171, v150, v151
    v_mfma_f32_32x32x16_bf16 v[48:63], v[220:223], v[164:167], v[48:63]
    s_add_u32 s54, s54, 25088
    buffer_load_dwordx4 v[204:207], v1, s[44:47], s48 offen offset:1024 sc1
    v_exp_f32 v156, v140
    v_exp_f32 v157, v141
    v_exp_f32 v158, v142
    v_exp_f32 v159, v143
    v_cvt_pk_bf16_f32 v172, v152, v153
    v_cvt_pk_bf16_f32 v173, v154, v155
    v_mfma_f32_32x32x16_bf16 v[128:143], v[184:187], a[232:235], 0
    s_waitcnt vmcnt(17)
    ds_read_b64_tr_b16 a[16:17], v4 offset:4096
    ds_read_b64_tr_b16 a[18:19], v4 offset:5120
    ds_read_b64_tr_b16 a[20:21], v5 offset:4096
    v_exp_f32 v144, v112
    v_exp_f32 v145, v113
    v_exp_f32 v146, v114
    v_exp_f32 v147, v115
    v_cvt_pk_bf16_f32 v174, v156, v157
    v_cvt_pk_bf16_f32 v175, v158, v159
    v_mfma_f32_32x32x16_bf16 v[128:143], v[188:191], a[236:239], v[128:143]
    buffer_load_dwordx4 v[32:35], v1, s[44:47], s48 offen offset:2048 sc1
    v_exp_f32 v148, v116
    v_exp_f32 v149, v117
    v_exp_f32 v150, v118
    v_exp_f32 v151, v119
    v_cvt_pk_bf16_f32 v160, v144, v145
    v_cvt_pk_bf16_f32 v161, v146, v147
    v_mfma_f32_32x32x16_bf16 v[64:79], v[216:219], v[168:171], v[64:79]
    buffer_load_dwordx4 v[36:39], v1, s[44:47], s48 offen offset:3072 sc1
    v_exp_f32 v152, v120
    v_exp_f32 v153, v121
    v_exp_f32 v154, v122
    v_exp_f32 v155, v123
    v_cvt_pk_bf16_f32 v162, v148, v149
    v_cvt_pk_bf16_f32 v163, v150, v151
    v_mfma_f32_32x32x16_bf16 v[64:79], v[220:223], v[172:175], v[64:79]
    s_add_u32 s48, s48, 0x4000
    ds_read_b64_tr_b16 a[22:23], v5 offset:5120
    ds_read_b64_tr_b16 a[24:25], v4 offset:6144
    ds_read_b64_tr_b16 a[26:27], v4 offset:7168
    v_exp_f32 v156, v124
    v_exp_f32 v157, v125
    v_exp_f32 v158, v126
    v_exp_f32 v159, v127
    v_cvt_pk_bf16_f32 v164, v152, v153
    v_cvt_pk_bf16_f32 v165, v154, v155
    v_mfma_f32_32x32x16_bf16 v[112:127], v[192:195], a[208:211], 0
    s_bitset0_b32 s48, 18
    buffer_store_dwordx4 v[8:11], v1, s[8:11], s50 offen offset:1024 sc1
    v_exp_f32 v144, v128
    v_exp_f32 v145, v129
    v_exp_f32 v146, v130
    v_exp_f32 v147, v131
    v_cvt_pk_bf16_f32 v166, v156, v157
    v_cvt_pk_bf16_f32 v167, v158, v159
    v_mfma_f32_32x32x16_bf16 v[112:127], v[196:199], a[212:215], v[112:127]
    buffer_load_dwordx4 v[16:19], v1, s[44:47], s48 offen offset:0 sc1
    v_exp_f32 v148, v132
    v_exp_f32 v149, v133
    v_exp_f32 v150, v134
    v_exp_f32 v151, v135
    v_cvt_pk_bf16_f32 v168, v144, v145
    v_cvt_pk_bf16_f32 v169, v146, v147
    v_mfma_f32_32x32x16_bf16 v[80:95], v[216:219], v[160:163], v[80:95]
    ds_read_b64_tr_b16 a[28:29], v5 offset:6144
    ds_read_b64_tr_b16 a[30:31], v5 offset:7168
    v_exp_f32 v152, v136
    v_exp_f32 v153, v137
    v_exp_f32 v154, v138
    v_exp_f32 v155, v139
    v_cvt_pk_bf16_f32 v170, v148, v149
    v_cvt_pk_bf16_f32 v171, v150, v151
    v_mfma_f32_32x32x16_bf16 v[80:95], v[220:223], v[164:167], v[80:95]
    buffer_load_dwordx4 v[20:23], v1, s[44:47], s48 offen offset:1024 sc1
    v_exp_f32 v156, v140
    v_exp_f32 v157, v141
    v_exp_f32 v158, v142
    v_exp_f32 v159, v143
    v_cvt_pk_bf16_f32 v172, v152, v153
    v_cvt_pk_bf16_f32 v173, v154, v155
    v_mfma_f32_32x32x16_bf16 v[128:143], v[192:195], a[216:219], 0
    s_waitcnt lgkmcnt(0)
    buffer_load_dwordx4 v[40:43], v1, s[44:47], s48 offen offset:2048 sc1
    v_exp_f32 v144, v112
    v_exp_f32 v145, v113
    v_exp_f32 v146, v114
    v_exp_f32 v147, v115
    v_cvt_pk_bf16_f32 v174, v156, v157
    v_cvt_pk_bf16_f32 v175, v158, v159
    v_mfma_f32_32x32x16_bf16 v[128:143], v[196:199], a[220:223], v[128:143]
    v_exp_f32 v148, v116
    v_exp_f32 v149, v117
    v_exp_f32 v150, v118
    v_exp_f32 v151, v119
    v_cvt_pk_bf16_f32 v160, v144, v145
    v_cvt_pk_bf16_f32 v161, v146, v147
    v_mfma_f32_32x32x16_bf16 v[96:111], v[216:219], v[168:171], v[96:111]
    buffer_load_dwordx4 v[44:47], v1, s[44:47], s48 offen offset:3072 sc1
    v_exp_f32 v152, v120
    v_exp_f32 v153, v121
    v_exp_f32 v154, v122
    v_exp_f32 v155, v123
    v_cvt_pk_bf16_f32 v162, v148, v149
    v_cvt_pk_bf16_f32 v163, v150, v151
    v_mfma_f32_32x32x16_bf16 v[96:111], v[220:223], v[172:175], v[96:111]
    s_add_u32 m0, s56, 0
    s_nop 0
    buffer_load_dwordx4 v2, s[16:19], s54 offen offset:0 lds
    v_exp_f32 v156, v124
    v_exp_f32 v157, v125
    v_exp_f32 v158, v126
    v_exp_f32 v159, v127
    v_cvt_pk_bf16_f32 v164, v152, v153
    v_cvt_pk_bf16_f32 v165, v154, v155
    v_mfma_f32_32x32x16_bf16 v[112:127], v[192:195], a[224:227], 0
    s_waitcnt vmcnt(9)
    v_max3_u32 v7, v224, v228, v200
    s_waitcnt vmcnt(8)
    v_max_u32 v7, v204, v7
    v_cmp_eq_u32 vcc, -1, v7
    v_exp_f32 v144, v128
    v_exp_f32 v145, v129
    v_exp_f32 v146, v130
    v_exp_f32 v147, v131
    v_cvt_pk_bf16_f32 v166, v156, v157
    v_cvt_pk_bf16_f32 v167, v158, v159
    v_mfma_f32_32x32x16_bf16 v[112:127], v[196:199], a[228:231], v[112:127]
    s_cbranch_vccnz B_r2
B_r2_ok:
    v_exp_f32 v148, v132
    v_exp_f32 v149, v133
    v_exp_f32 v150, v134
    v_exp_f32 v151, v135
    v_cvt_pk_bf16_f32 v168, v144, v145
    v_cvt_pk_bf16_f32 v169, v146, v147
    v_mfma_f32_32x32x16_bf16 v[48:63], v[224:227], v[160:163], v[48:63]
    s_add_u32 s48, s48, 0x4000
    buffer_load_dwordx4 v13, s[16:19], s54 offen offset:1024 lds
    v_exp_f32 v152, v136
    v_exp_f32 v153, v137
    v_exp_f32 v154, v138
    v_exp_f32 v155, v139
    v_cvt_pk_bf16_f32 v170, v148, v149
    v_cvt_pk_bf16_f32 v171, v150, v151
    v_mfma_f32_32x32x16_bf16 v[48:63], v[228:231], v[164:167], v[48:63]
    s_bitset0_b32 s48, 18
    buffer_load_dwordx4 v14, s[16:19], s54 offen offset:2048 lds
    v_exp_f32 v156, v140
    v_exp_f32 v157, v141
    v_exp_f32 v158, v142
    v_exp_f32 v159, v143
    v_cvt_pk_bf16_f32 v172, v152, v153
    v_cvt_pk_bf16_f32 v173, v154, v155
    v_mfma_f32_32x32x16_bf16 v[128:143], v[192:195], a[232:235], 0
    s_waitcnt vmcnt(12)
    ds_read_b64_tr_b16 a[32:33], v4 offset:8192
    ds_read_b64_tr_b16 a[34:35], v4 offset:9216
    ds_read_b64_tr_b16 a[36:37], v5 offset:8192
    v_exp_f32 v144, v112
    v_exp_f32 v145, v113
    v_exp_f32 v146, v114
    v_exp_f32 v147, v115
    v_cvt_pk_bf16_f32 v174, v156, v157
    v_cvt_pk_bf16_f32 v175, v158, v159
    v_mfma_f32_32x32x16_bf16 v[128:143], v[196:199], a[236:239], v[128:143]
    buffer_store_dwordx4 v[8:11], v1, s[8:11], s57 offen offset:0 sc1
    v_exp_f32 v148, v116
    v_exp_f32 v149, v117
    v_exp_f32 v150, v118
    v_exp_f32 v151, v119
    v_cvt_pk_bf16_f32 v160, v144, v145
    v_cvt_pk_bf16_f32 v161, v146, v147
    v_mfma_f32_32x32x16_bf16 v[64:79], v[224:227], v[168:171], v[64:79]
    buffer_load_dwordx4 v[24:27], v1, s[44:47], s48 offen offset:0 sc1
    v_exp_f32 v152, v120
    v_exp_f32 v153, v121
    v_exp_f32 v154, v122
    v_exp_f32 v155, v123
    v_cvt_pk_bf16_f32 v162, v148, v149
    v_cvt_pk_bf16_f32 v163, v150, v151
    v_mfma_f32_32x32x16_bf16 v[64:79], v[228:231], v[172:175], v[64:79]
    ds_read_b64_tr_b16 a[38:39], v5 offset:9216
    ds_read_b64_tr_b16 a[40:41], v4 offset:10240
    ds_read_b64_tr_b16 a[42:43], v4 offset:11264
    v_exp_f32 v156, v124
    v_exp_f32 v157, v125
    v_exp_f32 v158, v126
    v_exp_f32 v159, v127
    v_cvt_pk_bf16_f32 v164, v152, v153
    v_cvt_pk_bf16_f32 v165, v154, v155
    v_mfma_f32_32x32x16_bf16 v[112:127], v[200:203], a[208:211], 0
    buffer_load_dwordx4 v[28:31], v1, s[44:47], s48 offen offset:1024 sc1
    v_exp_f32 v144, v128
    v_exp_f32 v145, v129
    v_exp_f32 v146, v130
    v_exp_f32 v147, v131
    v_cvt_pk_bf16_f32 v166, v156, v157
    v_cvt_pk_bf16_f32 v167, v158, v159
    v_mfma_f32_32x32x16_bf16 v[112:127], v[204:207], a[212:215], v[112:127]
    buffer_load_dwordx4 v15, s[16:19], s54 offen offset:3072 lds
    v_exp_f32 v148, v132
    v_exp_f32 v149, v133
    v_exp_f32 v150, v134
    v_exp_f32 v151, v135
    v_cvt_pk_bf16_f32 v168, v144, v145
    v_cvt_pk_bf16_f32 v169, v146, v147
    v_mfma_f32_32x32x16_bf16 v[80:95], v[224:227], v[160:163], v[80:95]
    s_add_u32 s52, s74, 458752
    ds_read_b64_tr_b16 a[44:45], v5 offset:10240
    ds_read_b64_tr_b16 a[46:47], v5 offset:11264
    v_exp_f32 v152, v136
    v_exp_f32 v153, v137
    v_exp_f32 v154, v138
    v_exp_f32 v155, v139
    v_cvt_pk_bf16_f32 v170, v148, v149
    v_cvt_pk_bf16_f32 v171, v150, v151
    v_mfma_f32_32x32x16_bf16 v[80:95], v[228:231], v[164:167], v[80:95]
    s_add_u32 m0, s56, 16384
    s_nop 0
    buffer_load_dwordx4 v2, s[24:27], s74 offen offset:0 lds
    v_exp_f32 v156, v140
    v_exp_f32 v157, v141
    v_exp_f32 v158, v142
    v_exp_f32 v159, v143
    v_cvt_pk_bf16_f32 v172, v152, v153
    v_cvt_pk_bf16_f32 v173, v154, v155
    v_mfma_f32_32x32x16_bf16 v[128:143], v[200:203], a[216:219], 0
    s_waitcnt lgkmcnt(0)
    buffer_load_dwordx4 v[244:247], v1, s[44:47], s48 offen offset:2048 sc1
    v_exp_f32 v144, v112
    v_exp_f32 v145, v113
    v_exp_f32 v146, v114
    v_exp_f32 v147, v115
    v_cvt_pk_bf16_f32 v174, v156, v157
    v_cvt_pk_bf16_f32 v175, v158, v159
    v_mfma_f32_32x32x16_bf16 v[128:143], v[204:207], a[220:223], v[128:143]
    s_cmp_ge_u32 s52, 1605632
    s_cselect_b32 s75, 1576960, 0
    v_exp_f32 v148, v116
    v_exp_f32 v149, v117
    v_exp_f32 v150, v118
    v_exp_f32 v151, v119
    v_cvt_pk_bf16_f32 v160, v144, v145
    v_cvt_pk_bf16_f32 v161, v146, v147
    v_mfma_f32_32x32x16_bf16 v[96:111], v[224:227], v[168:171], v[96:111]
    s_sub_u32 s52, s52, s75
    buffer_load_dwordx4 v[248:251], v1, s[44:47], s48 offen offset:3072 sc1
    v_exp_f32 v152, v120
    v_exp_f32 v153, v121
    v_exp_f32 v154, v122
    v_exp_f32 v155, v123
    v_cvt_pk_bf16_f32 v162, v148, v149
    v_cvt_pk_bf16_f32 v163, v150, v151
    v_mfma_f32_32x32x16_bf16 v[96:111], v[228:231], v[172:175], v[96:111]
    s_add_u32 s48, s48, 0x4000
    buffer_load_dwordx4 v13, s[24:27], s74 offen offset:1024 lds
    v_exp_f32 v156, v124
    v_exp_f32 v157, v125
    v_exp_f32 v158, v126
    v_exp_f32 v159, v127
    v_cvt_pk_bf16_f32 v164, v152, v153
    v_cvt_pk_bf16_f32 v165, v154, v155
    v_mfma_f32_32x32x16_bf16 v[112:127], v[200:203], a[224:227], 0
    s_waitcnt vmcnt(14)
    v_max3_u32 v7, v32, v36, v16
    s_waitcnt vmcnt(13)
    v_max_u32 v7, v20, v7
    v_cmp_eq_u32 vcc, -1, v7
    v_exp_f32 v144, v128
    v_exp_f32 v145, v129
    v_exp_f32 v146, v130
    v_exp_f32 v147, v131
    v_cvt_pk_bf16_f32 v166, v156, v157
    v_cvt_pk_bf16_f32 v167, v158, v159
    v_mfma_f32_32x32x16_bf16 v[112:127], v[204:207], a[228:231], v[112:127]
    s_cbranch_vccnz B_r3
B_r3_ok:
    v_exp_f32 v148, v132
    v_exp_f32 v149, v133
    v_exp_f32 v150, v134
    v_exp_f32 v151, v135
    v_cvt_pk_bf16_f32 v168, v144, v145
    v_cvt_pk_bf16_f32 v169, v146, v147
    v_mfma_f32_32x32x16_bf16 v[48:63], v[32:35], v[160:163], v[48:63]
    s_bitset0_b32 s48, 18
    buffer_store_dwordx4 v[8:11], v1, s[8:11], s68 offen offset:0 sc1
    v_exp_f32 v152, v136
    v_exp_f32 v153, v137
    v_exp_f32 v154, v138
    v_exp_f32 v155, v139
    v_cvt_pk_bf16_f32 v170, v148, v149
    v_cvt_pk_bf16_f32 v171, v150, v151
    v_mfma_f32_32x32x16_bf16 v[48:63], v[36:39], v[164:167], v[48:63]
    buffer_load_dwordx4 v[176:179], v1, s[44:47], s48 offen offset:0 sc1
    v_exp_f32 v156, v140
    v_exp_f32 v157, v141
    v_exp_f32 v158, v142
    v_exp_f32 v159, v143
    v_cvt_pk_bf16_f32 v172, v152, v153
    v_cvt_pk_bf16_f32 v173, v154, v155
    v_mfma_f32_32x32x16_bf16 v[128:143], v[200:203], a[232:235], 0
    v_exp_f32 v144, v112
    v_exp_f32 v145, v113
    v_exp_f32 v146, v114
    v_exp_f32 v147, v115
    v_cvt_pk_bf16_f32 v174, v156, v157
    v_cvt_pk_bf16_f32 v175, v158, v159
    v_mfma_f32_32x32x16_bf16 v[128:143], v[204:207], a[236:239], v[128:143]
    buffer_load_dwordx4 v[180:183], v1, s[44:47], s48 offen offset:1024 sc1
    v_exp_f32 v148, v116
    v_exp_f32 v149, v117
    v_exp_f32 v150, v118
    v_exp_f32 v151, v119
    v_cvt_pk_bf16_f32 v160, v144, v145
    v_cvt_pk_bf16_f32 v161, v146, v147
    v_mfma_f32_32x32x16_bf16 v[64:79], v[32:35], v[168:171], v[64:79]
    buffer_load_dwordx4 v14, s[24:27], s74 offen offset:2048 lds
    v_exp_f32 v152, v120
    v_exp_f32 v153, v121
    v_exp_f32 v154, v122
    v_exp_f32 v155, v123
    v_cvt_pk_bf16_f32 v162, v148, v149
    v_cvt_pk_bf16_f32 v163, v150, v151
    v_mfma_f32_32x32x16_bf16 v[64:79], v[36:39], v[172:175], v[64:79]
    v_exp_f32 v156, v124
    v_exp_f32 v157, v125
    v_exp_f32 v158, v126
    v_exp_f32 v159, v127
    v_cvt_pk_bf16_f32 v164, v152, v153
    v_cvt_pk_bf16_f32 v165, v154, v155
    v_mfma_f32_32x32x16_bf16 v[112:127], v[16:19], a[208:211], 0
    buffer_load_dwordx4 v15, s[24:27], s74 offen offset:3072 lds
    v_exp_f32 v144, v128
    v_exp_f32 v145, v129
    v_exp_f32 v146, v130
    v_exp_f32 v147, v131
    v_cvt_pk_bf16_f32 v166, v156, v157
    v_cvt_pk_bf16_f32 v167, v158, v159
    v_mfma_f32_32x32x16_bf16 v[112:127], v[20:23], a[212:215], v[112:127]
    s_add_u32 m0, s56, 32768
    s_nop 0
    buffer_load_dwordx4 v2, s[24:27], s52 offen offset:0 lds
    v_exp_f32 v148, v132
    v_exp_f32 v149, v133
    v_exp_f32 v150, v134
    v_exp_f32 v151, v135
    v_cvt_pk_bf16_f32 v168, v144, v145
    v_cvt_pk_bf16_f32 v169, v146, v147
    v_mfma_f32_32x32x16_bf16 v[80:95], v[32:35], v[160:163], v[80:95]
    s_add_u32 s74, s52, 458752
    v_exp_f32 v152, v136
    v_exp_f32 v153, v137
    v_exp_f32 v154, v138
    v_exp_f32 v155, v139
    v_cvt_pk_bf16_f32 v170, v148, v149
    v_cvt_pk_bf16_f32 v171, v150, v151
    v_mfma_f32_32x32x16_bf16 v[80:95], v[36:39], v[164:167], v[80:95]
    s_cmp_ge_u32 s74, 1605632
    s_cselect_b32 s75, 1576960, 0
    buffer_load_dwordx4 v13, s[24:27], s52 offen offset:1024 lds
    v_exp_f32 v156, v140
    v_exp_f32 v157, v141
    v_exp_f32 v158, v142
    v_exp_f32 v159, v143
    v_cvt_pk_bf16_f32 v172, v152, v153
    v_cvt_pk_bf16_f32 v173, v154, v155
    v_mfma_f32_32x32x16_bf16 v[128:143], v[16:19], a[216:219], 0
    s_sub_u32 s74, s74, s75
    buffer_load_dwordx4 v[208:211], v1, s[44:47], s48 offen offset:2048 sc1
    v_exp_f32 v144, v112
    v_exp_f32 v145, v113
    v_exp_f32 v146, v114
    v_exp_f32 v147, v115
    v_cvt_pk_bf16_f32 v174, v156, v157
    v_cvt_pk_bf16_f32 v175, v158, v159
    v_mfma_f32_32x32x16_bf16 v[128:143], v[20:23], a[220:223], v[128:143]
    v_exp_f32 v148, v116
    v_exp_f32 v149, v117
    v_exp_f32 v150, v118
    v_exp_f32 v151, v119
    v_cvt_pk_bf16_f32 v160, v144, v145
    v_cvt_pk_bf16_f32 v161, v146, v147
    v_mfma_f32_32x32x16_bf16 v[96:111], v[32:35], v[168:171], v[96:111]
    buffer_store_dwordx4 v[8:11], v1, s[8:11], s58 offen offset:0 sc1
    v_exp_f32 v152, v120
    v_exp_f32 v153, v121
    v_exp_f32 v154, v122
    v_exp_f32 v155, v123
    v_cvt_pk_bf16_f32 v162, v148, v149
    v_cvt_pk_bf16_f32 v163, v150, v151
    v_mfma_f32_32x32x16_bf16 v[96:111], v[36:39], v[172:175], v[96:111]
    buffer_load_dwordx4 v[212:215], v1, s[44:47], s48 offen offset:3072 sc1
    v_exp_f32 v156, v124
    v_exp_f32 v157, v125
    v_exp_f32 v158, v126
    v_exp_f32 v159, v127
    v_cvt_pk_bf16_f32 v164, v152, v153
    v_cvt_pk_bf16_f32 v165, v154, v155
    v_mfma_f32_32x32x16_bf16 v[112:127], v[16:19], a[224:227], 0
    s_waitcnt vmcnt(16)
    v_max3_u32 v7, v40, v44, v24
    s_waitcnt vmcnt(15)
    v_max_u32 v7, v28, v7
    v_cmp_eq_u32 vcc, -1, v7
    v_exp_f32 v144, v128
    v_exp_f32 v145, v129
    v_exp_f32 v146, v130
    v_exp_f32 v147, v131
    v_cvt_pk_bf16_f32 v166, v156, v157
    v_cvt_pk_bf16_f32 v167, v158, v159
    v_mfma_f32_32x32x16_bf16 v[112:127], v[20:23], a[228:231], v[112:127]
    s_cbranch_vccnz B_r4
B_r4_ok:
    v_exp_f32 v148, v132
    v_exp_f32 v149, v133
    v_exp_f32 v150, v134
    v_exp_f32 v151, v135
    v_cvt_pk_bf16_f32 v168, v144, v145
    v_cvt_pk_bf16_f32 v169, v146, v147
    v_mfma_f32_32x32x16_bf16 v[48:63], v[40:43], v[160:163], v[48:63]
    s_add_u32 s48, s48, 0x4000
    buffer_load_dwordx4 v14, s[24:27], s52 offen offset:2048 lds
    v_exp_f32 v152, v136
    v_exp_f32 v153, v137
    v_exp_f32 v154, v138
    v_exp_f32 v155, v139
    v_cvt_pk_bf16_f32 v170, v148, v149
    v_cvt_pk_bf16_f32 v171, v150, v151
    v_mfma_f32_32x32x16_bf16 v[48:63], v[44:47], v[164:167], v[48:63]
    s_bitset0_b32 s48, 18
    buffer_load_dwordx4 v15, s[24:27], s52 offen offset:3072 lds
    v_exp_f32 v156, v140
    v_exp_f32 v157, v141
    v_exp_f32 v158, v142
    v_exp_f32 v159, v143
    v_cvt_pk_bf16_f32 v172, v152, v153
    v_cvt_pk_bf16_f32 v173, v154, v155
    v_mfma_f32_32x32x16_bf16 v[128:143], v[16:19], a[232:235], 0
    s_waitcnt vmcnt(16)
    ds_read_b64_tr_b16 a[48:49], v242 offset:0
    ds_read_b64_tr_b16 a[50:51], v242 offset:1024
    ds_read_b64_tr_b16 a[52:53], v243 offset:0
    v_exp_f32 v144, v112
    v_exp_f32 v145, v113
    v_exp_f32 v146, v114
    v_exp_f32 v147, v115
    v_cvt_pk_bf16_f32 v174, v156, v157
    v_cvt_pk_bf16_f32 v175, v158, v159
    v_mfma_f32_32x32x16_bf16 v[128:143], v[20:23], a[236:239], v[128:143]
    s_add_u32 s52, s74, 458752
    buffer_load_dwordx4 v[184:187], v1, s[44:47], s48 offen offset:0 sc1
    v_exp_f32 v148, v116
    v_exp_f32 v149, v117
    v_exp_f32 v150, v118
    v_exp_f32 v151, v119
    v_cvt_pk_bf16_f32 v160, v144, v145
    v_cvt_pk_bf16_f32 v161, v146, v147
    v_mfma_f32_32x32x16_bf16 v[64:79], v[40:43], v[168:171], v[64:79]
    s_cmp_ge_u32 s52, 1605632
    s_cselect_b32 s75, 1576960, 0
    buffer_load_dwordx4 v[188:191], v1, s[44:47], s48 offen offset:1024 sc1
    v_exp_f32 v152, v120
    v_exp_f32 v153, v121
    v_exp_f32 v154, v122
    v_exp_f32 v155, v123
    v_cvt_pk_bf16_f32 v162, v148, v149
    v_cvt_pk_bf16_f32 v163, v150, v151
    v_mfma_f32_32x32x16_bf16 v[64:79], v[44:47], v[172:175], v[64:79]
    s_sub_u32 s52, s52, s75
    ds_read_b64_tr_b16 a[54:55], v243 offset:1024
    ds_read_b64_tr_b16 a[56:57], v242 offset:2048
    ds_read_b64_tr_b16 a[58:59], v242 offset:3072
    v_exp_f32 v156, v124
    v_exp_f32 v157, v125
    v_exp_f32 v158, v126
    v_exp_f32 v159, v127
    v_cvt_pk_bf16_f32 v164, v152, v153
    v_cvt_pk_bf16_f32 v165, v154, v155
    v_mfma_f32_32x32x16_bf16 v[112:127], v[24:27], a[208:211], 0
    s_add_u32 m0, s51, 0
    s_nop 0
    buffer_load_dwordx4 v2, s[24:27], s74 offen offset:0 lds
    v_exp_f32 v144, v128
    v_exp_f32 v145, v129
    v_exp_f32 v146, v130
    v_exp_f32 v147, v131
    v_cvt_pk_bf16_f32 v166, v156, v157
    v_cvt_pk_bf16_f32 v167, v158, v159
    v_mfma_f32_32x32x16_bf16 v[112:127], v[28:31], a[212:215], v[112:127]
    buffer_load_dwordx4 v13, s[24:27], s74 offen offset:1024 lds
    v_exp_f32 v148, v132
    v_exp_f32 v149, v133
    v_exp_f32 v150, v134
    v_exp_f32 v151, v135
    v_cvt_pk_bf16_f32 v168, v144, v145
    v_cvt_pk_bf16_f32 v169, v146, v147
    v_mfma_f32_32x32x16_bf16 v[80:95], v[40:43], v[160:163], v[80:95]
    ds_read_b64_tr_b16 a[60:61], v243 offset:2048
    ds_read_b64_tr_b16 a[62:63], v243 offset:3072
    v_exp_f32 v152, v136
    v_exp_f32 v153, v137
    v_exp_f32 v154, v138
    v_exp_f32 v155, v139
    v_cvt_pk_bf16_f32 v170, v148, v149
    v_cvt_pk_bf16_f32 v171, v150, v151
    v_mfma_f32_32x32x16_bf16 v[80:95], v[44:47], v[164:167], v[80:95]
    buffer_store_dwordx4 v[8:11], v1, s[8:11], s58 offen offset:1024 sc1
    v_exp_f32 v156, v140
    v_exp_f32 v157, v141
    v_exp_f32 v158, v142
    v_exp_f32 v159, v143
    v_cvt_pk_bf16_f32 v172, v152, v153
    v_cvt_pk_bf16_f32 v173, v154, v155
    v_mfma_f32_32x32x16_bf16 v[128:143], v[24:27], a[216:219], 0
    s_waitcnt lgkmcnt(0)
    buffer_load_dwordx4 v[216:219], v1, s[44:47], s48 offen offset:2048 sc1
    v_exp_f32 v144, v112
    v_exp_f32 v145, v113
    v_exp_f32 v146, v114
    v_exp_f32 v147, v115
    v_cvt_pk_bf16_f32 v174, v156, v157
    v_cvt_pk_bf16_f32 v175, v158, v159
    v_mfma_f32_32x32x16_bf16 v[128:143], v[28:31], a[220:223], v[128:143]
    v_exp_f32 v148, v116
    v_exp_f32 v149, v117
    v_exp_f32 v150, v118
    v_exp_f32 v151, v119
    v_cvt_pk_bf16_f32 v160, v144, v145
    v_cvt_pk_bf16_f32 v161, v146, v147
    v_mfma_f32_32x32x16_bf16 v[96:111], v[40:43], v[168:171], v[96:111]
    buffer_load_dwordx4 v[220:223], v1, s[44:47], s48 offen offset:3072 sc1
    v_exp_f32 v152, v120
    v_exp_f32 v153, v121
    v_exp_f32 v154, v122
    v_exp_f32 v155, v123
    v_cvt_pk_bf16_f32 v162, v148, v149
    v_cvt_pk_bf16_f32 v163, v150, v151
    v_mfma_f32_32x32x16_bf16 v[96:111], v[44:47], v[172:175], v[96:111]
    s_add_u32 s48, s48, 0x4000
    buffer_load_dwordx4 v14, s[24:27], s74 offen offset:2048 lds
    v_exp_f32 v156, v124
    v_exp_f32 v157, v125
    v_exp_f32 v158, v126
    v_exp_f32 v159, v127
    v_cvt_pk_bf16_f32 v164, v152, v153
    v_cvt_pk_bf16_f32 v165, v154, v155
    v_mfma_f32_32x32x16_bf16 v[112:127], v[24:27], a[224:227], 0
    s_waitcnt vmcnt(18)
    v_max3_u32 v7, v244, v248, v176
    s_waitcnt vmcnt(17)
    v_max_u32 v7, v180, v7
    v_cmp_eq_u32 vcc, -1, v7
    v_exp_f32 v144, v128
    v_exp_f32 v145, v129
    v_exp_f32 v146, v130
    v_exp_f32 v147, v131
    v_cvt_pk_bf16_f32 v166, v156, v157
    v_cvt_pk_bf16_f32 v167, v158, v159
    v_mfma_f32_32x32x16_bf16 v[112:127], v[28:31], a[228:231], v[112:127]
    s_cbranch_vccnz B_r5
B_r5_ok:
    v_exp_f32 v148, v132
    v_exp_f32 v149, v133
    v_exp_f32 v150, v134
    v_exp_f32 v151, v135
    v_cvt_pk_bf16_f32 v168, v144, v145
    v_cvt_pk_bf16_f32 v169, v146, v147
    v_mfma_f32_32x32x16_bf16 v[48:63], v[244:247], v[160:163], v[48:63]
    s_bitset0_b32 s48, 18
    buffer_load_dwordx4 v15, s[24:27], s74 offen offset:3072 lds
    v_exp_f32 v152, v136
    v_exp_f32 v153, v137
    v_exp_f32 v154, v138
    v_exp_f32 v155, v139
    v_cvt_pk_bf16_f32 v170, v148, v149
    v_cvt_pk_bf16_f32 v171, v150, v151
    v_mfma_f32_32x32x16_bf16 v[48:63], v[248:251], v[164:167], v[48:63]
    s_add_u32 s74, s52, 458752
    buffer_load_dwordx4 v[192:195], v1, s[44:47], s48 offen offset:0 sc1
    v_exp_f32 v156, v140
    v_exp_f32 v157, v141
    v_exp_f32 v158, v142
    v_exp_f32 v159, v143
    v_cvt_pk_bf16_f32 v172, v152, v153
    v_cvt_pk_bf16_f32 v173, v154, v155
    v_mfma_f32_32x32x16_bf16 v[128:143], v[24:27], a[232:235], 0
    s_waitcnt vmcnt(17)
    ds_read_b64_tr_b16 a[64:65], v242 offset:16384
    ds_read_b64_tr_b16 a[66:67], v242 offset:17408
    ds_read_b64_tr_b16 a[68:69], v243 offset:16384
    v_exp_f32 v144, v112
    v_exp_f32 v145, v113
    v_exp_f32 v146, v114
    v_exp_f32 v147, v115
    v_cvt_pk_bf16_f32 v174, v156, v157
    v_cvt_pk_bf16_f32 v175, v158, v159
    v_mfma_f32_32x32x16_bf16 v[128:143], v[28:31], a[236:239], v[128:143]
    s_cmp_ge_u32 s74, 1605632
    s_cselect_b32 s75, 1576960, 0
    buffer_load_dwordx4 v[196:199], v1, s[44:47], s48 offen offset:1024 sc1
    v_exp_f32 v148, v116
    v_exp_f32 v149, v117
    v_exp_f32 v150, v118
    v_exp_f32 v151, v119
    v_cvt_pk_bf16_f32 v160, v144, v145
    v_cvt_pk_bf16_f32 v161, v146, v147
    v_mfma_f32_32x32x16_bf16 v[64:79], v[244:247], v[168:171], v[64:79]
    s_add_u32 m0, s51, 4096
    s_nop 0
    buffer_load_dwordx4 v2, s[24:27], s52 offen offset:0 lds
    v_exp_f32 v152, v120
    v_exp_f32 v153, v121
    v_exp_f32 v154, v122
    v_exp_f32 v155, v123
    v_cvt_pk_bf16_f32 v162, v148, v149
    v_cvt_pk_bf16_f32 v163, v150, v151
    v_mfma_f32_32x32x16_bf16 v[64:79], v[248:251], v[172:175], v[64:79]
    s_sub_u32 s74, s74, s75
    ds_read_b64_tr_b16 a[70:71], v243 offset:17408
    ds_read_b64_tr_b16 a[72:73], v242 offset:18432
    ds_read_b64_tr_b16 a[74:75], v242 offset:19456
    v_exp_f32 v156, v124
    v_exp_f32 v157, v125
    v_exp_f32 v158, v126
    v_exp_f32 v159, v127
    v_cvt_pk_bf16_f32 v164, v152, v153
    v_cvt_pk_bf16_f32 v165, v154, v155
    v_mfma_f32_32x32x16_bf16 v[112:127], v[176:179], a[208:211], 0
    buffer_store_dwordx4 v[8:11], v1, s[8:11], s58 offen offset:2048 sc1
    v_exp_f32 v144, v128
    v_exp_f32 v145, v129
    v_exp_f32 v146, v130
    v_exp_f32 v147, v131
    v_cvt_pk_bf16_f32 v166, v156, v157
    v_cvt_pk_bf16_f32 v167, v158, v159
    v_mfma_f32_32x32x16_bf16 v[112:127], v[180:183], a[212:215], v[112:127]
    buffer_load_dwordx4 v13, s[24:27], s52 offen offset:1024 lds
    v_exp_f32 v148, v132
    v_exp_f32 v149, v133
    v_exp_f32 v150, v134
    v_exp_f32 v151, v135
    v_cvt_pk_bf16_f32 v168, v144, v145
    v_cvt_pk_bf16_f32 v169, v146, v147
    v_mfma_f32_32x32x16_bf16 v[80:95], v[244:247], v[160:163], v[80:95]
    ds_read_b64_tr_b16 a[76:77], v243 offset:18432
    ds_read_b64_tr_b16 a[78:79], v243 offset:19456
    v_exp_f32 v152, v136
    v_exp_f32 v153, v137
    v_exp_f32 v154, v138
    v_exp_f32 v155, v139
    v_cvt_pk_bf16_f32 v170, v148, v149
    v_cvt_pk_bf16_f32 v171, v150, v151
    v_mfma_f32_32x32x16_bf16 v[80:95], v[248:251], v[164:167], v[80:95]
    buffer_load_dwordx4 v14, s[24:27], s52 offen offset:2048 lds
    v_exp_f32 v156, v140
    v_exp_f32 v157, v141
    v_exp_f32 v158, v142
    v_exp_f32 v159, v143
    v_cvt_pk_bf16_f32 v172, v152, v153
    v_cvt_pk_bf16_f32 v173, v154, v155
    v_mfma_f32_32x32x16_bf16 v[128:143], v[176:179], a[216:219], 0
    s_waitcnt lgkmcnt(0)
    buffer_load_dwordx4 v[224:227], v1, s[44:47], s48 offen offset:2048 sc1
    v_exp_f32 v144, v112
    v_exp_f32 v145, v113
    v_exp_f32 v146, v114
    v_exp_f32 v147, v115
    v_cvt_pk_bf16_f32 v174, v156, v157
    v_cvt_pk_bf16_f32 v175, v158, v159
    v_mfma_f32_32x32x16_bf16 v[128:143], v[180:183], a[220:223], v[128:143]
    s_waitcnt vmcnt(16)
    ds_read_b64_tr_b16 a[80:81], v242 offset:32768
    ds_read_b64_tr_b16 a[82:83], v242 offset:33792
    ds_read_b64_tr_b16 a[84:85], v243 offset:32768
    v_exp_f32 v148, v116
    v_exp_f32 v149, v117
    v_exp_f32 v150, v118
    v_exp_f32 v151, v119
    v_cvt_pk_bf16_f32 v160, v144, v145
    v_cvt_pk_bf16_f32 v161, v146, v147
    v_mfma_f32_32x32x16_bf16 v[96:111], v[244:247], v[168:171], v[96:111]
    buffer_load_dwordx4 v[228:231], v1, s[44:47], s48 offen offset:3072 sc1
    v_exp_f32 v152, v120
    v_exp_f32 v153, v121
    v_exp_f32 v154, v122
    v_exp_f32 v155, v123
    v_cvt_pk_bf16_f32 v162, v148, v149
    v_cvt_pk_bf16_f32 v163, v150, v151
    v_mfma_f32_32x32x16_bf16 v[96:111], v[248:251], v[172:175], v[96:111]
    s_add_u32 s48, s48, 0x4000
    buffer_load_dwordx4 v15, s[24:27], s52 offen offset:3072 lds
    v_exp_f32 v156, v124
    v_exp_f32 v157, v125
    v_exp_f32 v158, v126
    v_exp_f32 v159, v127
    v_cvt_pk_bf16_f32 v164, v152, v153
    v_cvt_pk_bf16_f32 v165, v154, v155
    v_mfma_f32_32x32x16_bf16 v[112:127], v[176:179], a[224:227], 0
    s_waitcnt vmcnt(17)
    v_max3_u32 v7, v208, v212, v184
    s_waitcnt vmcnt(16)
    v_max_u32 v7, v188, v7
    v_cmp_eq_u32 vcc, -1, v7
    v_exp_f32 v144, v128
    v_exp_f32 v145, v129
    v_exp_f32 v146, v130
    v_exp_f32 v147, v131
    v_cvt_pk_bf16_f32 v166, v156, v157
    v_cvt_pk_bf16_f32 v167, v158, v159
    v_mfma_f32_32x32x16_bf16 v[112:127], v[180:183], a[228:231], v[112:127]
    s_cbranch_vccnz B_r6
B_r6_ok:
    v_exp_f32 v148, v132
    v_exp_f32 v149, v133
    v_exp_f32 v150, v134
    v_exp_f32 v151, v135
    v_cvt_pk_bf16_f32 v168, v144, v145
    v_cvt_pk_bf16_f32 v169, v146, v147
    v_mfma_f32_32x32x16_bf16 v[48:63], v[208:211], v[160:163], v[48:63]
    s_add_u32 m0, s51, 8192
    s_nop 0
    buffer_load_dwordx4 v2, s[24:27], s74 offen offset:0 lds
    v_exp_f32 v152, v136
    v_exp_f32 v153, v137
    v_exp_f32 v154, v138
    v_exp_f32 v155, v139
    v_cvt_pk_bf16_f32 v170, v148, v149
    v_cvt_pk_bf16_f32 v171, v150, v151
    v_mfma_f32_32x32x16_bf16 v[48:63], v[212:215], v[164:167], v[48:63]
    s_bitset0_b32 s48, 18
    buffer_load_dwordx4 v13, s[24:27], s74 offen offset:1024 lds
    v_exp_f32 v156, v140
    v_exp_f32 v157, v141
    v_exp_f32 v158, v142
    v_exp_f32 v159, v143
    v_cvt_pk_bf16_f32 v172, v152, v153
    v_cvt_pk_bf16_f32 v173, v154, v155
    v_mfma_f32_32x32x16_bf16 v[128:143], v[176:179], a[232:235], 0
    s_add_u32 s52, s74, 458752
    ds_read_b64_tr_b16 a[86:87], v243 offset:33792
    ds_read_b64_tr_b16 a[88:89], v242 offset:34816
    ds_read_b64_tr_b16 a[90:91], v242 offset:35840
    v_exp_f32 v144, v112
    v_exp_f32 v145, v113
    v_exp_f32 v146, v114
    v_exp_f32 v147, v115
    v_cvt_pk_bf16_f32 v174, v156, v157
    v_cvt_pk_bf16_f32 v175, v158, v159
    v_mfma_f32_32x32x16_bf16 v[128:143], v[180:183], a[236:239], v[128:143]
    s_waitcnt vmcnt(47)
    buffer_store_dword v255, off, s[8:11], s66 sc1
    v_exp_f32 v148, v116
    v_exp_f32 v149, v117
    v_exp_f32 v150, v118
    v_exp_f32 v151, v119
    v_cvt_pk_bf16_f32 v160, v144, v145
    v_cvt_pk_bf16_f32 v161, v146, v147
    v_mfma_f32_32x32x16_bf16 v[64:79], v[208:211], v[168:171], v[64:79]
    s_cmp_ge_u32 s52, 1605632
    s_cselect_b32 s75, 1576960, 0
    buffer_load_dwordx4 v[200:203], v1, s[44:47], s48 offen offset:0 sc1
    v_exp_f32 v152, v120
    v_exp_f32 v153, v121
    v_exp_f32 v154, v122
    v_exp_f32 v155, v123
    v_cvt_pk_bf16_f32 v162, v148, v149
    v_cvt_pk_bf16_f32 v163, v150, v151
    v_mfma_f32_32x32x16_bf16 v[64:79], v[212:215], v[172:175], v[64:79]
    s_sub_u32 s52, s52, s75
    ds_read_b64_tr_b16 a[92:93], v243 offset:34816
    ds_read_b64_tr_b16 a[94:95], v243 offset:35840
    v_exp_f32 v156, v124
    v_exp_f32 v157, v125
    v_exp_f32 v158, v126
    v_exp_f32 v159, v127
    v_cvt_pk_bf16_f32 v164, v152, v153
    v_cvt_pk_bf16_f32 v165, v154, v155
    v_mfma_f32_32x32x16_bf16 v[112:127], v[184:187], a[208:211], 0
    buffer_load_dwordx4 v[204:207], v1, s[44:47], s48 offen offset:1024 sc1
    v_exp_f32 v144, v128
    v_exp_f32 v145, v129
    v_exp_f32 v146, v130
    v_exp_f32 v147, v131
    v_cvt_pk_bf16_f32 v166, v156, v157
    v_cvt_pk_bf16_f32 v167, v158, v159
    v_mfma_f32_32x32x16_bf16 v[112:127], v[188:191], a[212:215], v[112:127]
    s_waitcnt lgkmcnt(0)
    buffer_load_dwordx4 v14, s[24:27], s74 offen offset:2048 lds
    v_exp_f32 v148, v132
    v_exp_f32 v149, v133
    v_exp_f32 v150, v134
    v_exp_f32 v151, v135
    v_cvt_pk_bf16_f32 v168, v144, v145
    v_cvt_pk_bf16_f32 v169, v146, v147
    v_mfma_f32_32x32x16_bf16 v[80:95], v[208:211], v[160:163], v[80:95]
    s_waitcnt vmcnt(15)
    ds_read_b64_tr_b16 a[96:97], v4 offset:0
    ds_read_b64_tr_b16 a[98:99], v4 offset:1024
    ds_read_b64_tr_b16 a[100:101], v5 offset:0
    v_exp_f32 v152, v136
    v_exp_f32 v153, v137
    v_exp_f32 v154, v138
    v_exp_f32 v155, v139
    v_cvt_pk_bf16_f32 v170, v148, v149
    v_cvt_pk_bf16_f32 v171, v150, v151
    v_mfma_f32_32x32x16_bf16 v[80:95], v[212:215], v[164:167], v[80:95]
    buffer_load_dwordx4 v15, s[24:27], s74 offen offset:3072 lds
    v_exp_f32 v156, v140
    v_exp_f32 v157, v141
    v_exp_f32 v158, v142
    v_exp_f32 v159, v143
    v_cvt_pk_bf16_f32 v172, v152, v153
    v_cvt_pk_bf16_f32 v173, v154, v155
    v_mfma_f32_32x32x16_bf16 v[128:143], v[184:187], a[216:219], 0
    s_add_u32 s74, s52, 458752
    buffer_load_dwordx4 v[32:35], v1, s[44:47], s48 offen offset:2048 sc1
    v_exp_f32 v144, v112
    v_exp_f32 v145, v113
    v_exp_f32 v146, v114
    v_exp_f32 v147, v115
    v_cvt_pk_bf16_f32 v174, v156, v157
    v_cvt_pk_bf16_f32 v175, v158, v159
    v_mfma_f32_32x32x16_bf16 v[128:143], v[188:191], a[220:223], v[128:143]
    s_cmp_ge_u32 s74, 1605632
    s_cselect_b32 s75, 1576960, 0
    ds_read_b64_tr_b16 a[102:103], v5 offset:1024
    ds_read_b64_tr_b16 a[104:105], v4 offset:2048
    ds_read_b64_tr_b16 a[106:107], v4 offset:3072
    v_exp_f32 v148, v116
    v_exp_f32 v149, v117
    v_exp_f32 v150, v118
    v_exp_f32 v151, v119
    v_cvt_pk_bf16_f32 v160, v144, v145
    v_cvt_pk_bf16_f32 v161, v146, v147
    v_mfma_f32_32x32x16_bf16 v[96:111], v[208:211], v[168:171], v[96:111]
    s_sub_u32 s74, s74, s75
    buffer_load_dwordx4 v[36:39], v1, s[44:47], s48 offen offset:3072 sc1
    v_exp_f32 v152, v120
    v_exp_f32 v153, v121
    v_exp_f32 v154, v122
    v_exp_f32 v155, v123
    v_cvt_pk_bf16_f32 v162, v148, v149
    v_cvt_pk_bf16_f32 v163, v150, v151
    v_mfma_f32_32x32x16_bf16 v[96:111], v[212:215], v[172:175], v[96:111]
    s_add_u32 m0, s56, 0
    s_nop 0
    buffer_load_dwordx4 v2, s[24:27], s52 offen offset:0 lds
    v_exp_f32 v156, v124
    v_exp_f32 v157, v125
    v_exp_f32 v158, v126
    v_exp_f32 v159, v127
    v_cvt_pk_bf16_f32 v164, v152, v153
    v_cvt_pk_bf16_f32 v165, v154, v155
    v_mfma_f32_32x32x16_bf16 v[112:127], v[184:187], a[224:227], 0
    s_waitcnt vmcnt(18)
    v_max3_u32 v7, v216, v220, v192
    s_waitcnt vmcnt(17)
    v_max_u32 v7, v196, v7
    v_cmp_eq_u32 vcc, -1, v7
    v_exp_f32 v144, v128
    v_exp_f32 v145, v129
    v_exp_f32 v146, v130
    v_exp_f32 v147, v131
    v_cvt_pk_bf16_f32 v166, v156, v157
    v_cvt_pk_bf16_f32 v167, v158, v159
    v_mfma_f32_32x32x16_bf16 v[112:127], v[188:191], a[228:231], v[112:127]
    s_cbranch_vccnz B_r7
B_r7_ok:
    v_exp_f32 v148, v132
    v_exp_f32 v149, v133
    v_exp_f32 v150, v134
    v_exp_f32 v151, v135
    v_cvt_pk_bf16_f32 v168, v144, v145
    v_cvt_pk_bf16_f32 v169, v146, v147
    v_mfma_f32_32x32x16_bf16 v[48:63], v[216:219], v[160:163], v[48:63]
    s_add_u32 s48, s48, 0x4000
    buffer_store_dwordx2 v[8:9], v12, s[8:11], s59 offen sc1
    v_exp_f32 v152, v136
    v_exp_f32 v153, v137
    v_exp_f32 v154, v138
    v_exp_f32 v155, v139
    v_cvt_pk_bf16_f32 v170, v148, v149
    v_cvt_pk_bf16_f32 v171, v150, v151
    v_mfma_f32_32x32x16_bf16 v[48:63], v[220:223], v[164:167], v[48:63]
    s_bitset0_b32 s48, 18
    buffer_load_dwordx4 v13, s[24:27], s52 offen offset:1024 lds
    v_exp_f32 v156, v140
    v_exp_f32 v157, v141
    v_exp_f32 v158, v142
    v_exp_f32 v159, v143
    v_cvt_pk_bf16_f32 v172, v152, v153
    v_cvt_pk_bf16_f32 v173, v154, v155
    v_mfma_f32_32x32x16_bf16 v[128:143], v[184:187], a[232:235], 0
    ds_read_b64_tr_b16 a[108:109], v5 offset:2048
    ds_read_b64_tr_b16 a[110:111], v5 offset:3072
    v_exp_f32 v144, v112
    v_exp_f32 v145, v113
    v_exp_f32 v146, v114
    v_exp_f32 v147, v115
    v_cvt_pk_bf16_f32 v174, v156, v157
    v_cvt_pk_bf16_f32 v175, v158, v159
    v_mfma_f32_32x32x16_bf16 v[128:143], v[188:191], a[236:239], v[128:143]
    buffer_load_dwordx4 v[16:19], v1, s[44:47], s48 offen offset:0 sc1
    v_exp_f32 v148, v116
    v_exp_f32 v149, v117
    v_exp_f32 v150, v118
    v_exp_f32 v151, v119
    v_cvt_pk_bf16_f32 v160, v144, v145
    v_cvt_pk_bf16_f32 v161, v146, v147
    v_mfma_f32_32x32x16_bf16 v[64:79], v[216:219], v[168:171], v[64:79]
    s_waitcnt lgkmcnt(0)
    buffer_load_dwordx4 v[20:23], v1, s[44:47], s48 offen offset:1024 sc1
    v_exp_f32 v152, v120
    v_exp_f32 v153, v121
    v_exp_f32 v154, v122
    v_exp_f32 v155, v123
    v_cvt_pk_bf16_f32 v162, v148, v149
    v_cvt_pk_bf16_f32 v163, v150, v151
    v_mfma_f32_32x32x16_bf16 v[64:79], v[220:223], v[172:175], v[64:79]
    s_waitcnt vmcnt(14)
    ds_read_b64_tr_b16 a[112:113], v4 offset:4096
    ds_read_b64_tr_b16 a[114:115], v4 offset:5120
    ds_read_b64_tr_b16 a[116:117], v5 offset:4096
    v_exp_f32 v156, v124
    v_exp_f32 v157, v125
    v_exp_f32 v158, v126
    v_exp_f32 v159, v127
    v_cvt_pk_bf16_f32 v164, v152, v153
    v_cvt_pk_bf16_f32 v165, v154, v155
    v_mfma_f32_32x32x16_bf16 v[112:127], v[192:195], a[208:211], 0
    buffer_load_dwordx4 v14, s[24:27], s52 offen offset:2048 lds
    v_exp_f32 v144, v128
    v_exp_f32 v145, v129
    v_exp_f32 v146, v130
    v_exp_f32 v147, v131
    v_cvt_pk_bf16_f32 v166, v156, v157
    v_cvt_pk_bf16_f32 v167, v158, v159
    v_mfma_f32_32x32x16_bf16 v[112:127], v[196:199], a[212:215], v[112:127]
    buffer_load_dwordx4 v15, s[24:27], s52 offen offset:3072 lds
    v_exp_f32 v148, v132
    v_exp_f32 v149, v133
    v_exp_f32 v150, v134
    v_exp_f32 v151, v135
    v_cvt_pk_bf16_f32 v168, v144, v145
    v_cvt_pk_bf16_f32 v169, v146, v147
    v_mfma_f32_32x32x16_bf16 v[80:95], v[216:219], v[160:163], v[80:95]
    s_add_u32 s52, s74, 458752
    ds_read_b64_tr_b16 a[118:119], v5 offset:5120
    ds_read_b64_tr_b16 a[120:121], v4 offset:6144
    ds_read_b64_tr_b16 a[122:123], v4 offset:7168
    v_exp_f32 v152, v136
    v_exp_f32 v153, v137
    v_exp_f32 v154, v138
    v_exp_f32 v155, v139
    v_cvt_pk_bf16_f32 v170, v148, v149
    v_cvt_pk_bf16_f32 v171, v150, v151
    v_mfma_f32_32x32x16_bf16 v[80:95], v[220:223], v[164:167], v[80:95]
    s_add_u32 m0, s56, 16384
    s_nop 0
    buffer_load_dwordx4 v2, s[24:27], s74 offen offset:0 lds
    v_exp_f32 v156, v140
    v_exp_f32 v157, v141
    v_exp_f32 v158, v142
    v_exp_f32 v159, v143
    v_cvt_pk_bf16_f32 v172, v152, v153
    v_cvt_pk_bf16_f32 v173, v154, v155
    v_mfma_f32_32x32x16_bf16 v[128:143], v[192:195], a[216:219], 0
    s_cmp_ge_u32 s52, 1605632
    s_cselect_b32 s75, 1576960, 0
    buffer_load_dwordx4 v[40:43], v1, s[44:47], s48 offen offset:2048 sc1
    v_exp_f32 v144, v112
    v_exp_f32 v145, v113
    v_exp_f32 v146, v114
    v_exp_f32 v147, v115
    v_cvt_pk_bf16_f32 v174, v156, v157
    v_cvt_pk_bf16_f32 v175, v158, v159
    v_mfma_f32_32x32x16_bf16 v[128:143], v[196:199], a[220:223], v[128:143]
    s_sub_u32 s52, s52, s75
    ds_read_b64_tr_b16 a[124:125], v5 offset:6144
    ds_read_b64_tr_b16 a[126:127], v5 offset:7168
    v_exp_f32 v148, v116
    v_exp_f32 v149, v117
    v_exp_f32 v150, v118
    v_exp_f32 v151, v119
    v_cvt_pk_bf16_f32 v160, v144, v145
    v_cvt_pk_bf16_f32 v161, v146, v147
    v_mfma_f32_32x32x16_bf16 v[96:111], v[216:219], v[168:171], v[96:111]
    buffer_store_dwordx4 v[8:11], v1, s[8:11], s58 offen offset:3072 sc1
    v_exp_f32 v152, v120
    v_exp_f32 v153, v121
    v_exp_f32 v154, v122
    v_exp_f32 v155, v123
    v_cvt_pk_bf16_f32 v162, v148, v149
    v_cvt_pk_bf16_f32 v163, v150, v151
    v_mfma_f32_32x32x16_bf16 v[96:111], v[220:223], v[172:175], v[96:111]
    buffer_load_dwordx4 v[44:47], v1, s[44:47], s48 offen offset:3072 sc1
    v_exp_f32 v156, v124
    v_exp_f32 v157, v125
    v_exp_f32 v158, v126
    v_exp_f32 v159, v127
    v_cvt_pk_bf16_f32 v164, v152, v153
    v_cvt_pk_bf16_f32 v165, v154, v155
    v_mfma_f32_32x32x16_bf16 v[112:127], v[192:195], a[224:227], 0
    s_waitcnt vmcnt(16)
    v_max3_u32 v7, v224, v228, v200
    s_waitcnt vmcnt(15)
    v_max_u32 v7, v204, v7
    v_cmp_eq_u32 vcc, -1, v7
    v_exp_f32 v144, v128
    v_exp_f32 v145, v129
    v_exp_f32 v146, v130
    v_exp_f32 v147, v131
    v_cvt_pk_bf16_f32 v166, v156, v157
    v_cvt_pk_bf16_f32 v167, v158, v159
    v_mfma_f32_32x32x16_bf16 v[112:127], v[196:199], a[228:231], v[112:127]
    s_cbranch_vccnz B_r8
B_r8_ok:
    v_exp_f32 v148, v132
    v_exp_f32 v149, v133
    v_exp_f32 v150, v134
    v_exp_f32 v151, v135
    v_cvt_pk_bf16_f32 v168, v144, v145
    v_cvt_pk_bf16_f32 v169, v146, v147
    v_mfma_f32_32x32x16_bf16 v[48:63], v[224:227], v[160:163], v[48:63]
    s_add_u32 s48, s48, 0x4000
    buffer_load_dwordx4 v13, s[24:27], s74 offen offset:1024 lds
    v_exp_f32 v152, v136
    v_exp_f32 v153, v137
    v_exp_f32 v154, v138
    v_exp_f32 v155, v139
    v_cvt_pk_bf16_f32 v170, v148, v149
    v_cvt_pk_bf16_f32 v171, v150, v151
    v_mfma_f32_32x32x16_bf16 v[48:63], v[228:231], v[164:167], v[48:63]
    s_bitset0_b32 s48, 18
    buffer_load_dwordx4 v14, s[24:27], s74 offen offset:2048 lds
    v_exp_f32 v156, v140
    v_exp_f32 v157, v141
    v_exp_f32 v158, v142
    v_exp_f32 v159, v143
    v_cvt_pk_bf16_f32 v172, v152, v153
    v_cvt_pk_bf16_f32 v173, v154, v155
    v_mfma_f32_32x32x16_bf16 v[128:143], v[192:195], a[232:235], 0
    s_waitcnt vmcnt(15)
    ds_read_b64_tr_b16 a[128:129], v4 offset:8192
    ds_read_b64_tr_b16 a[130:131], v4 offset:9216
    ds_read_b64_tr_b16 a[132:133], v5 offset:8192
    v_exp_f32 v144, v112
    v_exp_f32 v145, v113
    v_exp_f32 v146, v114
    v_exp_f32 v147, v115
    v_cvt_pk_bf16_f32 v174, v156, v157
    v_cvt_pk_bf16_f32 v175, v158, v159
    v_mfma_f32_32x32x16_bf16 v[128:143], v[196:199], a[236:239], v[128:143]
    buffer_load_dwordx4 v[24:27], v1, s[44:47], s48 offen offset:0 sc1
    v_exp_f32 v148, v116
    v_exp_f32 v149, v117
    v_exp_f32 v150, v118
    v_exp_f32 v151, v119
    v_cvt_pk_bf16_f32 v160, v144, v145
    v_cvt_pk_bf16_f32 v161, v146, v147
    v_mfma_f32_32x32x16_bf16 v[64:79], v[224:227], v[168:171], v[64:79]
    buffer_load_dwordx4 v[28:31], v1, s[44:47], s48 offen offset:1024 sc1
    v_exp_f32 v152, v120
    v_exp_f32 v153, v121
    v_exp_f32 v154, v122
    v_exp_f32 v155, v123
    v_cvt_pk_bf16_f32 v162, v148, v149
    v_cvt_pk_bf16_f32 v163, v150, v151
    v_mfma_f32_32x32x16_bf16 v[64:79], v[228:231], v[172:175], v[64:79]
    ds_read_b64_tr_b16 a[134:135], v5 offset:9216
    ds_read_b64_tr_b16 a[136:137], v4 offset:10240
    ds_read_b64_tr_b16 a[138:139], v4 offset:11264
    v_exp_f32 v156, v124
    v_exp_f32 v157, v125
    v_exp_f32 v158, v126
    v_exp_f32 v159, v127
    v_cvt_pk_bf16_f32 v164, v152, v153
    v_cvt_pk_bf16_f32 v165, v154, v155
    v_mfma_f32_32x32x16_bf16 v[112:127], v[200:203], a[208:211], 0
    buffer_load_dwordx4 v15, s[24:27], s74 offen offset:3072 lds
    v_exp_f32 v144, v128
    v_exp_f32 v145, v129
    v_exp_f32 v146, v130
    v_exp_f32 v147, v131
    v_cvt_pk_bf16_f32 v166, v156, v157
    v_cvt_pk_bf16_f32 v167, v158, v159
    v_mfma_f32_32x32x16_bf16 v[112:127], v[204:207], a[212:215], v[112:127]
    s_add_u32 m0, s56, 32768
    s_nop 0
    buffer_load_dwordx4 v2, s[24:27], s52 offen offset:0 lds
    v_exp_f32 v148, v132
    v_exp_f32 v149, v133
    v_exp_f32 v150, v134
    v_exp_f32 v151, v135
    v_cvt_pk_bf16_f32 v168, v144, v145
    v_cvt_pk_bf16_f32 v169, v146, v147
    v_mfma_f32_32x32x16_bf16 v[80:95], v[224:227], v[160:163], v[80:95]
    s_add_u32 s74, s52, 458752
    ds_read_b64_tr_b16 a[140:141], v5 offset:10240
    ds_read_b64_tr_b16 a[142:143], v5 offset:11264
    v_exp_f32 v152, v136
    v_exp_f32 v153, v137
    v_exp_f32 v154, v138
    v_exp_f32 v155, v139
    v_cvt_pk_bf16_f32 v170, v148, v149
    v_cvt_pk_bf16_f32 v171, v150, v151
    v_mfma_f32_32x32x16_bf16 v[80:95], v[228:231], v[164:167], v[80:95]
    s_cmp_ge_u32 s74, 1605632
    s_cselect_b32 s75, 1576960, 0
    buffer_store_dwordx4 v[8:11], v1, s[8:11], s69 offen offset:0 sc1
    v_exp_f32 v156, v140
    v_exp_f32 v157, v141
    v_exp_f32 v158, v142
    v_exp_f32 v159, v143
    v_cvt_pk_bf16_f32 v172, v152, v153
    v_cvt_pk_bf16_f32 v173, v154, v155
    v_mfma_f32_32x32x16_bf16 v[128:143], v[200:203], a[216:219], 0
    s_sub_u32 s74, s74, s75
    buffer_load_dwordx4 v[244:247], v1, s[44:47], s48 offen offset:2048 sc1
    v_exp_f32 v144, v112
    v_exp_f32 v145, v113
    v_exp_f32 v146, v114
    v_exp_f32 v147, v115
    v_cvt_pk_bf16_f32 v174, v156, v157
    v_cvt_pk_bf16_f32 v175, v158, v159
    v_mfma_f32_32x32x16_bf16 v[128:143], v[204:207], a[220:223], v[128:143]
    v_exp_f32 v148, v116
    v_exp_f32 v149, v117
    v_exp_f32 v150, v118
    v_exp_f32 v151, v119
    v_cvt_pk_bf16_f32 v160, v144, v145
    v_cvt_pk_bf16_f32 v161, v146, v147
    v_mfma_f32_32x32x16_bf16 v[96:111], v[224:227], v[168:171], v[96:111]
    buffer_load_dwordx4 v[248:251], v1, s[44:47], s48 offen offset:3072 sc1
    v_exp_f32 v152, v120
    v_exp_f32 v153, v121
    v_exp_f32 v154, v122
    v_exp_f32 v155, v123
    v_cvt_pk_bf16_f32 v162, v148, v149
    v_cvt_pk_bf16_f32 v163, v150, v151
    v_mfma_f32_32x32x16_bf16 v[96:111], v[228:231], v[172:175], v[96:111]
    s_add_u32 s48, s48, 0x4000
    buffer_load_dwordx4 v13, s[24:27], s52 offen offset:1024 lds
    v_exp_f32 v156, v124
    v_exp_f32 v157, v125
    v_exp_f32 v158, v126
    v_exp_f32 v159, v127
    v_cvt_pk_bf16_f32 v164, v152, v153
    v_cvt_pk_bf16_f32 v165, v154, v155
    v_mfma_f32_32x32x16_bf16 v[112:127], v[200:203], a[224:227], 0
    s_waitcnt vmcnt(17)
    v_max3_u32 v7, v32, v36, v16
    s_waitcnt vmcnt(16)
    v_max_u32 v7, v20, v7
    v_cmp_eq_u32 vcc, -1, v7
    v_exp_f32 v144, v128
    v_exp_f32 v145, v129
    v_exp_f32 v146, v130
    v_exp_f32 v147, v131
    v_cvt_pk_bf16_f32 v166, v156, v157
    v_cvt_pk_bf16_f32 v167, v158, v159
    v_mfma_f32_32x32x16_bf16 v[112:127], v[204:207], a[228:231], v[112:127]
    s_cbranch_vccnz B_r9
B_r9_ok:
    v_exp_f32 v148, v132
    v_exp_f32 v149, v133
    v_exp_f32 v150, v134
    v_exp_f32 v151, v135
    v_cvt_pk_bf16_f32 v168, v144, v145
    v_cvt_pk_bf16_f32 v169, v146, v147
    v_mfma_f32_32x32x16_bf16 v[48:63], v[32:35], v[160:163], v[48:63]
    s_bitset0_b32 s48, 18
    buffer_load_dwordx4 v14, s[24:27], s52 offen offset:2048 lds
    v_exp_f32 v152, v136
    v_exp_f32 v153, v137
    v_exp_f32 v154, v138
    v_exp_f32 v155, v139
    v_cvt_pk_bf16_f32 v170, v148, v149
    v_cvt_pk_bf16_f32 v171, v150, v151
    v_mfma_f32_32x32x16_bf16 v[48:63], v[36:39], v[164:167], v[48:63]
    buffer_load_dwordx4 v[176:179], v1, s[44:47], s48 offen offset:0 sc1
    v_exp_f32 v156, v140
    v_exp_f32 v157, v141
    v_exp_f32 v158, v142
    v_exp_f32 v159, v143
    v_cvt_pk_bf16_f32 v172, v152, v153
    v_cvt_pk_bf16_f32 v173, v154, v155
    v_mfma_f32_32x32x16_bf16 v[128:143], v[200:203], a[232:235], 0
    s_waitcnt vmcnt(16)
    ds_read_b64_tr_b16 a[144:145], v242 offset:0
    ds_read_b64_tr_b16 a[146:147], v242 offset:1024
    ds_read_b64_tr_b16 a[148:149], v243 offset:0
    v_exp_f32 v144, v112
    v_exp_f32 v145, v113
    v_exp_f32 v146, v114
    v_exp_f32 v147, v115
    v_cvt_pk_bf16_f32 v174, v156, v157
    v_cvt_pk_bf16_f32 v175, v158, v159
    v_mfma_f32_32x32x16_bf16 v[128:143], v[204:207], a[236:239], v[128:143]
    buffer_load_dwordx4 v[180:183], v1, s[44:47], s48 offen offset:1024 sc1
    v_exp_f32 v148, v116
    v_exp_f32 v149, v117
    v_exp_f32 v150, v118
    v_exp_f32 v151, v119
    v_cvt_pk_bf16_f32 v160, v144, v145
    v_cvt_pk_bf16_f32 v161, v146, v147
    v_mfma_f32_32x32x16_bf16 v[64:79], v[32:35], v[168:171], v[64:79]
    buffer_load_dwordx4 v15, s[24:27], s52 offen offset:3072 lds
    v_exp_f32 v152, v120
    v_exp_f32 v153, v121
    v_exp_f32 v154, v122
    v_exp_f32 v155, v123
    v_cvt_pk_bf16_f32 v162, v148, v149
    v_cvt_pk_bf16_f32 v163, v150, v151
    v_mfma_f32_32x32x16_bf16 v[64:79], v[36:39], v[172:175], v[64:79]
    s_add_u32 s52, s74, 458752
    ds_read_b64_tr_b16 a[150:151], v243 offset:1024
    ds_read_b64_tr_b16 a[152:153], v242 offset:2048
    ds_read_b64_tr_b16 a[154:155], v242 offset:3072
    v_exp_f32 v156, v124
    v_exp_f32 v157, v125
    v_exp_f32 v158, v126
    v_exp_f32 v159, v127
    v_cvt_pk_bf16_f32 v164, v152, v153
    v_cvt_pk_bf16_f32 v165, v154, v155
    v_mfma_f32_32x32x16_bf16 v[112:127], v[16:19], a[208:211], 0
    s_cmp_ge_u32 s52, 1605632
    s_cselect_b32 s75, 1576960, 0
    buffer_store_dwordx4 v[8:11], v1, s[8:11], s69 offen offset:1024 sc1
    v_exp_f32 v144, v128
    v_exp_f32 v145, v129
    v_exp_f32 v146, v130
    v_exp_f32 v147, v131
    v_cvt_pk_bf16_f32 v166, v156, v157
    v_cvt_pk_bf16_f32 v167, v158, v159
    v_mfma_f32_32x32x16_bf16 v[112:127], v[20:23], a[212:215], v[112:127]
    s_add_u32 m0, s51, 0
    s_nop 0
    buffer_load_dwordx4 v2, s[24:27], s74 offen offset:0 lds
    v_exp_f32 v148, v132
    v_exp_f32 v149, v133
    v_exp_f32 v150, v134
    v_exp_f32 v151, v135
    v_cvt_pk_bf16_f32 v168, v144, v145
    v_cvt_pk_bf16_f32 v169, v146, v147
    v_mfma_f32_32x32x16_bf16 v[80:95], v[32:35], v[160:163], v[80:95]
    s_sub_u32 s52, s52, s75
    ds_read_b64_tr_b16 a[156:157], v243 offset:2048
    ds_read_b64_tr_b16 a[158:159], v243 offset:3072
    v_exp_f32 v152, v136
    v_exp_f32 v153, v137
    v_exp_f32 v154, v138
    v_exp_f32 v155, v139
    v_cvt_pk_bf16_f32 v170, v148, v149
    v_cvt_pk_bf16_f32 v171, v150, v151
    v_mfma_f32_32x32x16_bf16 v[80:95], v[36:39], v[164:167], v[80:95]
    buffer_load_dwordx4 v13, s[24:27], s74 offen offset:1024 lds
    v_exp_f32 v156, v140
    v_exp_f32 v157, v141
    v_exp_f32 v158, v142
    v_exp_f32 v159, v143
    v_cvt_pk_bf16_f32 v172, v152, v153
    v_cvt_pk_bf16_f32 v173, v154, v155
    v_mfma_f32_32x32x16_bf16 v[128:143], v[16:19], a[216:219], 0
    buffer_load_dwordx4 v[208:211], v1, s[44:47], s48 offen offset:2048 sc1
    v_exp_f32 v144, v112
    v_exp_f32 v145, v113
    v_exp_f32 v146, v114
    v_exp_f32 v147, v115
    v_cvt_pk_bf16_f32 v174, v156, v157
    v_cvt_pk_bf16_f32 v175, v158, v159
    v_mfma_f32_32x32x16_bf16 v[128:143], v[20:23], a[220:223], v[128:143]
    v_exp_f32 v148, v116
    v_exp_f32 v149, v117
    v_exp_f32 v150, v118
    v_exp_f32 v151, v119
    v_cvt_pk_bf16_f32 v160, v144, v145
    v_cvt_pk_bf16_f32 v161, v146, v147
    v_mfma_f32_32x32x16_bf16 v[96:111], v[32:35], v[168:171], v[96:111]
    buffer_load_dwordx4 v[212:215], v1, s[44:47], s48 offen offset:3072 sc1
    v_exp_f32 v152, v120
    v_exp_f32 v153, v121
    v_exp_f32 v154, v122
    v_exp_f32 v155, v123
    v_cvt_pk_bf16_f32 v162, v148, v149
    v_cvt_pk_bf16_f32 v163, v150, v151
    v_mfma_f32_32x32x16_bf16 v[96:111], v[36:39], v[172:175], v[96:111]
    s_add_u32 s48, s48, 0x4000
    buffer_load_dwordx4 v14, s[24:27], s74 offen offset:2048 lds
    v_exp_f32 v156, v124
    v_exp_f32 v157, v125
    v_exp_f32 v158, v126
    v_exp_f32 v159, v127
    v_cvt_pk_bf16_f32 v164, v152, v153
    v_cvt_pk_bf16_f32 v165, v154, v155
    v_mfma_f32_32x32x16_bf16 v[112:127], v[16:19], a[224:227], 0
    s_waitcnt vmcnt(17)
    v_max3_u32 v7, v40, v44, v24
    s_waitcnt vmcnt(16)
    v_max_u32 v7, v28, v7
    v_cmp_eq_u32 vcc, -1, v7
    v_exp_f32 v144, v128
    v_exp_f32 v145, v129
    v_exp_f32 v146, v130
    v_exp_f32 v147, v131
    v_cvt_pk_bf16_f32 v166, v156, v157
    v_cvt_pk_bf16_f32 v167, v158, v159
    v_mfma_f32_32x32x16_bf16 v[112:127], v[20:23], a[228:231], v[112:127]
    s_cbranch_vccnz B_r10
B_r10_ok:
    v_exp_f32 v148, v132
    v_exp_f32 v149, v133
    v_exp_f32 v150, v134
    v_exp_f32 v151, v135
    v_cvt_pk_bf16_f32 v168, v144, v145
    v_cvt_pk_bf16_f32 v169, v146, v147
    v_mfma_f32_32x32x16_bf16 v[48:63], v[40:43], v[160:163], v[48:63]
    s_bitset0_b32 s48, 18
    buffer_load_dwordx4 v15, s[24:27], s74 offen offset:3072 lds
    v_exp_f32 v152, v136
    v_exp_f32 v153, v137
    v_exp_f32 v154, v138
    v_exp_f32 v155, v139
    v_cvt_pk_bf16_f32 v170, v148, v149
    v_cvt_pk_bf16_f32 v171, v150, v151
    v_mfma_f32_32x32x16_bf16 v[48:63], v[44:47], v[164:167], v[48:63]
    s_add_u32 s70, s55, 688128
    buffer_load_dwordx4 v[184:187], v1, s[44:47], s48 offen offset:0 sc1
    v_exp_f32 v156, v140
    v_exp_f32 v157, v141
    v_exp_f32 v158, v142
    v_exp_f32 v159, v143
    v_cvt_pk_bf16_f32 v172, v152, v153
    v_cvt_pk_bf16_f32 v173, v154, v155
    v_mfma_f32_32x32x16_bf16 v[128:143], v[16:19], a[232:235], 0
    s_waitcnt vmcnt(17)
    ds_read_b64_tr_b16 a[160:161], v242 offset:16384
    ds_read_b64_tr_b16 a[162:163], v242 offset:17408
    ds_read_b64_tr_b16 a[164:165], v243 offset:16384
    v_exp_f32 v144, v112
    v_exp_f32 v145, v113
    v_exp_f32 v146, v114
    v_exp_f32 v147, v115
    v_cvt_pk_bf16_f32 v174, v156, v157
    v_cvt_pk_bf16_f32 v175, v158, v159
    v_mfma_f32_32x32x16_bf16 v[128:143], v[20:23], a[236:239], v[128:143]
    buffer_store_dwordx4 v[8:11], v1, s[8:11], s69 offen offset:2048 sc1
    v_exp_f32 v148, v116
    v_exp_f32 v149, v117
    v_exp_f32 v150, v118
    v_exp_f32 v151, v119
    v_cvt_pk_bf16_f32 v160, v144, v145
    v_cvt_pk_bf16_f32 v161, v146, v147
    v_mfma_f32_32x32x16_bf16 v[64:79], v[40:43], v[168:171], v[64:79]
    buffer_load_dwordx4 v[188:191], v1, s[44:47], s48 offen offset:1024 sc1
    v_exp_f32 v152, v120
    v_exp_f32 v153, v121
    v_exp_f32 v154, v122
    v_exp_f32 v155, v123
    v_cvt_pk_bf16_f32 v162, v148, v149
    v_cvt_pk_bf16_f32 v163, v150, v151
    v_mfma_f32_32x32x16_bf16 v[64:79], v[44:47], v[172:175], v[64:79]
    ds_read_b64_tr_b16 a[166:167], v243 offset:17408
    ds_read_b64_tr_b16 a[168:169], v242 offset:18432
    ds_read_b64_tr_b16 a[170:171], v242 offset:19456
    v_exp_f32 v156, v124
    v_exp_f32 v157, v125
    v_exp_f32 v158, v126
    v_exp_f32 v159, v127
    v_cvt_pk_bf16_f32 v164, v152, v153
    v_cvt_pk_bf16_f32 v165, v154, v155
    v_mfma_f32_32x32x16_bf16 v[112:127], v[24:27], a[208:211], 0
    buffer_load_dwordx4 v[216:219], v1, s[44:47], s48 offen offset:2048 sc1
    v_exp_f32 v144, v128
    v_exp_f32 v145, v129
    v_exp_f32 v146, v130
    v_exp_f32 v147, v131
    v_cvt_pk_bf16_f32 v166, v156, v157
    v_cvt_pk_bf16_f32 v167, v158, v159
    v_mfma_f32_32x32x16_bf16 v[112:127], v[28:31], a[212:215], v[112:127]
    buffer_load_dwordx4 v[220:223], v1, s[44:47], s48 offen offset:3072 sc1
    v_exp_f32 v148, v132
    v_exp_f32 v149, v133
    v_exp_f32 v150, v134
    v_exp_f32 v151, v135
    v_cvt_pk_bf16_f32 v168, v144, v145
    v_cvt_pk_bf16_f32 v169, v146, v147
    v_mfma_f32_32x32x16_bf16 v[80:95], v[40:43], v[160:163], v[80:95]
    s_add_u32 s48, s48, 0x4000
    ds_read_b64_tr_b16 a[172:173], v243 offset:18432
    ds_read_b64_tr_b16 a[174:175], v243 offset:19456
    v_exp_f32 v152, v136
    v_exp_f32 v153, v137
    v_exp_f32 v154, v138
    v_exp_f32 v155, v139
    v_cvt_pk_bf16_f32 v170, v148, v149
    v_cvt_pk_bf16_f32 v171, v150, v151
    v_mfma_f32_32x32x16_bf16 v[80:95], v[44:47], v[164:167], v[80:95]
    s_add_u32 m0, s56, 49152
    s_nop 0
    buffer_load_dwordx4 v3, s[20:23], s70 offen offset:0 lds
    v_exp_f32 v156, v140
    v_exp_f32 v157, v141
    v_exp_f32 v158, v142
    v_exp_f32 v159, v143
    v_cvt_pk_bf16_f32 v172, v152, v153
    v_cvt_pk_bf16_f32 v173, v154, v155
    v_mfma_f32_32x32x16_bf16 v[128:143], v[24:27], a[216:219], 0
    s_bitset0_b32 s48, 18
    buffer_load_dwordx4 v252, s[20:23], s70 offen offset:1024 lds
    v_exp_f32 v144, v112
    v_exp_f32 v145, v113
    v_exp_f32 v146, v114
    v_exp_f32 v147, v115
    v_cvt_pk_bf16_f32 v174, v156, v157
    v_cvt_pk_bf16_f32 v175, v158, v159
    v_mfma_f32_32x32x16_bf16 v[128:143], v[28:31], a[220:223], v[128:143]
    s_waitcnt vmcnt(14)
    ds_read_b64_tr_b16 a[176:177], v242 offset:32768
    ds_read_b64_tr_b16 a[178:179], v242 offset:33792
    ds_read_b64_tr_b16 a[180:181], v243 offset:32768
    v_exp_f32 v148, v116
    v_exp_f32 v149, v117
    v_exp_f32 v150, v118
    v_exp_f32 v151, v119
    v_cvt_pk_bf16_f32 v160, v144, v145
    v_cvt_pk_bf16_f32 v161, v146, v147
    v_mfma_f32_32x32x16_bf16 v[96:111], v[40:43], v[168:171], v[96:111]
    buffer_load_dwordx4 v[192:195], v1, s[44:47], s48 offen offset:0 sc1
    v_exp_f32 v152, v120
    v_exp_f32 v153, v121
    v_exp_f32 v154, v122
    v_exp_f32 v155, v123
    v_cvt_pk_bf16_f32 v162, v148, v149
    v_cvt_pk_bf16_f32 v163, v150, v151
    v_mfma_f32_32x32x16_bf16 v[96:111], v[44:47], v[172:175], v[96:111]
    buffer_load_dwordx4 v[196:199], v1, s[44:47], s48 offen offset:1024 sc1
    v_exp_f32 v156, v124
    v_exp_f32 v157, v125
    v_exp_f32 v158, v126
    v_exp_f32 v159, v127
    v_cvt_pk_bf16_f32 v164, v152, v153
    v_cvt_pk_bf16_f32 v165, v154, v155
    v_mfma_f32_32x32x16_bf16 v[112:127], v[24:27], a[224:227], 0
    v_max3_u32 v7, v244, v248, v176
    v_max_u32 v7, v180, v7
    v_cmp_eq_u32 vcc, -1, v7
    v_exp_f32 v144, v128
    v_exp_f32 v145, v129
    v_exp_f32 v146, v130
    v_exp_f32 v147, v131
    v_cvt_pk_bf16_f32 v166, v156, v157
    v_cvt_pk_bf16_f32 v167, v158, v159
    v_mfma_f32_32x32x16_bf16 v[112:127], v[28:31], a[228:231], v[112:127]
    s_cbranch_vccnz B_r11
B_r11_ok:
    v_exp_f32 v148, v132
    v_exp_f32 v149, v133
    v_exp_f32 v150, v134
    v_exp_f32 v151, v135
    v_cvt_pk_bf16_f32 v168, v144, v145
    v_cvt_pk_bf16_f32 v169, v146, v147
    v_mfma_f32_32x32x16_bf16 v[48:63], v[244:247], v[160:163], v[48:63]
    buffer_store_dwordx4 v[8:11], v1, s[8:11], s69 offen offset:3072 sc1
    v_exp_f32 v152, v136
    v_exp_f32 v153, v137
    v_exp_f32 v154, v138
    v_exp_f32 v155, v139
    v_cvt_pk_bf16_f32 v170, v148, v149
    v_cvt_pk_bf16_f32 v171, v150, v151
    v_mfma_f32_32x32x16_bf16 v[48:63], v[248:251], v[164:167], v[48:63]
    buffer_load_dwordx4 v[224:227], v1, s[44:47], s48 offen offset:2048 sc1
    v_exp_f32 v156, v140
    v_exp_f32 v157, v141
    v_exp_f32 v158, v142
    v_exp_f32 v159, v143
    v_cvt_pk_bf16_f32 v172, v152, v153
    v_cvt_pk_bf16_f32 v173, v154, v155
    v_mfma_f32_32x32x16_bf16 v[128:143], v[24:27], a[232:235], 0
    ds_read_b64_tr_b16 a[182:183], v243 offset:33792
    ds_read_b64_tr_b16 a[184:185], v242 offset:34816
    ds_read_b64_tr_b16 a[186:187], v242 offset:35840
    v_exp_f32 v144, v112
    v_exp_f32 v145, v113
    v_exp_f32 v146, v114
    v_exp_f32 v147, v115
    v_cvt_pk_bf16_f32 v174, v156, v157
    v_cvt_pk_bf16_f32 v175, v158, v159
    v_mfma_f32_32x32x16_bf16 v[128:143], v[28:31], a[236:239], v[128:143]
    buffer_load_dwordx4 v[228:231], v1, s[44:47], s48 offen offset:3072 sc1
    v_exp_f32 v148, v116
    v_exp_f32 v149, v117
    v_exp_f32 v150, v118
    v_exp_f32 v151, v119
    v_cvt_pk_bf16_f32 v160, v144, v145
    v_cvt_pk_bf16_f32 v161, v146, v147
    v_mfma_f32_32x32x16_bf16 v[64:79], v[244:247], v[168:171], v[64:79]
    s_add_u32 s48, s48, 0x4000
    buffer_load_dwordx4 v253, s[20:23], s70 offen offset:2048 lds
    v_exp_f32 v152, v120
    v_exp_f32 v153, v121
    v_exp_f32 v154, v122
    v_exp_f32 v155, v123
    v_cvt_pk_bf16_f32 v162, v148, v149
    v_cvt_pk_bf16_f32 v163, v150, v151
    v_mfma_f32_32x32x16_bf16 v[64:79], v[248:251], v[172:175], v[64:79]
    s_bitset0_b32 s48, 18
    ds_read_b64_tr_b16 a[188:189], v243 offset:34816
    ds_read_b64_tr_b16 a[190:191], v243 offset:35840
    v_exp_f32 v156, v124
    v_exp_f32 v157, v125
    v_exp_f32 v158, v126
    v_exp_f32 v159, v127
    v_cvt_pk_bf16_f32 v164, v152, v153
    v_cvt_pk_bf16_f32 v165, v154, v155
    v_mfma_f32_32x32x16_bf16 v[112:127], v[176:179], a[208:211], 0
    buffer_load_dwordx4 v[200:203], v1, s[44:47], s48 offen offset:0 sc1
    v_exp_f32 v144, v128
    v_exp_f32 v145, v129
    v_exp_f32 v146, v130
    v_exp_f32 v147, v131
    v_cvt_pk_bf16_f32 v166, v156, v157
    v_cvt_pk_bf16_f32 v167, v158, v159
    v_mfma_f32_32x32x16_bf16 v[112:127], v[180:183], a[212:215], v[112:127]
    buffer_load_dwordx4 v[204:207], v1, s[44:47], s48 offen offset:1024 sc1
    v_exp_f32 v148, v132
    v_exp_f32 v149, v133
    v_exp_f32 v150, v134
    v_exp_f32 v151, v135
    v_cvt_pk_bf16_f32 v168, v144, v145
    v_cvt_pk_bf16_f32 v169, v146, v147
    v_mfma_f32_32x32x16_bf16 v[80:95], v[244:247], v[160:163], v[80:95]
    s_waitcnt vmcnt(15)
    ds_read_b64_tr_b16 a[192:193], v4 offset:0
    ds_read_b64_tr_b16 a[194:195], v4 offset:1024
    ds_read_b64_tr_b16 a[196:197], v5 offset:0
    v_exp_f32 v152, v136
    v_exp_f32 v153, v137
    v_exp_f32 v154, v138
    v_exp_f32 v155, v139
    v_cvt_pk_bf16_f32 v170, v148, v149
    v_cvt_pk_bf16_f32 v171, v150, v151
    v_mfma_f32_32x32x16_bf16 v[80:95], v[248:251], v[164:167], v[80:95]
    buffer_load_dwordx4 v[32:35], v1, s[44:47], s48 offen offset:2048 sc1
    v_exp_f32 v156, v140
    v_exp_f32 v157, v141
    v_exp_f32 v158, v142
    v_exp_f32 v159, v143
    v_cvt_pk_bf16_f32 v172, v152, v153
    v_cvt_pk_bf16_f32 v173, v154, v155
    v_mfma_f32_32x32x16_bf16 v[128:143], v[176:179], a[216:219], 0
    buffer_load_dwordx4 v[36:39], v1, s[44:47], s48 offen offset:3072 sc1
    v_exp_f32 v144, v112
    v_exp_f32 v145, v113
    v_exp_f32 v146, v114
    v_exp_f32 v147, v115
    v_cvt_pk_bf16_f32 v174, v156, v157
    v_cvt_pk_bf16_f32 v175, v158, v159
    v_mfma_f32_32x32x16_bf16 v[128:143], v[180:183], a[220:223], v[128:143]
    ds_read_b64_tr_b16 a[198:199], v5 offset:1024
    ds_read_b64_tr_b16 a[200:201], v4 offset:2048
    ds_read_b64_tr_b16 a[202:203], v4 offset:3072
    v_exp_f32 v148, v116
    v_exp_f32 v149, v117
    v_exp_f32 v150, v118
    v_exp_f32 v151, v119
    v_cvt_pk_bf16_f32 v160, v144, v145
    v_cvt_pk_bf16_f32 v161, v146, v147
    v_mfma_f32_32x32x16_bf16 v[96:111], v[244:247], v[168:171], v[96:111]
    buffer_load_dwordx4 v254, s[20:23], s70 offen offset:3072 lds
    v_exp_f32 v152, v120
    v_exp_f32 v153, v121
    v_exp_f32 v154, v122
    v_exp_f32 v155, v123
    v_cvt_pk_bf16_f32 v162, v148, v149
    v_cvt_pk_bf16_f32 v163, v150, v151
    v_mfma_f32_32x32x16_bf16 v[96:111], v[248:251], v[172:175], v[96:111]
    s_add_u32 s70, s55, 917504
    ds_read_b64_tr_b16 a[204:205], v5 offset:2048
    ds_read_b64_tr_b16 a[206:207], v5 offset:3072
    v_exp_f32 v156, v124
    v_exp_f32 v157, v125
    v_exp_f32 v158, v126
    v_exp_f32 v159, v127
    v_cvt_pk_bf16_f32 v164, v152, v153
    v_cvt_pk_bf16_f32 v165, v154, v155
    v_mfma_f32_32x32x16_bf16 v[112:127], v[176:179], a[224:227], 0
    s_waitcnt vmcnt(17)
    v_max3_u32 v7, v208, v212, v184
    s_waitcnt vmcnt(15)
    v_max_u32 v7, v188, v7
    v_cmp_eq_u32 vcc, -1, v7
    v_exp_f32 v144, v128
    v_exp_f32 v145, v129
    v_exp_f32 v146, v130
    v_exp_f32 v147, v131
    v_cvt_pk_bf16_f32 v166, v156, v157
    v_cvt_pk_bf16_f32 v167, v158, v159
    v_mfma_f32_32x32x16_bf16 v[112:127], v[180:183], a[228:231], v[112:127]
    s_cbranch_vccnz B_r12
B_r12_ok:
    v_exp_f32 v148, v132
    v_exp_f32 v149, v133
    v_exp_f32 v150, v134
    v_exp_f32 v151, v135
    v_cvt_pk_bf16_f32 v168, v144, v145
    v_cvt_pk_bf16_f32 v169, v146, v147
    v_mfma_f32_32x32x16_bf16 v[48:63], v[208:211], v[160:163], v[48:63]
    s_add_u32 m0, s56, 65536
    s_nop 0
    buffer_load_dwordx4 v3, s[20:23], s70 offen offset:0 lds
    v_exp_f32 v152, v136
    v_exp_f32 v153, v137
    v_exp_f32 v154, v138
    v_exp_f32 v155, v139
    v_cvt_pk_bf16_f32 v170, v148, v149
    v_cvt_pk_bf16_f32 v171, v150, v151
    v_mfma_f32_32x32x16_bf16 v[48:63], v[212:215], v[164:167], v[48:63]
    s_waitcnt lgkmcnt(0)
    buffer_load_dwordx4 v252, s[20:23], s70 offen offset:1024 lds
    v_exp_f32 v156, v140
    v_exp_f32 v157, v141
    v_exp_f32 v158, v142
    v_exp_f32 v159, v143
    v_cvt_pk_bf16_f32 v172, v152, v153
    v_cvt_pk_bf16_f32 v173, v154, v155
    v_mfma_f32_32x32x16_bf16 v[128:143], v[176:179], a[232:235], 0
    v_exp_f32 v144, v112
    v_exp_f32 v145, v113
    v_exp_f32 v146, v114
    v_exp_f32 v147, v115
    v_cvt_pk_bf16_f32 v174, v156, v157
    v_cvt_pk_bf16_f32 v175, v158, v159
    v_mfma_f32_32x32x16_bf16 v[128:143], v[180:183], a[236:239], v[128:143]
    buffer_load_dwordx4 v253, s[20:23], s70 offen offset:2048 lds
    v_exp_f32 v148, v116
    v_exp_f32 v149, v117
    v_exp_f32 v150, v118
    v_exp_f32 v151, v119
    v_cvt_pk_bf16_f32 v160, v144, v145
    v_cvt_pk_bf16_f32 v161, v146, v147
    v_mfma_f32_32x32x16_bf16 v[64:79], v[208:211], v[168:171], v[64:79]
    buffer_load_dwordx4 v254, s[20:23], s70 offen offset:3072 lds
    v_exp_f32 v152, v120
    v_exp_f32 v153, v121
    v_exp_f32 v154, v122
    v_exp_f32 v155, v123
    v_cvt_pk_bf16_f32 v162, v148, v149
    v_cvt_pk_bf16_f32 v163, v150, v151
    v_mfma_f32_32x32x16_bf16 v[64:79], v[212:215], v[172:175], v[64:79]
    s_add_u32 s70, s55, 1146880
    v_exp_f32 v156, v124
    v_exp_f32 v157, v125
    v_exp_f32 v158, v126
    v_exp_f32 v159, v127
    v_cvt_pk_bf16_f32 v164, v152, v153
    v_cvt_pk_bf16_f32 v165, v154, v155
    v_mfma_f32_32x32x16_bf16 v[112:127], v[184:187], a[208:211], 0
    s_add_u32 m0, s56, 81920
    s_nop 0
    buffer_load_dwordx4 v3, s[20:23], s70 offen offset:0 lds
    v_exp_f32 v144, v128
    v_exp_f32 v145, v129
    v_exp_f32 v146, v130
    v_exp_f32 v147, v131
    v_cvt_pk_bf16_f32 v166, v156, v157
    v_cvt_pk_bf16_f32 v167, v158, v159
    v_mfma_f32_32x32x16_bf16 v[112:127], v[188:191], a[212:215], v[112:127]
    buffer_load_dwordx4 v252, s[20:23], s70 offen offset:1024 lds
    v_exp_f32 v148, v132
    v_exp_f32 v149, v133
    v_exp_f32 v150, v134
    v_exp_f32 v151, v135
    v_cvt_pk_bf16_f32 v168, v144, v145
    v_cvt_pk_bf16_f32 v169, v146, v147
    v_mfma_f32_32x32x16_bf16 v[80:95], v[208:211], v[160:163], v[80:95]
    v_exp_f32 v152, v136
    v_exp_f32 v153, v137
    v_exp_f32 v154, v138
    v_exp_f32 v155, v139
    v_cvt_pk_bf16_f32 v170, v148, v149
    v_cvt_pk_bf16_f32 v171, v150, v151
    v_mfma_f32_32x32x16_bf16 v[80:95], v[212:215], v[164:167], v[80:95]
    buffer_load_dwordx4 v253, s[20:23], s70 offen offset:2048 lds
    v_exp_f32 v156, v140
    v_exp_f32 v157, v141
    v_exp_f32 v158, v142
    v_exp_f32 v159, v143
    v_cvt_pk_bf16_f32 v172, v152, v153
    v_cvt_pk_bf16_f32 v173, v154, v155
    v_mfma_f32_32x32x16_bf16 v[128:143], v[184:187], a[216:219], 0
    buffer_load_dwordx4 v254, s[20:23], s70 offen offset:3072 lds
    v_exp_f32 v144, v112
    v_exp_f32 v145, v113
    v_exp_f32 v146, v114
    v_exp_f32 v147, v115
    v_cvt_pk_bf16_f32 v174, v156, v157
    v_cvt_pk_bf16_f32 v175, v158, v159
    v_mfma_f32_32x32x16_bf16 v[128:143], v[188:191], a[220:223], v[128:143]
    s_add_u32 s70, s55, 1376256
    v_exp_f32 v148, v116
    v_exp_f32 v149, v117
    v_exp_f32 v150, v118
    v_exp_f32 v151, v119
    v_cvt_pk_bf16_f32 v160, v144, v145
    v_cvt_pk_bf16_f32 v161, v146, v147
    v_mfma_f32_32x32x16_bf16 v[96:111], v[208:211], v[168:171], v[96:111]
    s_add_u32 m0, s56, 98304
    s_nop 0
    buffer_load_dwordx4 v3, s[20:23], s70 offen offset:0 lds
    v_exp_f32 v152, v120
    v_exp_f32 v153, v121
    v_exp_f32 v154, v122
    v_exp_f32 v155, v123
    v_cvt_pk_bf16_f32 v162, v148, v149
    v_cvt_pk_bf16_f32 v163, v150, v151
    v_mfma_f32_32x32x16_bf16 v[96:111], v[212:215], v[172:175], v[96:111]
    buffer_load_dwordx4 v252, s[20:23], s70 offen offset:1024 lds
    v_exp_f32 v156, v124
    v_exp_f32 v157, v125
    v_exp_f32 v158, v126
    v_exp_f32 v159, v127
    v_cvt_pk_bf16_f32 v164, v152, v153
    v_cvt_pk_bf16_f32 v165, v154, v155
    v_mfma_f32_32x32x16_bf16 v[112:127], v[184:187], a[224:227], 0
    s_waitcnt vmcnt(20)
    v_max3_u32 v7, v216, v220, v192
    s_waitcnt vmcnt(19)
    v_max_u32 v7, v196, v7
    v_cmp_eq_u32 vcc, -1, v7
    v_exp_f32 v144, v128
    v_exp_f32 v145, v129
    v_exp_f32 v146, v130
    v_exp_f32 v147, v131
    v_cvt_pk_bf16_f32 v166, v156, v157
    v_cvt_pk_bf16_f32 v167, v158, v159
    v_mfma_f32_32x32x16_bf16 v[112:127], v[188:191], a[228:231], v[112:127]
    s_cbranch_vccnz B_r13
B_r13_ok:
    v_exp_f32 v148, v132
    v_exp_f32 v149, v133
    v_exp_f32 v150, v134
    v_exp_f32 v151, v135
    v_cvt_pk_bf16_f32 v168, v144, v145
    v_cvt_pk_bf16_f32 v169, v146, v147
    v_mfma_f32_32x32x16_bf16 v[48:63], v[216:219], v[160:163], v[48:63]
    buffer_load_dwordx4 v253, s[20:23], s70 offen offset:2048 lds
    v_exp_f32 v152, v136
    v_exp_f32 v153, v137
    v_exp_f32 v154, v138
    v_exp_f32 v155, v139
    v_cvt_pk_bf16_f32 v170, v148, v149
    v_cvt_pk_bf16_f32 v171, v150, v151
    v_mfma_f32_32x32x16_bf16 v[48:63], v[220:223], v[164:167], v[48:63]
    buffer_load_dwordx4 v254, s[20:23], s70 offen offset:3072 lds
    v_exp_f32 v156, v140
    v_exp_f32 v157, v141
    v_exp_f32 v158, v142
    v_exp_f32 v159, v143
    v_cvt_pk_bf16_f32 v172, v152, v153
    v_cvt_pk_bf16_f32 v173, v154, v155
    v_mfma_f32_32x32x16_bf16 v[128:143], v[184:187], a[232:235], 0
    s_add_u32 s70, s55, 0
    v_exp_f32 v144, v112
    v_exp_f32 v145, v113
    v_exp_f32 v146, v114
    v_exp_f32 v147, v115
    v_cvt_pk_bf16_f32 v174, v156, v157
    v_cvt_pk_bf16_f32 v175, v158, v159
    v_mfma_f32_32x32x16_bf16 v[128:143], v[188:191], a[236:239], v[128:143]
    s_add_u32 m0, s56, 0
    s_nop 0
    buffer_load_dwordx4 v3, s[20:23], s70 offen offset:0 lds
    v_exp_f32 v148, v116
    v_exp_f32 v149, v117
    v_exp_f32 v150, v118
    v_exp_f32 v151, v119
    v_cvt_pk_bf16_f32 v160, v144, v145
    v_cvt_pk_bf16_f32 v161, v146, v147
    v_mfma_f32_32x32x16_bf16 v[64:79], v[216:219], v[168:171], v[64:79]
    buffer_load_dwordx4 v252, s[20:23], s70 offen offset:1024 lds
    v_exp_f32 v152, v120
    v_exp_f32 v153, v121
    v_exp_f32 v154, v122
    v_exp_f32 v155, v123
    v_cvt_pk_bf16_f32 v162, v148, v149
    v_cvt_pk_bf16_f32 v163, v150, v151
    v_mfma_f32_32x32x16_bf16 v[64:79], v[220:223], v[172:175], v[64:79]
    v_exp_f32 v156, v124
    v_exp_f32 v157, v125
    v_exp_f32 v158, v126
    v_exp_f32 v159, v127
    v_cvt_pk_bf16_f32 v164, v152, v153
    v_cvt_pk_bf16_f32 v165, v154, v155
    v_mfma_f32_32x32x16_bf16 v[112:127], v[192:195], a[208:211], 0
    buffer_load_dwordx4 v253, s[20:23], s70 offen offset:2048 lds
    v_exp_f32 v144, v128
    v_exp_f32 v145, v129
    v_exp_f32 v146, v130
    v_exp_f32 v147, v131
    v_cvt_pk_bf16_f32 v166, v156, v157
    v_cvt_pk_bf16_f32 v167, v158, v159
    v_mfma_f32_32x32x16_bf16 v[112:127], v[196:199], a[212:215], v[112:127]
    buffer_load_dwordx4 v254, s[20:23], s70 offen offset:3072 lds
    v_exp_f32 v148, v132
    v_exp_f32 v149, v133
    v_exp_f32 v150, v134
    v_exp_f32 v151, v135
    v_cvt_pk_bf16_f32 v168, v144, v145
    v_cvt_pk_bf16_f32 v169, v146, v147
    v_mfma_f32_32x32x16_bf16 v[80:95], v[216:219], v[160:163], v[80:95]
    s_add_u32 s70, s55, 229376
    v_exp_f32 v152, v136
    v_exp_f32 v153, v137
    v_exp_f32 v154, v138
    v_exp_f32 v155, v139
    v_cvt_pk_bf16_f32 v170, v148, v149
    v_cvt_pk_bf16_f32 v171, v150, v151
    v_mfma_f32_32x32x16_bf16 v[80:95], v[220:223], v[164:167], v[80:95]
    s_add_u32 m0, s56, 16384
    s_nop 0
    buffer_load_dwordx4 v3, s[20:23], s70 offen offset:0 lds
    v_exp_f32 v156, v140
    v_exp_f32 v157, v141
    v_exp_f32 v158, v142
    v_exp_f32 v159, v143
    v_cvt_pk_bf16_f32 v172, v152, v153
    v_cvt_pk_bf16_f32 v173, v154, v155
    v_mfma_f32_32x32x16_bf16 v[128:143], v[192:195], a[216:219], 0
    buffer_load_dwordx4 v252, s[20:23], s70 offen offset:1024 lds
    v_exp_f32 v144, v112
    v_exp_f32 v145, v113
    v_exp_f32 v146, v114
    v_exp_f32 v147, v115
    v_cvt_pk_bf16_f32 v174, v156, v157
    v_cvt_pk_bf16_f32 v175, v158, v159
    v_mfma_f32_32x32x16_bf16 v[128:143], v[196:199], a[220:223], v[128:143]
    v_exp_f32 v148, v116
    v_exp_f32 v149, v117
    v_exp_f32 v150, v118
    v_exp_f32 v151, v119
    v_cvt_pk_bf16_f32 v160, v144, v145
    v_cvt_pk_bf16_f32 v161, v146, v147
    v_mfma_f32_32x32x16_bf16 v[96:111], v[216:219], v[168:171], v[96:111]
    buffer_load_dwordx4 v253, s[20:23], s70 offen offset:2048 lds
    v_exp_f32 v152, v120
    v_exp_f32 v153, v121
    v_exp_f32 v154, v122
    v_exp_f32 v155, v123
    v_cvt_pk_bf16_f32 v162, v148, v149
    v_cvt_pk_bf16_f32 v163, v150, v151
    v_mfma_f32_32x32x16_bf16 v[96:111], v[220:223], v[172:175], v[96:111]
    buffer_load_dwordx4 v254, s[20:23], s70 offen offset:3072 lds
    v_exp_f32 v156, v124
    v_exp_f32 v157, v125
    v_exp_f32 v158, v126
    v_exp_f32 v159, v127
    v_cvt_pk_bf16_f32 v164, v152, v153
    v_cvt_pk_bf16_f32 v165, v154, v155
    v_mfma_f32_32x32x16_bf16 v[112:127], v[192:195], a[224:227], 0
    s_waitcnt vmcnt(24)
    v_max3_u32 v7, v224, v228, v200
    s_waitcnt vmcnt(23)
    v_max_u32 v7, v204, v7
    v_cmp_eq_u32 vcc, -1, v7
    v_exp_f32 v144, v128
    v_exp_f32 v145, v129
    v_exp_f32 v146, v130
    v_exp_f32 v147, v131
    v_cvt_pk_bf16_f32 v166, v156, v157
    v_cvt_pk_bf16_f32 v167, v158, v159
    v_mfma_f32_32x32x16_bf16 v[112:127], v[196:199], a[228:231], v[112:127]
    s_cbranch_vccnz B_r14
B_r14_ok:
    v_exp_f32 v148, v132
    v_exp_f32 v149, v133
    v_exp_f32 v150, v134
    v_exp_f32 v151, v135
    v_cvt_pk_bf16_f32 v168, v144, v145
    v_cvt_pk_bf16_f32 v169, v146, v147
    v_mfma_f32_32x32x16_bf16 v[48:63], v[224:227], v[160:163], v[48:63]
    s_add_u32 s70, s55, 458752
    buffer_load_dwordx4 v[244:247], v236, s[12:15], s4 offen
    v_exp_f32 v152, v136
    v_exp_f32 v153, v137
    v_exp_f32 v154, v138
    v_exp_f32 v155, v139
    v_cvt_pk_bf16_f32 v170, v148, v149
    v_cvt_pk_bf16_f32 v171, v150, v151
    v_mfma_f32_32x32x16_bf16 v[48:63], v[228:231], v[164:167], v[48:63]
    s_add_u32 m0, s56, 32768
    s_nop 0
    buffer_load_dwordx4 v3, s[20:23], s70 offen offset:0 lds
    v_exp_f32 v156, v140
    v_exp_f32 v157, v141
    v_exp_f32 v158, v142
    v_exp_f32 v159, v143
    v_cvt_pk_bf16_f32 v172, v152, v153
    v_cvt_pk_bf16_f32 v173, v154, v155
    v_mfma_f32_32x32x16_bf16 v[128:143], v[192:195], a[232:235], 0
    v_exp_f32 v144, v112
    v_exp_f32 v145, v113
    v_exp_f32 v146, v114
    v_exp_f32 v147, v115
    v_cvt_pk_bf16_f32 v174, v156, v157
    v_cvt_pk_bf16_f32 v175, v158, v159
    v_mfma_f32_32x32x16_bf16 v[128:143], v[196:199], a[236:239], v[128:143]
    buffer_load_dwordx4 v252, s[20:23], s70 offen offset:1024 lds
    v_exp_f32 v148, v116
    v_exp_f32 v149, v117
    v_exp_f32 v150, v118
    v_exp_f32 v151, v119
    v_cvt_pk_bf16_f32 v160, v144, v145
    v_cvt_pk_bf16_f32 v161, v146, v147
    v_mfma_f32_32x32x16_bf16 v[64:79], v[224:227], v[168:171], v[64:79]
    buffer_load_dwordx4 v253, s[20:23], s70 offen offset:2048 lds
    v_exp_f32 v152, v120
    v_exp_f32 v153, v121
    v_exp_f32 v154, v122
    v_exp_f32 v155, v123
    v_cvt_pk_bf16_f32 v162, v148, v149
    v_cvt_pk_bf16_f32 v163, v150, v151
    v_mfma_f32_32x32x16_bf16 v[64:79], v[228:231], v[172:175], v[64:79]
    v_exp_f32 v156, v124
    v_exp_f32 v157, v125
    v_exp_f32 v158, v126
    v_exp_f32 v159, v127
    v_cvt_pk_bf16_f32 v164, v152, v153
    v_cvt_pk_bf16_f32 v165, v154, v155
    v_mfma_f32_32x32x16_bf16 v[112:127], v[200:203], a[208:211], 0
    buffer_load_dwordx4 v254, s[20:23], s70 offen offset:3072 lds
    v_exp_f32 v144, v128
    v_exp_f32 v145, v129
    v_exp_f32 v146, v130
    v_exp_f32 v147, v131
    v_cvt_pk_bf16_f32 v166, v156, v157
    v_cvt_pk_bf16_f32 v167, v158, v159
    v_mfma_f32_32x32x16_bf16 v[112:127], v[204:207], a[212:215], v[112:127]
    buffer_load_dwordx4 v[248:251], v236, s[12:15], s5 offen
    v_exp_f32 v148, v132
    v_exp_f32 v149, v133
    v_exp_f32 v150, v134
    v_exp_f32 v151, v135
    v_cvt_pk_bf16_f32 v168, v144, v145
    v_cvt_pk_bf16_f32 v169, v146, v147
    v_mfma_f32_32x32x16_bf16 v[80:95], v[224:227], v[160:163], v[80:95]
    v_exp_f32 v152, v136
    v_exp_f32 v153, v137
    v_exp_f32 v154, v138
    v_exp_f32 v155, v139
    v_cvt_pk_bf16_f32 v170, v148, v149
    v_cvt_pk_bf16_f32 v171, v150, v151
    v_mfma_f32_32x32x16_bf16 v[80:95], v[228:231], v[164:167], v[80:95]
    global_load_dwordx4 v[232:235], v237, s[38:39]
    v_exp_f32 v156, v140
    v_exp_f32 v157, v141
    v_exp_f32 v158, v142
    v_exp_f32 v159, v143
    v_cvt_pk_bf16_f32 v172, v152, v153
    v_cvt_pk_bf16_f32 v173, v154, v155
    v_mfma_f32_32x32x16_bf16 v[128:143], v[200:203], a[216:219], 0
    global_load_ushort v176, v238, s[36:37]
    v_exp_f32 v144, v112
    v_exp_f32 v145, v113
    v_exp_f32 v146, v114
    v_exp_f32 v147, v115
    v_cvt_pk_bf16_f32 v174, v156, v157
    v_cvt_pk_bf16_f32 v175, v158, v159
    v_mfma_f32_32x32x16_bf16 v[128:143], v[204:207], a[220:223], v[128:143]
    v_exp_f32 v148, v116
    v_exp_f32 v149, v117
    v_exp_f32 v150, v118
    v_exp_f32 v151, v119
    v_cvt_pk_bf16_f32 v160, v144, v145
    v_cvt_pk_bf16_f32 v161, v146, v147
    v_mfma_f32_32x32x16_bf16 v[96:111], v[224:227], v[168:171], v[96:111]
    buffer_load_dword v16, v239, s[8:11], s6 offen sc1
    v_exp_f32 v152, v120
    v_exp_f32 v153, v121
    v_exp_f32 v154, v122
    v_exp_f32 v155, v123
    v_cvt_pk_bf16_f32 v162, v148, v149
    v_cvt_pk_bf16_f32 v163, v150, v151
    v_mfma_f32_32x32x16_bf16 v[96:111], v[228:231], v[172:175], v[96:111]
    v_exp_f32 v156, v124
    v_exp_f32 v157, v125
    v_exp_f32 v158, v126
    v_exp_f32 v159, v127
    v_cvt_pk_bf16_f32 v164, v152, v153
    v_cvt_pk_bf16_f32 v165, v154, v155
    v_mfma_f32_32x32x16_bf16 v[112:127], v[200:203], a[224:227], 0
    s_waitcnt vmcnt(30)
    v_max_u32 v7, v32, v36
    v_cmp_eq_u32 vcc, -1, v7
    v_exp_f32 v144, v128
    v_exp_f32 v145, v129
    v_exp_f32 v146, v130
    v_exp_f32 v147, v131
    v_cvt_pk_bf16_f32 v166, v156, v157
    v_cvt_pk_bf16_f32 v167, v158, v159
    v_mfma_f32_32x32x16_bf16 v[112:127], v[204:207], a[228:231], v[112:127]
    s_cbranch_vccnz B_r15
B_r15_ok:
    v_exp_f32 v148, v132
    v_exp_f32 v149, v133
    v_exp_f32 v150, v134
    v_exp_f32 v151, v135
    v_cvt_pk_bf16_f32 v168, v144, v145
    v_cvt_pk_bf16_f32 v169, v146, v147
    v_mfma_f32_32x32x16_bf16 v[48:63], v[32:35], v[160:163], v[48:63]
    v_exp_f32 v152, v136
    v_exp_f32 v153, v137
    v_exp_f32 v154, v138
    v_exp_f32 v155, v139
    v_cvt_pk_bf16_f32 v170, v148, v149
    v_cvt_pk_bf16_f32 v171, v150, v151
    v_mfma_f32_32x32x16_bf16 v[48:63], v[36:39], v[164:167], v[48:63]
    v_exp_f32 v156, v140
    v_exp_f32 v157, v141
    v_exp_f32 v158, v142
    v_exp_f32 v159, v143
    v_cvt_pk_bf16_f32 v172, v152, v153
    v_cvt_pk_bf16_f32 v173, v154, v155
    v_mfma_f32_32x32x16_bf16 v[128:143], v[200:203], a[232:235], 0
    v_exp_f32 v144, v112
    v_exp_f32 v145, v113
    v_exp_f32 v146, v114
    v_exp_f32 v147, v115
    v_cvt_pk_bf16_f32 v174, v156, v157
    v_cvt_pk_bf16_f32 v175, v158, v159
    v_mfma_f32_32x32x16_bf16 v[128:143], v[204:207], a[236:239], v[128:143]
    v_exp_f32 v148, v116
    v_exp_f32 v149, v117
    v_exp_f32 v150, v118
    v_exp_f32 v151, v119
    v_cvt_pk_bf16_f32 v160, v144, v145
    v_cvt_pk_bf16_f32 v161, v146, v147
    v_mfma_f32_32x32x16_bf16 v[64:79], v[32:35], v[168:171], v[64:79]
    ds_write_b128 v6, v[48:51] offset:0
    ds_write_b128 v6, v[52:55] offset:1024
    v_exp_f32 v152, v120
    v_exp_f32 v153, v121
    v_exp_f32 v154, v122
    v_exp_f32 v155, v123
    v_cvt_pk_bf16_f32 v162, v148, v149
    v_cvt_pk_bf16_f32 v163, v150, v151
    v_mfma_f32_32x32x16_bf16 v[64:79], v[36:39], v[172:175], v[64:79]
    ds_write_b128 v6, v[56:59] offset:2048
    ds_write_b128 v6, v[60:63] offset:3072
    v_exp_f32 v156, v124
    v_exp_f32 v157, v125
    v_exp_f32 v158, v126
    v_exp_f32 v159, v127
    v_cvt_pk_bf16_f32 v164, v152, v153
    v_cvt_pk_bf16_f32 v165, v154, v155
    v_mfma_f32_32x32x16_bf16 v[80:95], v[32:35], v[160:163], v[80:95]
    s_nop 2
    ds_write_b128 v6, v[64:67] offset:4096
    ds_write_b128 v6, v[68:71] offset:5120
    v_exp_f32 v144, v128
    v_exp_f32 v145, v129
    v_exp_f32 v146, v130
    v_exp_f32 v147, v131
    v_cvt_pk_bf16_f32 v166, v156, v157
    v_cvt_pk_bf16_f32 v167, v158, v159
    s_nop 1
    v_mfma_f32_32x32x16_bf16 v[80:95], v[36:39], v[164:167], v[80:95]
    ds_write_b128 v6, v[72:75] offset:6144
    ds_write_b128 v6, v[76:79] offset:7168
    v_exp_f32 v148, v132
    v_exp_f32 v149, v133
    v_exp_f32 v150, v134
    v_exp_f32 v151, v135
    v_cvt_pk_bf16_f32 v168, v144, v145
    v_cvt_pk_bf16_f32 v169, v146, v147
    v_exp_f32 v152, v136
    v_exp_f32 v153, v137
    v_exp_f32 v154, v138
    v_exp_f32 v155, v139
    v_cvt_pk_bf16_f32 v170, v148, v149
    v_cvt_pk_bf16_f32 v171, v150, v151
    v_exp_f32 v156, v140
    ds_write_b128 v6, v[80:83] offset:8192
    v_exp_f32 v157, v141
    ds_write_b128 v6, v[84:87] offset:9216
    v_exp_f32 v158, v142
    ds_write_b128 v6, v[88:91] offset:10240
    v_exp_f32 v159, v143
    ds_write_b128 v6, v[92:95] offset:11264
    v_cvt_pk_bf16_f32 v172, v152, v153
    v_cvt_pk_bf16_f32 v173, v154, v155
    v_mfma_f32_32x32x16_bf16 v[96:111], v[32:35], v[168:171], v[96:111]
    v_cvt_pk_bf16_f32 v174, v156, v157
    v_cvt_pk_bf16_f32 v175, v158, v159
    s_nop 1
    v_mfma_f32_32x32x16_bf16 v[96:111], v[36:39], v[172:175], v[96:111]
    s_xor_b32 s66, s3, 1
    s_mul_i32 s66, s66, 12288
    v_add_u32 v237, s66, v1
    s_xor_b32 s66, s3, 2
    s_mul_i32 s66, s66, 12288
    v_add_u32 v238, s66, v1
    s_xor_b32 s66, s3, 3
    s_mul_i32 s66, s66, 12288
    v_add_u32 v239, s66, v1
    s_and_b32 s66, s2, 7
    s_lshl_b32 s66, s66, 5
    s_add_u32 s66, s66, s43
    s_lshl_b32 s66, s66, 2
    s_add_u32 s66, s66, s3
    s_lshl_b32 s66, s66, 2
    s_add_u32 s22, s66, 0x1174000
    s_add_u32 s66, s66, 0x1172000
    s_getreg_b32 s74, hwreg(HW_REG_XCC_ID, 0, 3)
    s_add_u32 s74, s74, s40
    v_mov_b32 v199, s74
    s_waitcnt vmcnt(0) lgkmcnt(0)
    s_barrier
    ds_read_b128 v[112:115], v237 offset:0
    ds_read_b128 v[116:119], v237 offset:1024
    ds_read_b128 v[120:123], v237 offset:2048
    ds_read_b128 v[124:127], v237 offset:3072
    ds_read_b128 v[128:131], v238 offset:4096
    ds_read_b128 v[132:135], v238 offset:5120
    ds_read_b128 v[136:139], v238 offset:6144
    ds_read_b128 v[140:143], v238 offset:7168
    ds_read_b128 v[144:147], v239 offset:8192
    ds_read_b128 v[148:151], v239 offset:9216
    ds_read_b128 v[152:155], v239 offset:10240
    ds_read_b128 v[156:159], v239 offset:11264
    buffer_store_dword v199, off, s[8:11], s66 sc1
    v_bfe_u32 v224, v0, 2, 2
    v_lshrrev_b32 v225, 5, v0
    v_lshl_add_u32 v225, v225, 2, v224
    v_lshlrev_b32 v225, 8, v225
    v_lshl_add_u32 v225, v224, 6, v225
    v_and_b32 v224, 3, v0
    v_lshl_add_u32 v225, v224, 3, v225
    v_and_b32 v224, 16, v0
    v_lshl_add_u32 v225, v224, 1, v225
    v_add_u32 v184, 49152, v225
    v_xor_b32 v185, 64, v184
    v_xor_b32 v186, 128, v184
    v_xor_b32 v187, 192, v184
    v_add_u32 v188, 0x10000, v184
    v_add_u32 v189, 0x10000, v185
    v_add_u32 v190, 0x10000, v186
    v_add_u32 v191, 0x10000, v187
    s_lshl_b32 s67, s3, 6
    v_xor_b32 v182, s67, v184
    v_add_u32 v183, 0x10000, v182
    s_mov_b32 s28, s7
    s_add_u32 s29, s7, 4096
    s_add_u32 s30, s7, 32768
    s_add_u32 s31, s7, 36864
    v_lshlrev_b32 v242, 3, v0
    s_and_b32 s20, s2, 7
    s_lshl_b32 s20, s20, 9
    s_add_u32 s20, s20, 0x1172000
    s_add_u32 s21, s57, 28672
    v_and_b32 v224, 31, v0
    v_lshrrev_b32 v225, 5, v0
    v_lshlrev_b32 v224, 6, v224
    v_lshl_add_u32 v243, v225, 5, v224
    v_add_u32 v3, 114688, v1
    v_mov_b32 v8, 0x3f803f80
    v_mov_b32 v9, 0x3f803f80
    v_mov_b32 v10, 0x3f803f80
    v_mov_b32 v11, 0x3f803f80
    v_cmp_ne_u32 vcc, s40, v16
    s_cbranch_vccnz C_t2
C_t2_ok:
    v_mov_b32 v192, 0
    v_mov_b32 v193, 0
    v_mov_b32 v194, 0
    v_mov_b32 v195, 0
    s_mov_b32 s72, 0x21800000
    s_mov_b32 s73, 0x5d800000
    s_waitcnt lgkmcnt(11)
    v_pk_add_f32 v[96:97], v[96:97], v[112:113]
    v_pk_add_f32 v[98:99], v[98:99], v[114:115]
    s_waitcnt lgkmcnt(10)
    v_pk_add_f32 v[100:101], v[100:101], v[116:117]
    v_pk_add_f32 v[102:103], v[102:103], v[118:119]
    s_waitcnt lgkmcnt(9)
    v_pk_add_f32 v[104:105], v[104:105], v[120:121]
    v_pk_add_f32 v[106:107], v[106:107], v[122:123]
    s_waitcnt lgkmcnt(8)
    v_pk_add_f32 v[108:109], v[108:109], v[124:125]
    v_pk_add_f32 v[110:111], v[110:111], v[126:127]
    s_waitcnt lgkmcnt(7)
    v_pk_add_f32 v[96:97], v[96:97], v[128:129]
    v_pk_add_f32 v[98:99], v[98:99], v[130:131]
    s_waitcnt lgkmcnt(6)
    v_pk_add_f32 v[100:101], v[100:101], v[132:133]
    v_pk_add_f32 v[102:103], v[102:103], v[134:135]
    s_waitcnt lgkmcnt(5)
    v_pk_add_f32 v[104:105], v[104:105], v[136:137]
    v_pk_add_f32 v[106:107], v[106:107], v[138:139]
    s_waitcnt lgkmcnt(4)
    v_pk_add_f32 v[108:109], v[108:109], v[140:141]
    v_pk_add_f32 v[110:111], v[110:111], v[142:143]
    s_waitcnt lgkmcnt(3)
    v_pk_add_f32 v[96:97], v[96:97], v[144:145]
    v_pk_add_f32 v[98:99], v[98:99], v[146:147]
    s_waitcnt lgkmcnt(2)
    v_pk_add_f32 v[100:101], v[100:101], v[148:149]
    v_pk_add_f32 v[102:103], v[102:103], v[150:151]
    s_waitcnt lgkmcnt(1)
    v_pk_add_f32 v[104:105], v[104:105], v[152:153]
    v_pk_add_f32 v[106:107], v[106:107], v[154:155]
    s_waitcnt lgkmcnt(0)
    v_pk_add_f32 v[108:109], v[108:109], v[156:157]
    v_pk_add_f32 v[110:111], v[110:111], v[158:159]
    v_mov_b32 v196, v108
    v_mov_b32 v197, v108
    v_pk_fma_f32 v[194:195], v[96:97], v[192:193], v[194:195]
    v_pk_fma_f32 v[194:195], v[98:99], v[192:193], v[194:195]
    v_permlane32_swap_b32 v196, v197
    v_pk_fma_f32 v[194:195], v[100:101], v[192:193], v[194:195]
    v_pk_fma_f32 v[194:195], v[102:103], v[192:193], v[194:195]
    v_rcp_f32 v198, v197
    v_pk_fma_f32 v[194:195], v[104:105], v[192:193], v[194:195]
    v_pk_fma_f32 v[194:195], v[106:107], v[192:193], v[194:195]
    v_pk_fma_f32 v[194:195], v[108:109], v[192:193], v[194:195]
    v_pk_fma_f32 v[194:195], v[110:111], v[192:193], v[194:195]
    v_add_f32 v194, v194, v195
    v_add_f32 v194, v194, v197
    v_cmp_le_f32 vcc, s72, v194
    v_cmp_ge_f32 s[72:73], s73, v194
    s_nop 3
    s_and_b64 vcc, vcc, s[72:73]
    s_cmp_eq_u64 vcc, -1
    s_cbranch_scc0 B_slow
B_fin:
    v_pk_mul_f32 v[96:97], v[96:97], v[198:199] op_sel_hi:[1,0]
    v_pk_mul_f32 v[98:99], v[98:99], v[198:199] op_sel_hi:[1,0]
    v_pk_mul_f32 v[100:101], v[100:101], v[198:199] op_sel_hi:[1,0]
    v_pk_mul_f32 v[102:103], v[102:103], v[198:199] op_sel_hi:[1,0]
    v_pk_mul_f32 v[104:105], v[104:105], v[198:199] op_sel_hi:[1,0]
    v_pk_mul_f32 v[106:107], v[106:107], v[198:199] op_sel_hi:[1,0]
    v_pk_mul_f32 v[108:109], v[108:109], v[198:199] op_sel_hi:[1,0]
    v_pk_mul_f32 v[110:111], v[110:111], v[198:199] op_sel_hi:[1,0]
    v_cvt_pk_bf16_f32 v160, v96, v97
    v_cvt_pk_bf16_f32 v161, v98, v99
    v_cvt_pk_bf16_f32 v162, v100, v101
    v_cvt_pk_bf16_f32 v163, v102, v103
    v_cvt_pk_bf16_f32 v164, v104, v105
    v_cvt_pk_bf16_f32 v165, v106, v107
    v_cvt_pk_bf16_f32 v166, v108, v109
    v_cvt_pk_bf16_f32 v167, v110, v111
    v_min_u32 v160, -2, v160
    v_min_u32 v164, -2, v164
    s_mov_b32 exec_lo, 0
    v_mov_b32 v166, 0
    v_mov_b32 v167, 0
    s_mov_b32 exec_lo, -1
    buffer_store_dwordx4 v[160:163], v1, s[8:11], s50 offen offset:0 sc1
    buffer_store_dwordx4 v[164:167], v1, s[8:11], s50 offen offset:1024 sc1
    s_cmp_ge_u32 s43, 28
    s_cbranch_scc1 P_ep
    ds_read_b64_tr_b16 v[128:129], v182 offset:0
    ds_read_b64_tr_b16 v[130:131], v182 offset:2048
    ds_read_b64_tr_b16 v[132:133], v182 offset:4096
    ds_read_b64_tr_b16 v[134:135], v182 offset:6144
    ds_read_b64_tr_b16 v[136:137], v182 offset:8192
    ds_read_b64_tr_b16 v[138:139], v182 offset:10240
    ds_read_b64_tr_b16 v[140:141], v182 offset:12288
    ds_read_b64_tr_b16 v[142:143], v182 offset:14336
    ds_read_b64_tr_b16 v[144:145], v182 offset:16384
    ds_read_b64_tr_b16 v[146:147], v182 offset:18432
    s_barrier
    s_waitcnt lgkmcnt(8)
    v_mfma_f32_32x32x16_bf16 v[112:127], v[8:11], v[128:131], 0
    s_add_u32 m0, s51, 0
    s_nop 0
    buffer_load_dwordx4 v2, s[24:27], s52 offen offset:0 lds
    ds_read_b64_tr_b16 v[148:149], v182 offset:20480
    ds_read_b64_tr_b16 v[150:151], v182 offset:22528
    s_waitcnt lgkmcnt(8)
    v_mfma_f32_32x32x16_bf16 v[112:127], v[8:11], v[132:135], v[112:127]
    v_permlane32_swap_b32 v244, v246
    v_permlane32_swap_b32 v245, v247
    s_mul_i32 s12, s63, 28672
    s_add_u32 s12, s12, 0x800000
    ds_read_b64_tr_b16 v[152:153], v182 offset:24576
    ds_read_b64_tr_b16 v[154:155], v182 offset:26624
    s_waitcnt lgkmcnt(8)
    v_mfma_f32_32x32x16_bf16 v[112:127], v[8:11], v[136:139], v[112:127]
    buffer_load_dwordx4 v13, s[24:27], s52 offen offset:1024 lds
    ds_read_b64_tr_b16 v[156:157], v182 offset:28672
    ds_read_b64_tr_b16 v[158:159], v182 offset:30720
    s_waitcnt lgkmcnt(8)
    v_mfma_f32_32x32x16_bf16 v[112:127], v[8:11], v[140:143], v[112:127]
    v_permlane32_swap_b32 v248, v250
    v_permlane32_swap_b32 v249, v251
    s_add_u32 s13, s12, 4096
    s_add_u32 s14, s13, 4096
    ds_read_b64_tr_b16 v[128:129], v182 offset:32768
    ds_read_b64_tr_b16 v[130:131], v182 offset:34816
    s_waitcnt lgkmcnt(8)
    v_mfma_f32_32x32x16_bf16 v[112:127], v[8:11], v[144:147], v[112:127]
    buffer_load_dwordx4 v14, s[24:27], s52 offen offset:2048 lds
    ds_read_b64_tr_b16 v[132:133], v182 offset:36864
    ds_read_b64_tr_b16 v[134:135], v182 offset:38912
    s_waitcnt lgkmcnt(8)
    v_mfma_f32_32x32x16_bf16 v[112:127], v[8:11], v[148:151], v[112:127]
    v_permlane32_swap_b32 v232, v234
    v_permlane32_swap_b32 v233, v235
    s_add_u32 s15, s14, 4096
    s_add_u32 s16, s15, 4096
    ds_read_b64_tr_b16 v[136:137], v182 offset:40960
    ds_read_b64_tr_b16 v[138:139], v182 offset:43008
    s_waitcnt lgkmcnt(8)
    v_mfma_f32_32x32x16_bf16 v[112:127], v[8:11], v[152:155], v[112:127]
    buffer_load_dwordx4 v15, s[24:27], s52 offen offset:3072 lds
    s_add_u32 s52, s52, 458752
    s_cmp_ge_u32 s52, 1605632
    s_cselect_b32 s75, 1576960, 0
    s_sub_u32 s52, s52, s75
    ds_read_b64_tr_b16 v[140:141], v182 offset:45056
    ds_read_b64_tr_b16 v[142:143], v182 offset:47104
    s_waitcnt lgkmcnt(8)
    v_mfma_f32_32x32x16_bf16 v[112:127], v[8:11], v[156:159], v[112:127]
    v_lshlrev_b32 v96, 16, v244
    v_and_b32 v97, s42, v244
    s_add_u32 s17, s16, 4096
    s_add_u32 s18, s17, 4096
    ds_read_b64_tr_b16 v[144:145], v182 offset:49152
    ds_read_b64_tr_b16 v[146:147], v182 offset:51200
    s_waitcnt lgkmcnt(8)
    v_mfma_f32_32x32x16_bf16 v[112:127], v[8:11], v[128:131], v[112:127]
    s_add_u32 m0, s51, 4096
    s_nop 0
    buffer_load_dwordx4 v2, s[24:27], s52 offen offset:0 lds
    ds_read_b64_tr_b16 v[148:149], v182 offset:53248
    ds_read_b64_tr_b16 v[150:151], v182 offset:55296
    s_waitcnt lgkmcnt(8)
    v_mfma_f32_32x32x16_bf16 v[112:127], v[8:11], v[132:135], v[112:127]
    v_lshlrev_b32 v98, 16, v245
    v_and_b32 v99, s42, v245
    s_lshl_b32 s36, s63, 11
    s_add_u32 s36, s36, 0x1100000
    ds_read_b64_tr_b16 v[152:153], v182 offset:57344
    ds_read_b64_tr_b16 v[154:155], v182 offset:59392
    s_waitcnt lgkmcnt(8)
    v_mfma_f32_32x32x16_bf16 v[112:127], v[8:11], v[136:139], v[112:127]
    buffer_load_dwordx4 v13, s[24:27], s52 offen offset:1024 lds
    ds_read_b64_tr_b16 v[156:157], v182 offset:61440
    ds_read_b64_tr_b16 v[158:159], v182 offset:63488
    s_waitcnt lgkmcnt(8)
    v_mfma_f32_32x32x16_bf16 v[112:127], v[8:11], v[140:143], v[112:127]
    v_lshlrev_b32 v100, 16, v246
    v_and_b32 v101, s42, v246
    s_add_u32 s37, s58, 4096
    s_mul_i32 s44, s61, 229376
    ds_read_b64_tr_b16 v[128:129], v183 offset:0
    ds_read_b64_tr_b16 v[130:131], v183 offset:2048
    s_waitcnt lgkmcnt(8)
    v_mfma_f32_32x32x16_bf16 v[112:127], v[8:11], v[144:147], v[112:127]
    buffer_load_dwordx4 v14, s[24:27], s52 offen offset:2048 lds
    ds_read_b64_tr_b16 v[132:133], v183 offset:4096
    ds_read_b64_tr_b16 v[134:135], v183 offset:6144
    s_waitcnt lgkmcnt(8)
    v_mfma_f32_32x32x16_bf16 v[112:127], v[8:11], v[148:151], v[112:127]
    v_lshlrev_b32 v102, 16, v247
    v_and_b32 v103, s42, v247
    s_add_u32 s44, s44, 0xa00000
    s_add_u32 s39, s44, 114688
    ds_read_b64_tr_b16 v[136:137], v183 offset:8192
    ds_read_b64_tr_b16 v[138:139], v183 offset:10240
    s_waitcnt lgkmcnt(8)
    v_mfma_f32_32x32x16_bf16 v[112:127], v[8:11], v[152:155], v[112:127]
    buffer_load_dwordx4 v15, s[24:27], s52 offen offset:3072 lds
    s_add_u32 s52, s52, 458752
    s_cmp_ge_u32 s52, 1605632
    s_cselect_b32 s75, 1576960, 0
    s_sub_u32 s52, s52, s75
    ds_read_b64_tr_b16 v[140:141], v183 offset:12288
    ds_read_b64_tr_b16 v[142:143], v183 offset:14336
    s_waitcnt lgkmcnt(8)
    v_mfma_f32_32x32x16_bf16 v[112:127], v[8:11], v[156:159], v[112:127]
    v_lshlrev_b32 v104, 16, v248
    v_and_b32 v105, s42, v248
    s_lshl_b32 s66, s3, 13
    s_add_u32 s44, s44, s66
    s_add_u32 s45, s44, 32768
    ds_read_b64_tr_b16 v[144:145], v183 offset:16384
    ds_read_b64_tr_b16 v[146:147], v183 offset:18432
    s_waitcnt lgkmcnt(8)
    v_mfma_f32_32x32x16_bf16 v[112:127], v[8:11], v[128:131], v[112:127]
    s_add_u32 m0, s51, 8192
    s_nop 0
    buffer_load_dwordx4 v2, s[24:27], s52 offen offset:0 lds
    ds_read_b64_tr_b16 v[148:149], v183 offset:20480
    ds_read_b64_tr_b16 v[150:151], v183 offset:22528
    s_waitcnt lgkmcnt(8)
    v_mfma_f32_32x32x16_bf16 v[112:127], v[8:11], v[132:135], v[112:127]
    v_lshlrev_b32 v106, 16, v249
    v_and_b32 v107, s42, v249
    s_cmp_ge_u32 s45, s39
    s_cselect_b32 s66, 112640, 0
    s_sub_u32 s45, s45, s66
    s_add_u32 s46, s45, 32768
    ds_read_b64_tr_b16 v[152:153], v183 offset:24576
    ds_read_b64_tr_b16 v[154:155], v183 offset:26624
    s_waitcnt lgkmcnt(8)
    v_mfma_f32_32x32x16_bf16 v[112:127], v[8:11], v[136:139], v[112:127]
    buffer_load_dwordx4 v13, s[24:27], s52 offen offset:1024 lds
    ds_read_b64_tr_b16 v[156:157], v183 offset:28672
    ds_read_b64_tr_b16 v[158:159], v183 offset:30720
    s_waitcnt lgkmcnt(8)
    v_mfma_f32_32x32x16_bf16 v[112:127], v[8:11], v[140:143], v[112:127]
    v_lshlrev_b32 v108, 16, v250
    v_and_b32 v109, s42, v250
    s_cmp_ge_u32 s46, s39
    s_cselect_b32 s66, 112640, 0
    s_sub_u32 s46, s46, s66
    s_add_u32 s47, s46, 32768
    ds_read_b64_tr_b16 v[128:129], v183 offset:32768
    ds_read_b64_tr_b16 v[130:131], v183 offset:34816
    s_waitcnt lgkmcnt(8)
    v_mfma_f32_32x32x16_bf16 v[112:127], v[8:11], v[144:147], v[112:127]
    buffer_load_dwordx4 v14, s[24:27], s52 offen offset:2048 lds
    ds_read_b64_tr_b16 v[132:133], v183 offset:36864
    ds_read_b64_tr_b16 v[134:135], v183 offset:38912
    s_waitcnt lgkmcnt(8)
    v_mfma_f32_32x32x16_bf16 v[112:127], v[8:11], v[148:151], v[112:127]
    v_lshlrev_b32 v110, 16, v251
    v_and_b32 v111, s42, v251
    s_cmp_ge_u32 s47, s39
    s_cselect_b32 s66, 112640, 0
    s_sub_u32 s47, s47, s66
    s_add_u32 s48, s47, 32768
    ds_read_b64_tr_b16 v[136:137], v183 offset:40960
    ds_read_b64_tr_b16 v[138:139], v183 offset:43008
    s_waitcnt lgkmcnt(8)
    v_mfma_f32_32x32x16_bf16 v[112:127], v[8:11], v[152:155], v[112:127]
    buffer_load_dwordx4 v15, s[24:27], s52 offen offset:3072 lds
    s_add_u32 s52, s52, 458752
    s_cmp_ge_u32 s52, 1605632
    s_cselect_b32 s75, 1576960, 0
    s_sub_u32 s52, s52, s75
    ds_read_b64_tr_b16 v[140:141], v183 offset:45056
    ds_read_b64_tr_b16 v[142:143], v183 offset:47104
    s_waitcnt lgkmcnt(8)
    v_mfma_f32_32x32x16_bf16 v[112:127], v[8:11], v[156:159], v[112:127]
    s_cmp_ge_u32 s48, s39
    s_cselect_b32 s66, 112640, 0
    s_sub_u32 s48, s48, s66
    s_add_u32 s49, s48, 32768
    s_waitcnt lgkmcnt(6)
    v_mfma_f32_32x32x16_bf16 v[112:127], v[8:11], v[128:131], v[112:127]
    buffer_load_dwordx4 v[16:19], v1, s[8:11], s28 offen offset:0 sc1
    s_waitcnt lgkmcnt(4)
    v_mfma_f32_32x32x16_bf16 v[112:127], v[8:11], v[132:135], v[112:127]
    buffer_load_dwordx4 v[20:23], v1, s[8:11], s28 offen offset:1024 sc1
    s_waitcnt lgkmcnt(2)
    v_mfma_f32_32x32x16_bf16 v[112:127], v[8:11], v[136:139], v[112:127]
    buffer_load_dwordx4 v[24:27], v1, s[8:11], s30 offen offset:0 sc1
    s_waitcnt lgkmcnt(0)
    v_mfma_f32_32x32x16_bf16 v[112:127], v[8:11], v[140:143], v[112:127]
    buffer_load_dwordx4 v[28:31], v1, s[8:11], s30 offen offset:1024 sc1
    buffer_load_dwordx4 v[32:35], v1, s[8:11], s28 offen offset:2048 sc1
    s_cmp_ge_u32 s49, s39
    s_cselect_b32 s66, 112640, 0
    s_sub_u32 s49, s49, s66
    s_add_u32 s50, s49, 32768
    s_cmp_ge_u32 s50, s39
    s_cselect_b32 s66, 112640, 0
    s_sub_u32 s50, s50, s66
    s_add_u32 s53, s50, 32768
    s_cmp_ge_u32 s53, s39
    s_cselect_b32 s66, 112640, 0
    s_sub_u32 s53, s53, s66
    s_add_u32 s54, s53, 32768
    buffer_load_dwordx4 v[36:39], v1, s[8:11], s28 offen offset:3072 sc1
    s_cmp_ge_u32 s54, s39
    s_cselect_b32 s66, 112640, 0
    s_sub_u32 s54, s54, s66
    s_add_u32 s55, s54, 32768
    s_cmp_ge_u32 s55, s39
    s_cselect_b32 s66, 112640, 0
    s_sub_u32 s55, s55, s66
    s_add_u32 s56, s55, 32768
    s_cmp_ge_u32 s56, s39
    s_cselect_b32 s66, 112640, 0
    s_sub_u32 s56, s56, s66
    s_add_u32 s60, s56, 32768
    buffer_load_dwordx4 v[40:43], v1, s[8:11], s30 offen offset:2048 sc1
    s_cmp_ge_u32 s60, s39
    s_cselect_b32 s66, 112640, 0
    s_sub_u32 s60, s60, s66
    s_add_u32 s65, s60, 32768
    s_cmp_ge_u32 s65, s39
    s_cselect_b32 s66, 112640, 0
    s_sub_u32 s65, s65, s66
    s_add_u32 s6, s65, 32768
    s_cmp_ge_u32 s6, s39
    s_cselect_b32 s66, 112640, 0
    s_sub_u32 s6, s6, s66
    s_waitcnt vmcnt(15)
    ds_read_b64_tr_b16 a[208:209], v4 offset:0
    buffer_load_dwordx4 v[44:47], v1, s[8:11], s30 offen offset:3072 sc1
    ds_read_b64_tr_b16 a[210:211], v4 offset:1024
    ds_read_b64_tr_b16 a[212:213], v5 offset:0
    ds_read_b64_tr_b16 a[214:215], v5 offset:1024
    ds_read_b64_tr_b16 a[216:217], v4 offset:2048
    ds_read_b64_tr_b16 a[218:219], v4 offset:3072
    ds_read_b64_tr_b16 a[220:221], v5 offset:2048
    buffer_load_dwordx4 v[48:51], v1, s[8:11], s29 offen offset:0 sc1
    ds_read_b64_tr_b16 a[222:223], v5 offset:3072
    v_lshlrev_b32 v220, 16, v176
    v_mov_b32 v218, v176
    v_mov_b32 v219, 0
    v_cvt_pk_bf16_f32 v216, v112, v112
    v_and_b32 v221, s42, v216
    buffer_load_dwordx4 v[52:55], v1, s[8:11], s29 offen offset:1024 sc1
    v_sub_f32 v221, v112, v221
    v_cvt_pk_bf16_f32 v217, v221, v220
    s_mov_b32 exec_lo, 0
    v_mov_b32 v216, 0
    v_mov_b32 v217, 0
    v_mov_b32 v218, 0
    s_mov_b32 exec_lo, -1
    s_waitcnt vmcnt(14)
    ds_read_b64_tr_b16 a[224:225], v4 offset:4096
    ds_read_b64_tr_b16 a[226:227], v4 offset:5120
    ds_read_b64_tr_b16 a[228:229], v5 offset:4096
    buffer_load_dwordx4 v[56:59], v1, s[8:11], s31 offen offset:0 sc1
    ds_read_b64_tr_b16 a[230:231], v5 offset:5120
    ds_read_b64_tr_b16 a[232:233], v4 offset:6144
    ds_read_b64_tr_b16 a[234:235], v4 offset:7168
    ds_read_b64_tr_b16 a[236:237], v5 offset:6144
    ds_read_b64_tr_b16 a[238:239], v5 offset:7168
    s_waitcnt vmcnt(11)
    ds_read_b64_tr_b16 a[240:241], v4 offset:8192
    buffer_load_dwordx4 v[60:63], v1, s[8:11], s31 offen offset:1024 sc1
    ds_read_b64_tr_b16 a[242:243], v4 offset:9216
    ds_read_b64_tr_b16 a[244:245], v5 offset:8192
    ds_read_b64_tr_b16 a[246:247], v5 offset:9216
    s_waitcnt vmcnt(9)
    v_max3_u32 v7, v16, v20, v24
    s_waitcnt vmcnt(8)
    v_max_u32 v7, v28, v7
    v_cmp_eq_u32 vcc, -1, v7
    ds_read_b64_tr_b16 a[248:249], v4 offset:10240
    ds_read_b64_tr_b16 a[250:251], v4 offset:11264
    ds_read_b64_tr_b16 a[252:253], v5 offset:10240
    ds_read_b64_tr_b16 a[254:255], v5 offset:11264
    s_cbranch_vccnz C_r0
C_r0_ok:
    v_mfma_f32_32x32x16_bf16 v[112:127], a[4:7], v[16:19], 0
    buffer_load_dwordx4 v[64:67], v1, s[8:11], s29 offen offset:2048 sc1
    v_mfma_f32_32x32x16_bf16 v[160:175], a[4:7], v[24:27], 0
    v_mfma_f32_32x32x16_bf16 v[128:143], a[0:3], v[16:19], 0
    buffer_load_dwordx4 v[68:71], v1, s[8:11], s29 offen offset:3072 sc1
    v_mfma_f32_32x32x16_bf16 v[144:159], a[0:3], v[24:27], 0
    v_mfma_f32_32x32x16_bf16 v[112:127], a[12:15], v[20:23], v[112:127]
    buffer_load_dwordx4 v[72:75], v1, s[8:11], s31 offen offset:2048 sc1
    v_mfma_f32_32x32x16_bf16 v[160:175], a[12:15], v[28:31], v[160:175]
    v_mfma_f32_32x32x16_bf16 v[128:143], a[8:11], v[20:23], v[128:143]
    s_waitcnt vmcnt(8)
    v_max3_u32 v7, v32, v36, v40
    s_waitcnt vmcnt(7)
    v_max_u32 v7, v44, v7
    v_cmp_eq_u32 vcc, -1, v7
    v_mfma_f32_32x32x16_bf16 v[144:159], a[8:11], v[28:31], v[144:159]
    s_cbranch_vccnz C_r1
C_r1_ok:
    v_mfma_f32_32x32x16_bf16 v[112:127], a[20:23], v[32:35], v[112:127]
    buffer_load_dwordx4 v[76:79], v1, s[8:11], s31 offen offset:3072 sc1
    v_mfma_f32_32x32x16_bf16 v[160:175], a[20:23], v[40:43], v[160:175]
    v_mfma_f32_32x32x16_bf16 v[128:143], a[16:19], v[32:35], v[128:143]
    buffer_load_dwordx2 v[240:241], v242, s[8:11], s20 offen sc1
    v_mfma_f32_32x32x16_bf16 v[144:159], a[16:19], v[40:43], v[144:159]
    v_mfma_f32_32x32x16_bf16 v[112:127], a[28:31], v[36:39], v[112:127]
    v_mfma_f32_32x32x16_bf16 v[160:175], a[28:31], v[44:47], v[160:175]
    v_mfma_f32_32x32x16_bf16 v[128:143], a[24:27], v[36:39], v[128:143]
    s_waitcnt vmcnt(6)
    v_max3_u32 v7, v48, v52, v56
    s_waitcnt vmcnt(5)
    v_max_u32 v7, v60, v7
    v_cmp_eq_u32 vcc, -1, v7
    v_mfma_f32_32x32x16_bf16 v[144:159], a[24:27], v[44:47], v[144:159]
    s_cbranch_vccnz C_r2
C_r2_ok:
    v_mfma_f32_32x32x16_bf16 v[112:127], a[36:39], v[48:51], v[112:127]
    v_mfma_f32_32x32x16_bf16 v[160:175], a[36:39], v[56:59], v[160:175]
    v_mfma_f32_32x32x16_bf16 v[128:143], a[32:35], v[48:51], v[128:143]
    v_mfma_f32_32x32x16_bf16 v[144:159], a[32:35], v[56:59], v[144:159]
    v_mfma_f32_32x32x16_bf16 v[112:127], a[44:47], v[52:55], v[112:127]
    v_mfma_f32_32x32x16_bf16 v[160:175], a[44:47], v[60:63], v[160:175]
    v_mfma_f32_32x32x16_bf16 v[128:143], a[40:43], v[52:55], v[128:143]
    s_waitcnt vmcnt(2)
    v_max3_u32 v7, v64, v68, v72
    s_waitcnt vmcnt(1)
    v_max_u32 v7, v76, v7
    v_cmp_eq_u32 vcc, -1, v7
    v_mfma_f32_32x32x16_bf16 v[144:159], a[40:43], v[60:63], v[144:159]
    s_cbranch_vccnz C_r3
C_r3_ok:
    v_mfma_f32_32x32x16_bf16 v[112:127], a[52:55], v[64:67], v[112:127]
    s_waitcnt vmcnt(0)
    v_xor_b32 v220, s74, v240
    v_xor_b32 v221, s74, v241
    v_or_b32 v220, v220, v221
    v_cmp_ne_u32 vcc, 0, v220
    v_subrev_u32 v220, s40, v240
    v_subrev_u32 v221, s40, v241
    v_max_u32 v220, v220, v221
    v_mfma_f32_32x32x16_bf16 v[160:175], a[52:55], v[72:75], v[160:175]
    s_cmp_eq_u64 vcc, 0
    s_cselect_b32 s73, 1, 0
    v_cmp_lt_u32 vcc, 7, v220
    v_mfma_f32_32x32x16_bf16 v[112:127], a[60:63], v[68:71], v[112:127]
    s_cbranch_vccnz C_t3
C_t3_ok:
    v_mfma_f32_32x32x16_bf16 v[160:175], a[60:63], v[76:79], v[160:175]
    v_mfma_f32_32x32x16_bf16 v[128:143], a[48:51], v[64:67], v[128:143]
    v_mfma_f32_32x32x16_bf16 v[144:159], a[48:51], v[72:75], v[144:159]
    s_nop 7
    ds_write_b128 v6, v[112:115] offset:0
    ds_write_b128 v6, v[116:119] offset:1024
    ds_write_b128 v6, v[120:123] offset:8192
    v_mfma_f32_32x32x16_bf16 v[128:143], a[56:59], v[68:71], v[128:143]
    ds_write_b128 v6, v[124:127] offset:9216
    ds_write_b128 v6, v[160:163] offset:2048
    ds_write_b128 v6, v[164:167] offset:3072
    v_mfma_f32_32x32x16_bf16 v[144:159], a[56:59], v[76:79], v[144:159]
    ds_write_b128 v6, v[168:171] offset:10240
    ds_write_b128 v6, v[172:175] offset:11264
    s_nop 5
    ds_write_b128 v6, v[136:139] offset:4096
    ds_write_b128 v6, v[140:143] offset:5120
    s_nop 1
    ds_write_b128 v6, v[152:155] offset:6144
    ds_write_b128 v6, v[156:159] offset:7168
    v_pk_add_f32 v[128:129], v[128:129], v[96:97]
    v_pk_add_f32 v[130:131], v[130:131], v[98:99]
    v_pk_add_f32 v[132:133], v[132:133], v[100:101]
    v_pk_add_f32 v[134:135], v[134:135], v[102:103]
    v_pk_add_f32 v[144:145], v[144:145], v[104:105]
    v_pk_add_f32 v[146:147], v[146:147], v[106:107]
    v_pk_add_f32 v[148:149], v[148:149], v[108:109]
    v_pk_add_f32 v[150:151], v[150:151], v[110:111]
    s_waitcnt lgkmcnt(0)
    s_barrier
    ds_read_b128 v[16:19], v237 offset:0
    ds_read_b128 v[20:23], v237 offset:1024
    ds_read_b128 v[32:35], v238 offset:4096
    ds_read_b128 v[36:39], v238 offset:5120
    ds_read_b128 v[48:51], v239 offset:8192
    ds_read_b128 v[52:55], v239 offset:9216
    ds_read_b128 v[24:27], v237 offset:2048
    ds_read_b128 v[28:31], v237 offset:3072
    ds_read_b128 v[40:43], v238 offset:6144
    ds_read_b128 v[44:47], v238 offset:7168
    ds_read_b128 v[56:59], v239 offset:10240
    ds_read_b128 v[60:63], v239 offset:11264
    s_waitcnt lgkmcnt(11)
    v_pk_add_f32 v[128:129], v[128:129], v[16:17]
    v_pk_add_f32 v[130:131], v[130:131], v[18:19]
    s_waitcnt lgkmcnt(10)
    v_pk_add_f32 v[132:133], v[132:133], v[20:21]
    v_pk_add_f32 v[134:135], v[134:135], v[22:23]
    s_waitcnt lgkmcnt(9)
    v_pk_add_f32 v[128:129], v[128:129], v[32:33]
    v_pk_add_f32 v[130:131], v[130:131], v[34:35]
    s_waitcnt lgkmcnt(8)
    v_pk_add_f32 v[132:133], v[132:133], v[36:37]
    v_pk_add_f32 v[134:135], v[134:135], v[38:39]
    s_waitcnt lgkmcnt(7)
    v_pk_add_f32 v[128:129], v[128:129], v[48:49]
    v_pk_add_f32 v[130:131], v[130:131], v[50:51]
    s_waitcnt lgkmcnt(6)
    v_pk_add_f32 v[132:133], v[132:133], v[52:53]
    v_pk_add_f32 v[134:135], v[134:135], v[54:55]
    s_cmp_eq_u32 s73, 0
    v_cvt_pk_bf16_f32 v244, v128, v129
    v_cvt_pk_bf16_f32 v245, v130, v131
    v_cvt_pk_bf16_f32 v246, v132, v133
    v_cvt_pk_bf16_f32 v247, v134, v135
    v_min_u32 v244, -2, v244
    s_cbranch_scc1 C_sh0
    buffer_store_dwordx4 v[244:247], v1, s[8:11], s57 offen
C_sh0_ok:
    s_waitcnt lgkmcnt(5)
    v_pk_add_f32 v[144:145], v[144:145], v[24:25]
    v_pk_add_f32 v[146:147], v[146:147], v[26:27]
    s_waitcnt lgkmcnt(4)
    v_pk_add_f32 v[148:149], v[148:149], v[28:29]
    v_pk_add_f32 v[150:151], v[150:151], v[30:31]
    s_waitcnt lgkmcnt(3)
    v_pk_add_f32 v[144:145], v[144:145], v[40:41]
    v_pk_add_f32 v[146:147], v[146:147], v[42:43]
    s_waitcnt lgkmcnt(2)
    v_pk_add_f32 v[148:149], v[148:149], v[44:45]
    v_pk_add_f32 v[150:151], v[150:151], v[46:47]
    s_waitcnt lgkmcnt(1)
    v_pk_add_f32 v[144:145], v[144:145], v[56:57]
    v_pk_add_f32 v[146:147], v[146:147], v[58:59]
    s_waitcnt lgkmcnt(0)
    v_pk_add_f32 v[148:149], v[148:149], v[60:61]
    v_pk_add_f32 v[150:151], v[150:151], v[62:63]
    s_cmp_eq_u32 s73, 0
    v_cvt_pk_bf16_f32 v248, v144, v145
    v_cvt_pk_bf16_f32 v249, v146, v147
    v_cvt_pk_bf16_f32 v250, v148, v149
    v_cvt_pk_bf16_f32 v251, v150, v151
    v_min_u32 v248, -2, v248
    s_cbranch_scc1 C_sh1
    buffer_store_dwordx4 v[248:251], v1, s[8:11], s21 offen
C_sh1_ok:
    s_barrier
    s_add_u32 m0, s51, 0
    s_nop 0
    buffer_load_dwordx4 v2, s[24:27], s52 offen offset:0 lds
    v_pk_add_f32 v[224:225], v[128:129], v[130:131]
    v_pk_mul_f32 v[226:227], v[128:129], v[128:129]
    v_pk_fma_f32 v[226:227], v[130:131], v[130:131], v[226:227]
    v_pk_add_f32 v[224:225], v[224:225], v[132:133]
    v_pk_fma_f32 v[226:227], v[132:133], v[132:133], v[226:227]
    buffer_load_dwordx4 v13, s[24:27], s52 offen offset:1024 lds
    v_pk_add_f32 v[224:225], v[224:225], v[134:135]
    v_pk_fma_f32 v[226:227], v[134:135], v[134:135], v[226:227]
    v_pk_add_f32 v[228:229], v[144:145], v[146:147]
    v_pk_mul_f32 v[230:231], v[144:145], v[144:145]
    v_pk_fma_f32 v[230:231], v[146:147], v[146:147], v[230:231]
    buffer_load_dwordx4 v14, s[24:27], s52 offen offset:2048 lds
    v_pk_add_f32 v[228:229], v[228:229], v[148:149]
    v_pk_fma_f32 v[230:231], v[148:149], v[148:149], v[230:231]
    v_pk_add_f32 v[228:229], v[228:229], v[150:151]
    v_pk_fma_f32 v[230:231], v[150:151], v[150:151], v[230:231]
    v_add_f32 v224, v224, v225
    buffer_load_dwordx4 v15, s[24:27], s52 offen offset:3072 lds
    s_add_u32 s52, s52, 458752
    s_cmp_ge_u32 s52, 1605632
    s_cselect_b32 s75, 1576960, 0
    s_sub_u32 s52, s52, s75
    v_add_f32 v225, v226, v227
    v_add_f32 v226, v228, v229
    v_add_f32 v227, v230, v231
    s_lshl_b32 s66, s3, 9
    v_add_u32 v228, s66, v242
    v_permlane32_swap_b32 v224, v226
    s_add_u32 m0, s51, 4096
    s_nop 0
    buffer_load_dwordx4 v2, s[24:27], s52 offen offset:0 lds
    v_permlane32_swap_b32 v225, v227
    v_pk_add_f32 v[224:225], v[224:225], v[226:227]
    ds_write_b64 v228, v[224:225] offset:8192
    ds_write_b128 v6, v[216:219] offset:10240
    v_accvgpr_write_b32 a48, v244
    buffer_load_dwordx4 v13, s[24:27], s52 offen offset:1024 lds
    v_accvgpr_write_b32 a49, v245
    v_accvgpr_write_b32 a50, v246
    v_accvgpr_write_b32 a51, v247
    v_accvgpr_write_b32 a52, v248
    v_accvgpr_write_b32 a53, v249
    buffer_load_dwordx4 v14, s[24:27], s52 offen offset:2048 lds
    v_accvgpr_write_b32 a54, v250
    v_accvgpr_write_b32 a55, v251
    v_accvgpr_write_b32 a56, v232
    v_accvgpr_write_b32 a57, v233
    v_accvgpr_write_b32 a58, v234
    buffer_load_dwordx4 v15, s[24:27], s52 offen offset:3072 lds
    v_accvgpr_write_b32 a59, v235
    buffer_load_dwordx4 v[16:19], v1, s[8:11], s12 offen offset:0 sc1
    buffer_load_dwordx4 v[20:23], v1, s[8:11], s12 offen offset:1024 sc1
    buffer_load_dwordx4 v[24:27], v1, s[8:11], s12 offen offset:2048 sc1
    buffer_load_dwordx4 v[28:31], v1, s[8:11], s12 offen offset:3072 sc1
    buffer_load_dwordx4 v[32:35], v1, s[8:11], s13 offen offset:0 sc1
    buffer_load_dwordx4 v[36:39], v1, s[8:11], s13 offen offset:1024 sc1
    s_waitcnt lgkmcnt(0)
    s_barrier
    buffer_load_dwordx4 v[40:43], v1, s[8:11], s13 offen offset:2048 sc1
    ds_read_b64 v[224:225], v242 offset:8192
    ds_read_b64 v[226:227], v242 offset:8704
    ds_read_b64 v[228:229], v242 offset:9216
    ds_read_b64 v[230:231], v242 offset:9728
    ds_read_b128 a[32:35], v1 offset:10240
    buffer_load_dwordx4 v[44:47], v1, s[8:11], s13 offen offset:3072 sc1
    ds_read_b128 a[36:39], v1 offset:22528
    ds_read_b128 a[40:43], v1 offset:34816
    ds_read_b128 a[44:47], v1 offset:47104
    ds_read_b64_tr_b16 v[160:161], v184 offset:0
    ds_read_b64_tr_b16 v[162:163], v184 offset:2048
    ds_read_b64_tr_b16 v[164:165], v185 offset:0
    ds_read_b64_tr_b16 v[166:167], v185 offset:2048
    ds_read_b64_tr_b16 v[168:169], v184 offset:4096
    ds_read_b64_tr_b16 v[170:171], v184 offset:6144
    ds_read_b64_tr_b16 v[172:173], v185 offset:4096
    ds_read_b64_tr_b16 v[174:175], v185 offset:6144
    ds_read_b64_tr_b16 v[176:177], v184 offset:8192
    ds_read_b64_tr_b16 v[178:179], v184 offset:10240
    buffer_load_dwordx4 v[48:51], v1, s[8:11], s14 offen offset:0 sc1
    ds_read_b64_tr_b16 v[180:181], v185 offset:8192
    ds_read_b64_tr_b16 v[182:183], v185 offset:10240
    s_waitcnt lgkmcnt(15)
    v_pk_add_f32 v[224:225], v[224:225], v[226:227]
    v_pk_add_f32 v[228:229], v[228:229], v[230:231]
    buffer_load_dwordx4 v[52:55], v1, s[8:11], s14 offen offset:1024 sc1
    s_cmp_eq_u32 s73, 0
    v_pk_add_f32 v[224:225], v[224:225], v[228:229]
    v_min_u32 v224, -2, v224
    s_cbranch_scc1 C_ss
    buffer_store_dwordx2 v[224:225], v12, s[8:11], s59 offen
C_ss_ok:
    buffer_load_dwordx4 v[56:59], v1, s[8:11], s14 offen offset:2048 sc1
    buffer_load_dwordx4 v[60:63], v1, s[8:11], s14 offen offset:3072 sc1
    buffer_load_dwordx4 v[64:67], v1, s[8:11], s15 offen offset:0 sc1
    s_waitcnt vmcnt(12)
    v_max_u32 v7, v16, v20
    v_cmp_eq_u32 vcc, -1, v7
    s_cbranch_vccnz D_rH0
D_rH0_ok:
    s_waitcnt lgkmcnt(8)
    v_mfma_f32_32x32x16_bf16 v[128:143], v[160:163], v[16:19], 0
    ds_read_b64_tr_b16 v[160:161], v184 offset:12288
    ds_read_b64_tr_b16 v[162:163], v184 offset:14336
    buffer_load_dwordx4 v[68:71], v1, s[8:11], s15 offen offset:1024 sc1
    v_mfma_f32_32x32x16_bf16 v[144:159], v[164:167], v[16:19], 0
    ds_read_b64_tr_b16 v[164:165], v185 offset:12288
    ds_read_b64_tr_b16 v[166:167], v185 offset:14336
    s_waitcnt lgkmcnt(8)
    v_mfma_f32_32x32x16_bf16 v[128:143], v[168:171], v[20:23], v[128:143]
    ds_read_b64_tr_b16 v[168:169], v184 offset:16384
    ds_read_b64_tr_b16 v[170:171], v184 offset:18432
    buffer_load_dwordx4 v[72:75], v1, s[8:11], s15 offen offset:2048 sc1
    s_waitcnt vmcnt(12)
    v_max_u32 v7, v24, v28
    v_cmp_eq_u32 vcc, -1, v7
    v_mfma_f32_32x32x16_bf16 v[144:159], v[172:175], v[20:23], v[144:159]
    ds_read_b64_tr_b16 v[172:173], v185 offset:16384
    ds_read_b64_tr_b16 v[174:175], v185 offset:18432
    s_cbranch_vccnz D_rH1
D_rH1_ok:
    s_waitcnt vmcnt(20)
    ds_read_b64_tr_b16 a[0:1], v4 offset:0
    ds_read_b64_tr_b16 a[2:3], v4 offset:1024
    s_waitcnt lgkmcnt(10)
    v_mfma_f32_32x32x16_bf16 v[128:143], v[176:179], v[24:27], v[128:143]
    buffer_load_dwordx4 v[76:79], v1, s[8:11], s15 offen offset:3072 sc1
    ds_read_b64_tr_b16 v[176:177], v184 offset:20480
    ds_read_b64_tr_b16 v[178:179], v184 offset:22528
    ds_read_b64_tr_b16 a[4:5], v5 offset:0
    ds_read_b64_tr_b16 a[6:7], v5 offset:1024
    v_mfma_f32_32x32x16_bf16 v[144:159], v[180:183], v[24:27], v[144:159]
    ds_read_b64_tr_b16 v[180:181], v185 offset:20480
    ds_read_b64_tr_b16 v[182:183], v185 offset:22528
    ds_read_b64_tr_b16 a[8:9], v4 offset:2048
    ds_read_b64_tr_b16 a[10:11], v4 offset:3072
    ds_read_b64_tr_b16 a[12:13], v5 offset:2048
    ds_read_b64_tr_b16 a[14:15], v5 offset:3072
    s_waitcnt lgkmcnt(15)
    v_mfma_f32_32x32x16_bf16 v[128:143], v[160:163], v[28:31], v[128:143]
    buffer_load_dwordx4 v[80:83], v1, s[8:11], s16 offen offset:0 sc1
    ds_read_b64_tr_b16 v[160:161], v184 offset:24576
    ds_read_b64_tr_b16 v[162:163], v184 offset:26624
    s_waitcnt vmcnt(12)
    v_max_u32 v7, v32, v36
    v_cmp_eq_u32 vcc, -1, v7
    v_mfma_f32_32x32x16_bf16 v[144:159], v[164:167], v[28:31], v[144:159]
    ds_read_b64_tr_b16 v[164:165], v185 offset:24576
    ds_read_b64_tr_b16 v[166:167], v185 offset:26624
    s_waitcnt vmcnt(18)
    ds_read_b64_tr_b16 a[16:17], v4 offset:4096
    s_cbranch_vccnz D_rH2
D_rH2_ok:
    ds_read_b64_tr_b16 a[18:19], v4 offset:5120
    ds_read_b64_tr_b16 a[20:21], v5 offset:4096
    s_waitcnt lgkmcnt(15)
    v_mfma_f32_32x32x16_bf16 v[128:143], v[168:171], v[32:35], v[128:143]
    buffer_load_dwordx4 v[84:87], v1, s[8:11], s16 offen offset:1024 sc1
    ds_read_b64_tr_b16 v[168:169], v184 offset:28672
    ds_read_b64_tr_b16 v[170:171], v184 offset:30720
    ds_read_b64_tr_b16 a[22:23], v5 offset:5120
    ds_read_b64_tr_b16 a[24:25], v4 offset:6144
    v_mfma_f32_32x32x16_bf16 v[144:159], v[172:175], v[32:35], v[144:159]
    ds_read_b64_tr_b16 v[172:173], v185 offset:28672
    ds_read_b64_tr_b16 v[174:175], v185 offset:30720
    ds_read_b64_tr_b16 a[26:27], v4 offset:7168
    ds_read_b64_tr_b16 a[28:29], v5 offset:6144
    ds_read_b64_tr_b16 a[30:31], v5 offset:7168
    s_waitcnt lgkmcnt(15)
    v_mfma_f32_32x32x16_bf16 v[128:143], v[176:179], v[36:39], v[128:143]
    buffer_load_dwordx4 v[88:91], v1, s[8:11], s16 offen offset:2048 sc1
    s_waitcnt vmcnt(12)
    v_max_u32 v7, v40, v44
    v_cmp_eq_u32 vcc, -1, v7
    ds_read_b64_tr_b16 v[176:177], v184 offset:32768
    ds_read_b64_tr_b16 v[178:179], v184 offset:34816
    v_mfma_f32_32x32x16_bf16 v[144:159], v[180:183], v[36:39], v[144:159]
    ds_read_b64_tr_b16 v[180:181], v185 offset:32768
    ds_read_b64_tr_b16 v[182:183], v185 offset:34816
    s_cbranch_vccnz D_rH3
D_rH3_ok:
    buffer_load_dwordx4 v[92:95], v1, s[8:11], s16 offen offset:3072 sc1
    s_waitcnt lgkmcnt(15)
    v_mfma_f32_32x32x16_bf16 v[128:143], v[160:163], v[40:43], v[128:143]
    buffer_load_dwordx4 v[192:195], v243, s[8:11], s36 offen offset:0 sc1
    buffer_load_dwordx4 v[196:199], v243, s[8:11], s36 offen offset:16 sc1
    ds_read_b64_tr_b16 v[160:161], v184 offset:36864
    ds_read_b64_tr_b16 v[162:163], v184 offset:38912
    v_mfma_f32_32x32x16_bf16 v[144:159], v[164:167], v[40:43], v[144:159]
    ds_read_b64_tr_b16 v[164:165], v185 offset:36864
    ds_read_b64_tr_b16 v[166:167], v185 offset:38912
    buffer_load_dwordx4 v[96:99], v1, s[8:11], s17 offen offset:0 sc1
    s_waitcnt lgkmcnt(11)
    v_mfma_f32_32x32x16_bf16 v[128:143], v[168:171], v[44:47], v[128:143]
    s_waitcnt vmcnt(14)
    v_max_u32 v7, v48, v52
    v_cmp_eq_u32 vcc, -1, v7
    ds_read_b64_tr_b16 v[168:169], v184 offset:40960
    ds_read_b64_tr_b16 v[170:171], v184 offset:43008
    v_mfma_f32_32x32x16_bf16 v[144:159], v[172:175], v[44:47], v[144:159]
    s_cbranch_vccnz D_rH4
D_rH4_ok:
    ds_read_b64_tr_b16 v[172:173], v185 offset:40960
    ds_read_b64_tr_b16 v[174:175], v185 offset:43008
    buffer_load_dwordx4 v[100:103], v1, s[8:11], s17 offen offset:1024 sc1
    s_waitcnt lgkmcnt(8)
    v_mfma_f32_32x32x16_bf16 v[128:143], v[176:179], v[48:51], v[128:143]
    ds_read_b64_tr_b16 v[176:177], v184 offset:45056
    ds_read_b64_tr_b16 v[178:179], v184 offset:47104
    v_mfma_f32_32x32x16_bf16 v[144:159], v[180:183], v[48:51], v[144:159]
    ds_read_b64_tr_b16 v[180:181], v185 offset:45056
    ds_read_b64_tr_b16 v[182:183], v185 offset:47104
    buffer_load_dwordx4 v[104:107], v1, s[8:11], s17 offen offset:2048 sc1
    s_waitcnt lgkmcnt(8)
    v_mfma_f32_32x32x16_bf16 v[128:143], v[160:163], v[52:55], v[128:143]
    s_waitcnt vmcnt(13)
    v_max_u32 v7, v56, v60
    v_cmp_eq_u32 vcc, -1, v7
    ds_read_b64_tr_b16 v[160:161], v184 offset:49152
    ds_read_b64_tr_b16 v[162:163], v184 offset:51200
    v_mfma_f32_32x32x16_bf16 v[144:159], v[164:167], v[52:55], v[144:159]
    s_cbranch_vccnz D_rH5
D_rH5_ok:
    ds_read_b64_tr_b16 v[164:165], v185 offset:49152
    ds_read_b64_tr_b16 v[166:167], v185 offset:51200
    buffer_load_dwordx4 v[108:111], v1, s[8:11], s17 offen offset:3072 sc1
    s_waitcnt lgkmcnt(8)
    v_mfma_f32_32x32x16_bf16 v[128:143], v[168:171], v[56:59], v[128:143]
    ds_read_b64_tr_b16 v[168:169], v184 offset:53248
    ds_read_b64_tr_b16 v[170:171], v184 offset:55296
    v_mfma_f32_32x32x16_bf16 v[144:159], v[172:175], v[56:59], v[144:159]
    ds_read_b64_tr_b16 v[172:173], v185 offset:53248
    ds_read_b64_tr_b16 v[174:175], v185 offset:55296
    buffer_load_dwordx4 v[112:115], v1, s[8:11], s18 offen offset:0 sc1
    s_waitcnt lgkmcnt(8)
    v_mfma_f32_32x32x16_bf16 v[128:143], v[176:179], v[60:63], v[128:143]
    s_waitcnt vmcnt(13)
    v_max_u32 v7, v64, v68
    v_cmp_eq_u32 vcc, -1, v7
    ds_read_b64_tr_b16 v[176:177], v184 offset:57344
    ds_read_b64_tr_b16 v[178:179], v184 offset:59392
    v_mfma_f32_32x32x16_bf16 v[144:159], v[180:183], v[60:63], v[144:159]
    s_cbranch_vccnz D_rH6
D_rH6_ok:
    ds_read_b64_tr_b16 v[180:181], v185 offset:57344
    ds_read_b64_tr_b16 v[182:183], v185 offset:59392
    buffer_load_dwordx4 v[116:119], v1, s[8:11], s18 offen offset:1024 sc1
    s_waitcnt lgkmcnt(8)
    v_mfma_f32_32x32x16_bf16 v[128:143], v[160:163], v[64:67], v[128:143]
    ds_read_b64_tr_b16 v[160:161], v184 offset:61440
    ds_read_b64_tr_b16 v[162:163], v184 offset:63488
    v_mfma_f32_32x32x16_bf16 v[144:159], v[164:167], v[64:67], v[144:159]
    ds_read_b64_tr_b16 v[164:165], v185 offset:61440
    ds_read_b64_tr_b16 v[166:167], v185 offset:63488
    buffer_load_dwordx4 v[120:123], v1, s[8:11], s18 offen offset:2048 sc1
    s_waitcnt lgkmcnt(8)
    v_mfma_f32_32x32x16_bf16 v[128:143], v[168:171], v[68:71], v[128:143]
    s_waitcnt vmcnt(13)
    v_max_u32 v7, v72, v76
    v_cmp_eq_u32 vcc, -1, v7
    ds_read_b64_tr_b16 v[168:169], v188 offset:0
    ds_read_b64_tr_b16 v[170:171], v188 offset:2048
    v_mfma_f32_32x32x16_bf16 v[144:159], v[172:175], v[68:71], v[144:159]
    s_cbranch_vccnz D_rH7
D_rH7_ok:
    ds_read_b64_tr_b16 v[172:173], v189 offset:0
    ds_read_b64_tr_b16 v[174:175], v189 offset:2048
    buffer_load_dwordx4 v[124:127], v1, s[8:11], s18 offen offset:3072 sc1
    s_waitcnt lgkmcnt(8)
    v_mfma_f32_32x32x16_bf16 v[128:143], v[176:179], v[72:75], v[128:143]
    ds_read_b64_tr_b16 v[176:177], v188 offset:4096
    ds_read_b64_tr_b16 v[178:179], v188 offset:6144
    v_mfma_f32_32x32x16_bf16 v[144:159], v[180:183], v[72:75], v[144:159]
    ds_read_b64_tr_b16 v[180:181], v189 offset:4096
    ds_read_b64_tr_b16 v[182:183], v189 offset:6144
    s_waitcnt lgkmcnt(8)
    v_mfma_f32_32x32x16_bf16 v[128:143], v[160:163], v[76:79], v[128:143]
    s_waitcnt vmcnt(12)
    v_max_u32 v7, v80, v84
    v_cmp_eq_u32 vcc, -1, v7
    ds_read_b64_tr_b16 v[160:161], v188 offset:8192
    ds_read_b64_tr_b16 v[162:163], v188 offset:10240
    v_mfma_f32_32x32x16_bf16 v[144:159], v[164:167], v[76:79], v[144:159]
    s_cbranch_vccnz D_rH8
D_rH8_ok:
    ds_read_b64_tr_b16 v[164:165], v189 offset:8192
    ds_read_b64_tr_b16 v[166:167], v189 offset:10240
    s_waitcnt lgkmcnt(8)
    v_mfma_f32_32x32x16_bf16 v[128:143], v[168:171], v[80:83], v[128:143]
    ds_read_b64_tr_b16 v[168:169], v188 offset:12288
    ds_read_b64_tr_b16 v[170:171], v188 offset:14336
    v_mfma_f32_32x32x16_bf16 v[144:159], v[172:175], v[80:83], v[144:159]
    ds_read_b64_tr_b16 v[172:173], v189 offset:12288
    ds_read_b64_tr_b16 v[174:175], v189 offset:14336
    s_waitcnt lgkmcnt(8)
    v_mfma_f32_32x32x16_bf16 v[128:143], v[176:179], v[84:87], v[128:143]
    s_waitcnt vmcnt(10)
    v_max_u32 v7, v88, v92
    v_cmp_eq_u32 vcc, -1, v7
    ds_read_b64_tr_b16 v[176:177], v188 offset:16384
    ds_read_b64_tr_b16 v[178:179], v188 offset:18432
    v_mfma_f32_32x32x16_bf16 v[144:159], v[180:183], v[84:87], v[144:159]
    s_cbranch_vccnz D_rH9
D_rH9_ok:
    ds_read_b64_tr_b16 v[180:181], v189 offset:16384
    ds_read_b64_tr_b16 v[182:183], v189 offset:18432
    s_waitcnt lgkmcnt(8)
    v_mfma_f32_32x32x16_bf16 v[128:143], v[160:163], v[88:91], v[128:143]
    ds_read_b64_tr_b16 v[160:161], v188 offset:20480
    ds_read_b64_tr_b16 v[162:163], v188 offset:22528
    v_mfma_f32_32x32x16_bf16 v[144:159], v[164:167], v[88:91], v[144:159]
    ds_read_b64_tr_b16 v[164:165], v189 offset:20480
    ds_read_b64_tr_b16 v[166:167], v189 offset:22528
    s_waitcnt lgkmcnt(8)
    v_mfma_f32_32x32x16_bf16 v[128:143], v[168:171], v[92:95], v[128:143]
    ds_read_b64_tr_b16 v[168:169], v188 offset:24576
    ds_read_b64_tr_b16 v[170:171], v188 offset:26624
    v_mfma_f32_32x32x16_bf16 v[144:159], v[172:175], v[92:95], v[144:159]
    ds_read_b64_tr_b16 v[172:173], v189 offset:24576
    ds_read_b64_tr_b16 v[174:175], v189 offset:26624
    s_waitcnt vmcnt(6)
    v_max_u32 v7, v96, v100
    v_cmp_eq_u32 vcc, -1, v7
    s_cbranch_vccnz D_rH10
D_rH10_ok:
    s_waitcnt lgkmcnt(8)
    v_mfma_f32_32x32x16_bf16 v[128:143], v[176:179], v[96:99], v[128:143]
    s_mov_b32 exec_lo, 0
    v_mov_b32 v198, 0
    v_mov_b32 v199, 0
    s_mov_b32 exec_lo, -1
    v_max3_u32 v7, v192, v194, v196
    v_max_u32 v7, v198, v7
    v_cmp_eq_u32 vcc, -1, v7
    v_mfma_f32_32x32x16_bf16 v[144:159], v[180:183], v[96:99], v[144:159]
    ds_read_b64_tr_b16 v[176:177], v188 offset:28672
    ds_read_b64_tr_b16 v[178:179], v188 offset:30720
    ds_read_b64_tr_b16 v[180:181], v189 offset:28672
    ds_read_b64_tr_b16 v[182:183], v189 offset:30720
    s_cbranch_vccnz D_rS0
D_rS0_ok:
    v_add_f32 v192, v192, v194
    s_waitcnt lgkmcnt(8)
    v_mfma_f32_32x32x16_bf16 v[128:143], v[160:163], v[100:103], v[128:143]
    ds_read_b64_tr_b16 v[160:161], v188 offset:32768
    ds_read_b64_tr_b16 v[162:163], v188 offset:34816
    v_add_f32 v193, v193, v195
    s_waitcnt vmcnt(4)
    v_max_u32 v7, v104, v108
    v_cmp_eq_u32 vcc, -1, v7
    v_mfma_f32_32x32x16_bf16 v[144:159], v[164:167], v[100:103], v[144:159]
    ds_read_b64_tr_b16 v[164:165], v189 offset:32768
    ds_read_b64_tr_b16 v[166:167], v189 offset:34816
    v_add_f32 v196, v196, v198
    s_cbranch_vccnz D_rH11
D_rH11_ok:
    v_add_f32 v197, v197, v199
    v_add_f32 v192, v192, v196
    s_waitcnt lgkmcnt(8)
    v_mfma_f32_32x32x16_bf16 v[128:143], v[168:171], v[104:107], v[128:143]
    ds_read_b64_tr_b16 v[168:169], v188 offset:36864
    ds_read_b64_tr_b16 v[170:171], v188 offset:38912
    v_add_f32 v193, v193, v197
    v_mov_b32 v194, v192
    v_mov_b32 v195, v193
    s_nop 0
    v_mfma_f32_32x32x16_bf16 v[144:159], v[172:175], v[104:107], v[144:159]
    ds_read_b64_tr_b16 v[172:173], v189 offset:36864
    ds_read_b64_tr_b16 v[174:175], v189 offset:38912
    v_permlane32_swap_b32 v192, v194
    v_permlane32_swap_b32 v193, v195
    v_add_f32 v192, v192, v194
    v_add_f32 v193, v193, v195
    s_waitcnt lgkmcnt(8)
    v_mfma_f32_32x32x16_bf16 v[128:143], v[176:179], v[108:111], v[128:143]
    ds_read_b64_tr_b16 v[176:177], v188 offset:40960
    ds_read_b64_tr_b16 v[178:179], v188 offset:43008
    v_mul_f32 v192, 0xbb124925, v192
    s_waitcnt vmcnt(2)
    v_max_u32 v7, v112, v116
    v_cmp_eq_u32 vcc, -1, v7
    v_mfma_f32_32x32x16_bf16 v[144:159], v[180:183], v[108:111], v[144:159]
    ds_read_b64_tr_b16 v[180:181], v189 offset:40960
    ds_read_b64_tr_b16 v[182:183], v189 offset:43008
    v_mul_f32 v193, 0x3b124925, v193
    s_cbranch_vccnz D_rH12
D_rH12_ok:
    v_fma_f32 v193, -v192, v192, v193
    v_max_f32 v193, 0, v193
    s_waitcnt lgkmcnt(8)
    v_mfma_f32_32x32x16_bf16 v[128:143], v[160:163], v[112:115], v[128:143]
    ds_read_b64_tr_b16 v[160:161], v188 offset:45056
    ds_read_b64_tr_b16 v[162:163], v188 offset:47104
    v_add_f32 v193, 0x3727c5ac, v193
    v_rsq_f32 v194, v193
    v_mov_b32 v235, 0
    v_mfma_f32_32x32x16_bf16 v[144:159], v[164:167], v[112:115], v[144:159]
    ds_read_b64_tr_b16 v[164:165], v189 offset:45056
    ds_read_b64_tr_b16 v[166:167], v189 offset:47104
    v_mul_f32 v10, v193, v194
    v_mul_f32 v8, 0xc0135761, v194
    v_mul_f32 v195, v194, v194
    v_cvt_pk_bf16_f32 v233, v192, v10
    s_waitcnt lgkmcnt(8)
    v_mfma_f32_32x32x16_bf16 v[128:143], v[168:171], v[116:119], v[128:143]
    ds_read_b64_tr_b16 v[168:169], v186 offset:0
    ds_read_b64_tr_b16 v[170:171], v186 offset:2048
    v_mul_f32 v195, 0x3d372713, v195
    s_waitcnt vmcnt(0)
    v_max_u32 v7, v120, v124
    v_cmp_eq_u32 vcc, -1, v7
    v_mfma_f32_32x32x16_bf16 v[144:159], v[172:175], v[116:119], v[144:159]
    ds_read_b64_tr_b16 v[172:173], v187 offset:0
    ds_read_b64_tr_b16 v[174:175], v187 offset:2048
    v_lshlrev_b32 v196, 16, v233
    s_cbranch_vccnz D_rH13
D_rH13_ok:
    v_and_b32 v197, s42, v233
    v_mul_f32 v9, v8, v195
    s_waitcnt lgkmcnt(8)
    v_mfma_f32_32x32x16_bf16 v[128:143], v[176:179], v[120:123], v[128:143]
    ds_read_b64_tr_b16 v[176:177], v186 offset:4096
    ds_read_b64_tr_b16 v[178:179], v186 offset:6144
    v_sub_f32 v198, v192, v196
    v_sub_f32 v197, v10, v197
    v_cvt_pk_bf16_f32 v232, v196, v198
    v_cvt_pk_bf16_f32 v234, v197, v235
    v_mfma_f32_32x32x16_bf16 v[144:159], v[180:183], v[120:123], v[144:159]
    ds_read_b64_tr_b16 v[180:181], v187 offset:4096
    ds_read_b64_tr_b16 v[182:183], v187 offset:6144
    s_waitcnt lgkmcnt(8)
    v_mfma_f32_32x32x16_bf16 v[128:143], v[160:163], v[124:127], v[128:143]
    ds_read_b64_tr_b16 v[160:161], v186 offset:8192
    ds_read_b64_tr_b16 v[162:163], v186 offset:10240
    v_mfma_f32_32x32x16_bf16 v[144:159], v[164:167], v[124:127], v[144:159]
    ds_read_b64_tr_b16 v[164:165], v187 offset:8192
    ds_read_b64_tr_b16 v[166:167], v187 offset:10240
    v_mfma_f32_32x32x16_bf16 v[128:143], a[32:35], v[232:235], v[128:143]
    v_mfma_f32_32x32x16_bf16 v[144:159], a[36:39], v[232:235], v[144:159]
    s_barrier
    s_waitcnt lgkmcnt(8)
    v_mfma_f32_32x32x16_bf16 v[192:207], v[168:171], v[16:19], 0
    ds_read_b64_tr_b16 v[168:169], v186 offset:12288
    ds_read_b64_tr_b16 v[170:171], v186 offset:14336
    s_nop 5
    v_mul_f32 v224, v128, v128
    v_mul_f32 v225, v129, v129
    v_mul_f32 v226, v130, v130
    v_mul_f32 v227, v131, v131
    v_mfma_f32_32x32x16_bf16 v[208:223], v[172:175], v[16:19], 0
    ds_read_b64_tr_b16 v[172:173], v187 offset:12288
    ds_read_b64_tr_b16 v[174:175], v187 offset:14336
    v_fma_f32 v224, v224, v9, v8
    v_fma_f32 v225, v225, v9, v8
    v_fma_f32 v226, v226, v9, v8
    v_fma_f32 v227, v227, v9, v8
    s_waitcnt lgkmcnt(8)
    v_mfma_f32_32x32x16_bf16 v[192:207], v[176:179], v[20:23], v[192:207]
    ds_read_b64_tr_b16 v[176:177], v186 offset:16384
    ds_read_b64_tr_b16 v[178:179], v186 offset:18432
    v_mul_f32 v224, v224, v128
    v_mul_f32 v225, v225, v129
    v_mul_f32 v226, v226, v130
    v_mul_f32 v227, v227, v131
    v_mfma_f32_32x32x16_bf16 v[208:223], v[180:183], v[20:23], v[208:223]
    ds_read_b64_tr_b16 v[180:181], v187 offset:16384
    ds_read_b64_tr_b16 v[182:183], v187 offset:18432
    v_exp_f32 v224, v224
    v_exp_f32 v225, v225
    s_waitcnt lgkmcnt(8)
    v_mfma_f32_32x32x16_bf16 v[192:207], v[160:163], v[24:27], v[192:207]
    ds_read_b64_tr_b16 v[160:161], v186 offset:20480
    ds_read_b64_tr_b16 v[162:163], v186 offset:22528
    v_exp_f32 v226, v226
    v_exp_f32 v227, v227
    v_mfma_f32_32x32x16_bf16 v[208:223], v[164:167], v[24:27], v[208:223]
    ds_read_b64_tr_b16 v[164:165], v187 offset:20480
    ds_read_b64_tr_b16 v[166:167], v187 offset:22528
    v_fma_f32 v224, v224, v10, v10
    v_fma_f32 v225, v225, v10, v10
    v_fma_f32 v226, v226, v10, v10
    v_fma_f32 v227, v227, v10, v10
    s_waitcnt lgkmcnt(8)
    v_mfma_f32_32x32x16_bf16 v[192:207], v[168:171], v[28:31], v[192:207]
    ds_read_b64_tr_b16 v[168:169], v186 offset:24576
    ds_read_b64_tr_b16 v[170:171], v186 offset:26624
    v_rcp_f32 v224, v224
    v_rcp_f32 v225, v225
    v_mfma_f32_32x32x16_bf16 v[208:223], v[172:175], v[28:31], v[208:223]
    ds_read_b64_tr_b16 v[172:173], v187 offset:24576
    ds_read_b64_tr_b16 v[174:175], v187 offset:26624
    v_rcp_f32 v226, v226
    v_rcp_f32 v227, v227
    s_waitcnt lgkmcnt(8)
    v_mfma_f32_32x32x16_bf16 v[192:207], v[176:179], v[32:35], v[192:207]
    ds_read_b64_tr_b16 v[176:177], v186 offset:28672
    ds_read_b64_tr_b16 v[178:179], v186 offset:30720
    v_mul_f32 v224, v224, v128
    v_mul_f32 v225, v225, v129
    v_mul_f32 v226, v226, v130
    v_mul_f32 v227, v227, v131
    v_mfma_f32_32x32x16_bf16 v[208:223], v[180:183], v[32:35], v[208:223]
    ds_read_b64_tr_b16 v[180:181], v187 offset:28672
    ds_read_b64_tr_b16 v[182:183], v187 offset:30720
    v_cvt_pk_bf16_f32 v240, v224, v225
    v_cvt_pk_bf16_f32 v241, v226, v227
    v_mul_f32 v228, v132, v132
    v_mul_f32 v229, v133, v133
    s_waitcnt lgkmcnt(8)
    v_mfma_f32_32x32x16_bf16 v[192:207], v[160:163], v[36:39], v[192:207]
    ds_read_b64_tr_b16 v[160:161], v186 offset:32768
    ds_read_b64_tr_b16 v[162:163], v186 offset:34816
    v_mul_f32 v230, v134, v134
    v_mul_f32 v231, v135, v135
    v_fma_f32 v228, v228, v9, v8
    v_fma_f32 v229, v229, v9, v8
    v_mfma_f32_32x32x16_bf16 v[208:223], v[164:167], v[36:39], v[208:223]
    ds_read_b64_tr_b16 v[164:165], v187 offset:32768
    ds_read_b64_tr_b16 v[166:167], v187 offset:34816
    v_fma_f32 v230, v230, v9, v8
    v_fma_f32 v231, v231, v9, v8
    v_mul_f32 v228, v228, v132
    v_mul_f32 v229, v229, v133
    s_waitcnt lgkmcnt(8)
    v_mfma_f32_32x32x16_bf16 v[192:207], v[168:171], v[40:43], v[192:207]
    ds_read_b64_tr_b16 v[168:169], v186 offset:36864
    ds_read_b64_tr_b16 v[170:171], v186 offset:38912
    v_mul_f32 v230, v230, v134
    v_mul_f32 v231, v231, v135
    v_exp_f32 v228, v228
    v_mfma_f32_32x32x16_bf16 v[208:223], v[172:175], v[40:43], v[208:223]
    ds_read_b64_tr_b16 v[172:173], v187 offset:36864
    ds_read_b64_tr_b16 v[174:175], v187 offset:38912
    v_exp_f32 v229, v229
    v_exp_f32 v230, v230
    s_waitcnt lgkmcnt(8)
    v_mfma_f32_32x32x16_bf16 v[192:207], v[176:179], v[44:47], v[192:207]
    ds_read_b64_tr_b16 v[176:177], v186 offset:40960
    ds_read_b64_tr_b16 v[178:179], v186 offset:43008
    v_exp_f32 v231, v231
    v_fma_f32 v228, v228, v10, v10
    v_fma_f32 v229, v229, v10, v10
    v_mfma_f32_32x32x16_bf16 v[208:223], v[180:183], v[44:47], v[208:223]
    ds_read_b64_tr_b16 v[180:181], v187 offset:40960
    ds_read_b64_tr_b16 v[182:183], v187 offset:43008
    v_fma_f32 v230, v230, v10, v10
    v_fma_f32 v231, v231, v10, v10
    v_rcp_f32 v228, v228
    s_waitcnt lgkmcnt(8)
    v_mfma_f32_32x32x16_bf16 v[192:207], v[160:163], v[48:51], v[192:207]
    ds_read_b64_tr_b16 v[160:161], v186 offset:45056
    ds_read_b64_tr_b16 v[162:163], v186 offset:47104
    v_rcp_f32 v229, v229
    v_rcp_f32 v230, v230
    v_mfma_f32_32x32x16_bf16 v[208:223], v[164:167], v[48:51], v[208:223]
    ds_read_b64_tr_b16 v[164:165], v187 offset:45056
    ds_read_b64_tr_b16 v[166:167], v187 offset:47104
    v_rcp_f32 v231, v231
    v_mul_f32 v228, v228, v132
    v_mul_f32 v229, v229, v133
    s_waitcnt lgkmcnt(8)
    v_mfma_f32_32x32x16_bf16 v[192:207], v[168:171], v[52:55], v[192:207]
    ds_read_b64_tr_b16 v[168:169], v186 offset:49152
    ds_read_b64_tr_b16 v[170:171], v186 offset:51200
    v_mul_f32 v230, v230, v134
    v_mul_f32 v231, v231, v135
    v_cvt_pk_bf16_f32 v242, v228, v229
    v_cvt_pk_bf16_f32 v243, v230, v231
    v_min_u32 v240, -2, v240
    buffer_store_dwordx4 v[240:243], v1, s[8:11], s58 offen offset:0 sc1
    v_mfma_f32_32x32x16_bf16 v[208:223], v[172:175], v[52:55], v[208:223]
    ds_read_b64_tr_b16 v[172:173], v187 offset:49152
    ds_read_b64_tr_b16 v[174:175], v187 offset:51200
    v_mul_f32 v224, v136, v136
    v_mul_f32 v225, v137, v137
    v_mul_f32 v226, v138, v138
    v_mul_f32 v227, v139, v139
    s_waitcnt lgkmcnt(8)
    v_mfma_f32_32x32x16_bf16 v[192:207], v[176:179], v[56:59], v[192:207]
    ds_read_b64_tr_b16 v[176:177], v186 offset:53248
    ds_read_b64_tr_b16 v[178:179], v186 offset:55296
    v_fma_f32 v224, v224, v9, v8
    v_fma_f32 v225, v225, v9, v8
    v_fma_f32 v226, v226, v9, v8
    v_fma_f32 v227, v227, v9, v8
    v_mfma_f32_32x32x16_bf16 v[208:223], v[180:183], v[56:59], v[208:223]
    ds_read_b64_tr_b16 v[180:181], v187 offset:53248
    ds_read_b64_tr_b16 v[182:183], v187 offset:55296
    v_mul_f32 v224, v224, v136
    v_mul_f32 v225, v225, v137
    v_mul_f32 v226, v226, v138
    v_mul_f32 v227, v227, v139
    s_waitcnt lgkmcnt(8)
    v_mfma_f32_32x32x16_bf16 v[192:207], v[160:163], v[60:63], v[192:207]
    ds_read_b64_tr_b16 v[160:161], v186 offset:57344
    ds_read_b64_tr_b16 v[162:163], v186 offset:59392
    v_exp_f32 v224, v224
    v_exp_f32 v225, v225
    v_mfma_f32_32x32x16_bf16 v[208:223], v[164:167], v[60:63], v[208:223]
    ds_read_b64_tr_b16 v[164:165], v187 offset:57344
    ds_read_b64_tr_b16 v[166:167], v187 offset:59392
    v_exp_f32 v226, v226
    v_exp_f32 v227, v227
    s_waitcnt lgkmcnt(8)
    v_mfma_f32_32x32x16_bf16 v[192:207], v[168:171], v[64:67], v[192:207]
    ds_read_b64_tr_b16 v[168:169], v186 offset:61440
    ds_read_b64_tr_b16 v[170:171], v186 offset:63488
    v_fma_f32 v224, v224, v10, v10
    v_fma_f32 v225, v225, v10, v10
    v_fma_f32 v226, v226, v10, v10
    v_fma_f32 v227, v227, v10, v10
    v_mfma_f32_32x32x16_bf16 v[208:223], v[172:175], v[64:67], v[208:223]
    ds_read_b64_tr_b16 v[172:173], v187 offset:61440
    ds_read_b64_tr_b16 v[174:175], v187 offset:63488
    v_rcp_f32 v224, v224
    v_rcp_f32 v225, v225
    s_waitcnt lgkmcnt(8)
    v_mfma_f32_32x32x16_bf16 v[192:207], v[176:179], v[68:71], v[192:207]
    ds_read_b64_tr_b16 v[176:177], v190 offset:0
    ds_read_b64_tr_b16 v[178:179], v190 offset:2048
    v_rcp_f32 v226, v226
    v_rcp_f32 v227, v227
    v_mfma_f32_32x32x16_bf16 v[208:223], v[180:183], v[68:71], v[208:223]
    ds_read_b64_tr_b16 v[180:181], v191 offset:0
    ds_read_b64_tr_b16 v[182:183], v191 offset:2048
    v_mul_f32 v224, v224, v136
    v_mul_f32 v225, v225, v137
    v_mul_f32 v226, v226, v138
    v_mul_f32 v227, v227, v139
    s_waitcnt lgkmcnt(8)
    v_mfma_f32_32x32x16_bf16 v[192:207], v[160:163], v[72:75], v[192:207]
    ds_read_b64_tr_b16 v[160:161], v190 offset:4096
    ds_read_b64_tr_b16 v[162:163], v190 offset:6144
    v_cvt_pk_bf16_f32 v244, v224, v225
    v_cvt_pk_bf16_f32 v245, v226, v227
    v_mul_f32 v228, v140, v140
    v_mul_f32 v229, v141, v141
    v_mfma_f32_32x32x16_bf16 v[208:223], v[164:167], v[72:75], v[208:223]
    ds_read_b64_tr_b16 v[164:165], v191 offset:4096
    ds_read_b64_tr_b16 v[166:167], v191 offset:6144
    v_mul_f32 v230, v142, v142
    v_mul_f32 v231, v143, v143
    v_fma_f32 v228, v228, v9, v8
    v_fma_f32 v229, v229, v9, v8
    s_waitcnt lgkmcnt(8)
    v_mfma_f32_32x32x16_bf16 v[192:207], v[168:171], v[76:79], v[192:207]
    ds_read_b64_tr_b16 v[168:169], v190 offset:8192
    ds_read_b64_tr_b16 v[170:171], v190 offset:10240
    v_fma_f32 v230, v230, v9, v8
    v_fma_f32 v231, v231, v9, v8
    v_mul_f32 v228, v228, v140
    v_mul_f32 v229, v229, v141
    v_mfma_f32_32x32x16_bf16 v[208:223], v[172:175], v[76:79], v[208:223]
    ds_read_b64_tr_b16 v[172:173], v191 offset:8192
    ds_read_b64_tr_b16 v[174:175], v191 offset:10240
    v_mul_f32 v230, v230, v142
    v_mul_f32 v231, v231, v143
    v_exp_f32 v228, v228
    s_waitcnt lgkmcnt(8)
    v_mfma_f32_32x32x16_bf16 v[192:207], v[176:179], v[80:83], v[192:207]
    ds_read_b64_tr_b16 v[176:177], v190 offset:12288
    ds_read_b64_tr_b16 v[178:179], v190 offset:14336
    v_exp_f32 v229, v229
    v_exp_f32 v230, v230
    v_mfma_f32_32x32x16_bf16 v[208:223], v[180:183], v[80:83], v[208:223]
    ds_read_b64_tr_b16 v[180:181], v191 offset:12288
    ds_read_b64_tr_b16 v[182:183], v191 offset:14336
    v_exp_f32 v231, v231
    v_fma_f32 v228, v228, v10, v10
    v_fma_f32 v229, v229, v10, v10
    s_waitcnt lgkmcnt(8)
    v_mfma_f32_32x32x16_bf16 v[192:207], v[160:163], v[84:87], v[192:207]
    ds_read_b64_tr_b16 v[160:161], v190 offset:16384
    ds_read_b64_tr_b16 v[162:163], v190 offset:18432
    v_fma_f32 v230, v230, v10, v10
    v_fma_f32 v231, v231, v10, v10
    v_rcp_f32 v228, v228
    v_mfma_f32_32x32x16_bf16 v[208:223], v[164:167], v[84:87], v[208:223]
    ds_read_b64_tr_b16 v[164:165], v191 offset:16384
    ds_read_b64_tr_b16 v[166:167], v191 offset:18432
    v_rcp_f32 v229, v229
    v_rcp_f32 v230, v230
    s_waitcnt lgkmcnt(8)
    v_mfma_f32_32x32x16_bf16 v[192:207], v[168:171], v[88:91], v[192:207]
    ds_read_b64_tr_b16 v[168:169], v190 offset:20480
    ds_read_b64_tr_b16 v[170:171], v190 offset:22528
    v_rcp_f32 v231, v231
    v_mul_f32 v228, v228, v140
    v_mul_f32 v229, v229, v141
    v_mfma_f32_32x32x16_bf16 v[208:223], v[172:175], v[88:91], v[208:223]
    ds_read_b64_tr_b16 v[172:173], v191 offset:20480
    ds_read_b64_tr_b16 v[174:175], v191 offset:22528
    v_mul_f32 v230, v230, v142
    v_mul_f32 v231, v231, v143
    v_cvt_pk_bf16_f32 v246, v228, v229
    v_cvt_pk_bf16_f32 v247, v230, v231
    v_min_u32 v244, -2, v244
    buffer_store_dwordx4 v[244:247], v1, s[8:11], s58 offen offset:1024 sc1
    s_waitcnt lgkmcnt(8)
    v_mfma_f32_32x32x16_bf16 v[192:207], v[176:179], v[92:95], v[192:207]
    ds_read_b64_tr_b16 v[176:177], v190 offset:24576
    ds_read_b64_tr_b16 v[178:179], v190 offset:26624
    v_mul_f32 v224, v144, v144
    v_mul_f32 v225, v145, v145
    v_mul_f32 v226, v146, v146
    v_mul_f32 v227, v147, v147
    v_mfma_f32_32x32x16_bf16 v[208:223], v[180:183], v[92:95], v[208:223]
    ds_read_b64_tr_b16 v[180:181], v191 offset:24576
    ds_read_b64_tr_b16 v[182:183], v191 offset:26624
    v_fma_f32 v224, v224, v9, v8
    v_fma_f32 v225, v225, v9, v8
    v_fma_f32 v226, v226, v9, v8
    v_fma_f32 v227, v227, v9, v8
    s_waitcnt lgkmcnt(8)
    v_mfma_f32_32x32x16_bf16 v[192:207], v[160:163], v[96:99], v[192:207]
    ds_read_b64_tr_b16 v[160:161], v190 offset:28672
    ds_read_b64_tr_b16 v[162:163], v190 offset:30720
    v_mul_f32 v224, v224, v144
    v_mul_f32 v225, v225, v145
    v_mul_f32 v226, v226, v146
    v_mul_f32 v227, v227, v147
    v_mfma_f32_32x32x16_bf16 v[208:223], v[164:167], v[96:99], v[208:223]
    ds_read_b64_tr_b16 v[164:165], v191 offset:28672
    ds_read_b64_tr_b16 v[166:167], v191 offset:30720
    v_exp_f32 v224, v224
    v_exp_f32 v225, v225
    s_waitcnt lgkmcnt(8)
    v_mfma_f32_32x32x16_bf16 v[192:207], v[168:171], v[100:103], v[192:207]
    ds_read_b64_tr_b16 v[168:169], v190 offset:32768
    ds_read_b64_tr_b16 v[170:171], v190 offset:34816
    v_exp_f32 v226, v226
    v_exp_f32 v227, v227
    v_mfma_f32_32x32x16_bf16 v[208:223], v[172:175], v[100:103], v[208:223]
    ds_read_b64_tr_b16 v[172:173], v191 offset:32768
    ds_read_b64_tr_b16 v[174:175], v191 offset:34816
    v_fma_f32 v224, v224, v10, v10
    v_fma_f32 v225, v225, v10, v10
    v_fma_f32 v226, v226, v10, v10
    v_fma_f32 v227, v227, v10, v10
    s_waitcnt lgkmcnt(8)
    v_mfma_f32_32x32x16_bf16 v[192:207], v[176:179], v[104:107], v[192:207]
    ds_read_b64_tr_b16 v[176:177], v190 offset:36864
    ds_read_b64_tr_b16 v[178:179], v190 offset:38912
    v_rcp_f32 v224, v224
    v_rcp_f32 v225, v225
    v_mfma_f32_32x32x16_bf16 v[208:223], v[180:183], v[104:107], v[208:223]
    ds_read_b64_tr_b16 v[180:181], v191 offset:36864
    ds_read_b64_tr_b16 v[182:183], v191 offset:38912
    v_rcp_f32 v226, v226
    v_rcp_f32 v227, v227
    s_waitcnt lgkmcnt(8)
    v_mfma_f32_32x32x16_bf16 v[192:207], v[160:163], v[108:111], v[192:207]
    ds_read_b64_tr_b16 v[160:161], v190 offset:40960
    ds_read_b64_tr_b16 v[162:163], v190 offset:43008
    v_mul_f32 v224, v224, v144
    v_mul_f32 v225, v225, v145
    v_mul_f32 v226, v226, v146
    v_mul_f32 v227, v227, v147
    v_mfma_f32_32x32x16_bf16 v[208:223], v[164:167], v[108:111], v[208:223]
    ds_read_b64_tr_b16 v[164:165], v191 offset:40960
    ds_read_b64_tr_b16 v[166:167], v191 offset:43008
    v_cvt_pk_bf16_f32 v240, v224, v225
    v_cvt_pk_bf16_f32 v241, v226, v227
    v_mul_f32 v228, v148, v148
    v_mul_f32 v229, v149, v149
    s_waitcnt lgkmcnt(8)
    v_mfma_f32_32x32x16_bf16 v[192:207], v[168:171], v[112:115], v[192:207]
    ds_read_b64_tr_b16 v[168:169], v190 offset:45056
    ds_read_b64_tr_b16 v[170:171], v190 offset:47104
    v_mul_f32 v230, v150, v150
    v_mul_f32 v231, v151, v151
    v_fma_f32 v228, v228, v9, v8
    v_fma_f32 v229, v229, v9, v8
    v_mfma_f32_32x32x16_bf16 v[208:223], v[172:175], v[112:115], v[208:223]
    ds_read_b64_tr_b16 v[172:173], v191 offset:45056
    ds_read_b64_tr_b16 v[174:175], v191 offset:47104
    v_fma_f32 v230, v230, v9, v8
    v_fma_f32 v231, v231, v9, v8
    v_mul_f32 v228, v228, v148
    v_mul_f32 v229, v229, v149
    s_waitcnt lgkmcnt(8)
    v_mfma_f32_32x32x16_bf16 v[192:207], v[176:179], v[116:119], v[192:207]
    v_mul_f32 v230, v230, v150
    v_mul_f32 v231, v231, v151
    v_exp_f32 v228, v228
    v_exp_f32 v229, v229
    v_mfma_f32_32x32x16_bf16 v[208:223], v[180:183], v[116:119], v[208:223]
    v_exp_f32 v230, v230
    v_exp_f32 v231, v231
    v_fma_f32 v228, v228, v10, v10
    v_fma_f32 v229, v229, v10, v10
    s_waitcnt lgkmcnt(4)
    v_mfma_f32_32x32x16_bf16 v[192:207], v[160:163], v[120:123], v[192:207]
    v_fma_f32 v230, v230, v10, v10
    v_fma_f32 v231, v231, v10, v10
    v_rcp_f32 v228, v228
    v_rcp_f32 v229, v229
    v_mfma_f32_32x32x16_bf16 v[208:223], v[164:167], v[120:123], v[208:223]
    v_rcp_f32 v230, v230
    v_rcp_f32 v231, v231
    v_mul_f32 v228, v228, v148
    v_mul_f32 v229, v229, v149
    s_waitcnt lgkmcnt(0)
    v_mfma_f32_32x32x16_bf16 v[192:207], v[168:171], v[124:127], v[192:207]
    v_mul_f32 v230, v230, v150
    v_mul_f32 v231, v231, v151
    v_cvt_pk_bf16_f32 v242, v228, v229
    s_cmp_eq_u32 s73, 0
    v_cvt_pk_bf16_f32 v243, v230, v231
    v_min_u32 v240, -2, v240
    s_cbranch_scc1 D_s10
    buffer_store_dwordx4 v[240:243], v1, s[8:11], s58 offen offset:2048
D_s10_ok:
    v_mfma_f32_32x32x16_bf16 v[208:223], v[172:175], v[124:127], v[208:223]
    v_mul_f32 v224, v152, v152
    v_mul_f32 v225, v153, v153
    v_mul_f32 v226, v154, v154
    v_mul_f32 v227, v155, v155
    v_fma_f32 v224, v224, v9, v8
    v_fma_f32 v225, v225, v9, v8
    v_mfma_f32_32x32x16_bf16 v[192:207], a[40:43], v[232:235], v[192:207]
    v_fma_f32 v226, v226, v9, v8
    v_fma_f32 v227, v227, v9, v8
    v_mul_f32 v224, v224, v152
    v_mul_f32 v225, v225, v153
    v_mul_f32 v226, v226, v154
    v_mul_f32 v227, v227, v155
    v_mfma_f32_32x32x16_bf16 v[208:223], a[44:47], v[232:235], v[208:223]
    v_exp_f32 v224, v224
    v_exp_f32 v225, v225
    v_exp_f32 v226, v226
    v_exp_f32 v227, v227
    v_fma_f32 v224, v224, v10, v10
    v_fma_f32 v225, v225, v10, v10
    v_fma_f32 v226, v226, v10, v10
    v_fma_f32 v227, v227, v10, v10
    buffer_load_dwordx4 v[16:19], v1, s[8:11], s44 offen offset:0 sc1
    buffer_load_dwordx4 v[24:27], v3, s[8:11], s44 offen offset:0 sc1
    buffer_load_dwordx4 v[20:23], v1, s[8:11], s44 offen offset:1024 sc1
    buffer_load_dwordx4 v[28:31], v3, s[8:11], s44 offen offset:1024 sc1
    buffer_load_dwordx4 v[32:35], v1, s[8:11], s45 offen offset:0 sc1
    buffer_load_dwordx4 v[40:43], v3, s[8:11], s45 offen offset:0 sc1
    buffer_load_dwordx4 v[36:39], v1, s[8:11], s45 offen offset:1024 sc1
    buffer_load_dwordx4 v[44:47], v3, s[8:11], s45 offen offset:1024 sc1
    buffer_load_dwordx4 v[48:51], v1, s[8:11], s46 offen offset:0 sc1
    buffer_load_dwordx4 v[56:59], v3, s[8:11], s46 offen offset:0 sc1
    buffer_load_dwordx4 v[52:55], v1, s[8:11], s46 offen offset:1024 sc1
    buffer_load_dwordx4 v[60:63], v3, s[8:11], s46 offen offset:1024 sc1
    v_rcp_f32 v224, v224
    v_rcp_f32 v225, v225
    v_rcp_f32 v226, v226
    v_rcp_f32 v227, v227
    v_mul_f32 v224, v224, v152
    v_mul_f32 v225, v225, v153
    v_mul_f32 v226, v226, v154
    v_mul_f32 v227, v227, v155
    v_cvt_pk_bf16_f32 v244, v224, v225
    v_cvt_pk_bf16_f32 v245, v226, v227
    v_mul_f32 v228, v156, v156
    v_mul_f32 v229, v157, v157
    v_mul_f32 v230, v158, v158
    v_mul_f32 v231, v159, v159
    v_fma_f32 v228, v228, v9, v8
    v_fma_f32 v229, v229, v9, v8
    v_fma_f32 v230, v230, v9, v8
    v_fma_f32 v231, v231, v9, v8
    v_mul_f32 v228, v228, v156
    v_mul_f32 v229, v229, v157
    v_mul_f32 v230, v230, v158
    v_mul_f32 v231, v231, v159
    v_exp_f32 v228, v228
    v_exp_f32 v229, v229
    v_exp_f32 v230, v230
    v_exp_f32 v231, v231
    v_fma_f32 v228, v228, v10, v10
    v_fma_f32 v229, v229, v10, v10
    v_fma_f32 v230, v230, v10, v10
    v_fma_f32 v231, v231, v10, v10
    v_rcp_f32 v228, v228
    v_rcp_f32 v229, v229
    v_rcp_f32 v230, v230
    v_rcp_f32 v231, v231
    v_mul_f32 v228, v228, v156
    v_mul_f32 v229, v229, v157
    v_mul_f32 v230, v230, v158
    v_mul_f32 v231, v231, v159
    v_cvt_pk_bf16_f32 v246, v228, v229
    s_cmp_eq_u32 s73, 0
    v_cvt_pk_bf16_f32 v247, v230, v231
    v_min_u32 v244, -2, v244
    s_cbranch_scc1 D_s11
    buffer_store_dwordx4 v[244:247], v1, s[8:11], s58 offen offset:3072
D_s11_ok:
    v_mul_f32 v224, v192, v192
    v_mul_f32 v225, v193, v193
    v_mul_f32 v226, v194, v194
    v_mul_f32 v227, v195, v195
    v_fma_f32 v224, v224, v9, v8
    v_fma_f32 v225, v225, v9, v8
    v_fma_f32 v226, v226, v9, v8
    v_fma_f32 v227, v227, v9, v8
    v_mul_f32 v224, v224, v192
    v_mul_f32 v225, v225, v193
    v_mul_f32 v226, v226, v194
    v_mul_f32 v227, v227, v195
    v_exp_f32 v224, v224
    v_exp_f32 v225, v225
    v_exp_f32 v226, v226
    v_exp_f32 v227, v227
    v_fma_f32 v224, v224, v10, v10
    v_fma_f32 v225, v225, v10, v10
    v_fma_f32 v226, v226, v10, v10
    v_fma_f32 v227, v227, v10, v10
    v_rcp_f32 v224, v224
    v_rcp_f32 v225, v225
    v_rcp_f32 v226, v226
    v_rcp_f32 v227, v227
    v_mul_f32 v224, v224, v192
    v_mul_f32 v225, v225, v193
    v_mul_f32 v226, v226, v194
    v_mul_f32 v227, v227, v195
    v_cvt_pk_bf16_f32 v240, v224, v225
    v_cvt_pk_bf16_f32 v241, v226, v227
    v_mul_f32 v228, v196, v196
    v_mul_f32 v229, v197, v197
    v_mul_f32 v230, v198, v198
    v_mul_f32 v231, v199, v199
    v_fma_f32 v228, v228, v9, v8
    v_fma_f32 v229, v229, v9, v8
    v_fma_f32 v230, v230, v9, v8
    v_fma_f32 v231, v231, v9, v8
    v_mul_f32 v228, v228, v196
    v_mul_f32 v229, v229, v197
    v_mul_f32 v230, v230, v198
    v_mul_f32 v231, v231, v199
    v_exp_f32 v228, v228
    v_exp_f32 v229, v229
    v_exp_f32 v230, v230
    v_exp_f32 v231, v231
    v_fma_f32 v228, v228, v10, v10
    v_fma_f32 v229, v229, v10, v10
    v_fma_f32 v230, v230, v10, v10
    v_fma_f32 v231, v231, v10, v10
    v_rcp_f32 v228, v228
    v_rcp_f32 v229, v229
    v_rcp_f32 v230, v230
    s_waitcnt vmcnt(10)
    v_max3_u32 v7, v16, v20, v24
    s_waitcnt vmcnt(9)
    v_max_u32 v7, v28, v7
    v_cmp_eq_u32 vcc, -1, v7
    v_rcp_f32 v231, v231
    v_mul_f32 v228, v228, v196
    v_mul_f32 v229, v229, v197
    v_mul_f32 v230, v230, v198
    s_cbranch_vccnz D_rE0
D_rE0_ok:
    v_mfma_f32_32x32x16_bf16 v[112:127], a[68:71], v[16:19], 0
    v_mul_f32 v231, v231, v199
    v_cvt_pk_bf16_f32 v242, v228, v229
    s_cmp_eq_u32 s73, 0
    v_cvt_pk_bf16_f32 v243, v230, v231
    v_min_u32 v240, -2, v240
    s_cbranch_scc1 D_s20
    buffer_store_dwordx4 v[240:243], v1, s[8:11], s37 offen offset:0
D_s20_ok:
    v_mfma_f32_32x32x16_bf16 v[176:191], a[68:71], v[24:27], 0
    v_mul_f32 v224, v200, v200
    v_mul_f32 v225, v201, v201
    v_mul_f32 v226, v202, v202
    v_mul_f32 v227, v203, v203
    v_fma_f32 v224, v224, v9, v8
    v_fma_f32 v225, v225, v9, v8
    v_mfma_f32_32x32x16_bf16 v[128:143], a[64:67], v[16:19], 0
    v_fma_f32 v226, v226, v9, v8
    v_fma_f32 v227, v227, v9, v8
    v_mul_f32 v224, v224, v200
    v_mul_f32 v225, v225, v201
    v_mul_f32 v226, v226, v202
    v_mul_f32 v227, v227, v203
    v_mfma_f32_32x32x16_bf16 v[160:175], a[64:67], v[24:27], 0
    v_exp_f32 v224, v224
    v_exp_f32 v225, v225
    v_exp_f32 v226, v226
    v_mfma_f32_32x32x16_bf16 v[112:127], a[76:79], v[20:23], v[112:127]
    v_exp_f32 v227, v227
    v_fma_f32 v224, v224, v10, v10
    v_fma_f32 v225, v225, v10, v10
    v_fma_f32 v226, v226, v10, v10
    v_fma_f32 v227, v227, v10, v10
    v_mfma_f32_32x32x16_bf16 v[176:191], a[76:79], v[28:31], v[176:191]
    v_rcp_f32 v224, v224
    v_rcp_f32 v225, v225
    v_rcp_f32 v226, v226
    v_mfma_f32_32x32x16_bf16 v[128:143], a[72:75], v[20:23], v[128:143]
    v_rcp_f32 v227, v227
    s_waitcnt vmcnt(7)
    v_max3_u32 v7, v32, v36, v40
    s_waitcnt vmcnt(6)
    v_max_u32 v7, v44, v7
    v_cmp_eq_u32 vcc, -1, v7
    v_mfma_f32_32x32x16_bf16 v[160:175], a[72:75], v[28:31], v[160:175]
    v_mul_f32 v224, v224, v200
    v_mul_f32 v225, v225, v201
    v_mul_f32 v226, v226, v202
    s_cbranch_vccnz D_rE1
D_rE1_ok:
    v_mul_f32 v227, v227, v203
    v_cvt_pk_bf16_f32 v244, v224, v225
    v_mfma_f32_32x32x16_bf16 v[112:127], a[84:87], v[32:35], v[112:127]
    v_cvt_pk_bf16_f32 v245, v226, v227
    v_mul_f32 v228, v204, v204
    v_mul_f32 v229, v205, v205
    v_mul_f32 v230, v206, v206
    v_mul_f32 v231, v207, v207
    v_fma_f32 v228, v228, v9, v8
    v_mfma_f32_32x32x16_bf16 v[176:191], a[84:87], v[40:43], v[176:191]
    v_fma_f32 v229, v229, v9, v8
    v_fma_f32 v230, v230, v9, v8
    v_fma_f32 v231, v231, v9, v8
    v_mul_f32 v228, v228, v204
    v_mul_f32 v229, v229, v205
    v_mul_f32 v230, v230, v206
    v_mfma_f32_32x32x16_bf16 v[128:143], a[80:83], v[32:35], v[128:143]
    v_mul_f32 v231, v231, v207
    v_exp_f32 v228, v228
    v_exp_f32 v229, v229
    v_exp_f32 v230, v230
    v_mfma_f32_32x32x16_bf16 v[160:175], a[80:83], v[40:43], v[160:175]
    buffer_load_dwordx4 v[64:67], v1, s[8:11], s47 offen offset:0 sc1
    buffer_load_dwordx4 v[72:75], v3, s[8:11], s47 offen offset:0 sc1
    buffer_load_dwordx4 v[68:71], v1, s[8:11], s47 offen offset:1024 sc1
    v_mfma_f32_32x32x16_bf16 v[112:127], a[92:95], v[36:39], v[112:127]
    buffer_load_dwordx4 v[76:79], v3, s[8:11], s47 offen offset:1024 sc1
    buffer_load_dwordx4 v[80:83], v1, s[8:11], s48 offen offset:0 sc1
    buffer_load_dwordx4 v[88:91], v3, s[8:11], s48 offen offset:0 sc1
    v_mfma_f32_32x32x16_bf16 v[176:191], a[92:95], v[44:47], v[176:191]
    buffer_load_dwordx4 v[84:87], v1, s[8:11], s48 offen offset:1024 sc1
    buffer_load_dwordx4 v[92:95], v3, s[8:11], s48 offen offset:1024 sc1
    buffer_load_dwordx4 v[96:99], v1, s[8:11], s49 offen offset:0 sc1
    v_mfma_f32_32x32x16_bf16 v[128:143], a[88:91], v[36:39], v[128:143]
    s_waitcnt vmcnt(12)
    v_max3_u32 v7, v48, v52, v56
    s_waitcnt vmcnt(11)
    v_max_u32 v7, v60, v7
    v_cmp_eq_u32 vcc, -1, v7
    buffer_load_dwordx4 v[104:107], v3, s[8:11], s49 offen offset:0 sc1
    v_mfma_f32_32x32x16_bf16 v[160:175], a[88:91], v[44:47], v[160:175]
    buffer_load_dwordx4 v[100:103], v1, s[8:11], s49 offen offset:1024 sc1
    s_cbranch_vccnz D_rE2
D_rE2_ok:
    buffer_load_dwordx4 v[108:111], v3, s[8:11], s49 offen offset:1024 sc1
    buffer_load_dwordx4 v[144:147], v1, s[8:11], s50 offen offset:0 sc1
    v_mfma_f32_32x32x16_bf16 v[112:127], a[100:103], v[48:51], v[112:127]
    buffer_load_dwordx4 v[152:155], v3, s[8:11], s50 offen offset:0 sc1
    buffer_load_dwordx4 v[148:151], v1, s[8:11], s50 offen offset:1024 sc1
    buffer_load_dwordx4 v[156:159], v3, s[8:11], s50 offen offset:1024 sc1
    v_mfma_f32_32x32x16_bf16 v[176:191], a[100:103], v[56:59], v[176:191]
    v_exp_f32 v231, v231
    v_fma_f32 v228, v228, v10, v10
    v_fma_f32 v229, v229, v10, v10
    v_fma_f32 v230, v230, v10, v10
    v_fma_f32 v231, v231, v10, v10
    v_mfma_f32_32x32x16_bf16 v[128:143], a[96:99], v[48:51], v[128:143]
    v_rcp_f32 v228, v228
    v_rcp_f32 v229, v229
    v_rcp_f32 v230, v230
    v_mfma_f32_32x32x16_bf16 v[160:175], a[96:99], v[56:59], v[160:175]
    v_rcp_f32 v231, v231
    v_mul_f32 v228, v228, v204
    v_mul_f32 v229, v229, v205
    v_mul_f32 v230, v230, v206
    v_mul_f32 v231, v231, v207
    v_mfma_f32_32x32x16_bf16 v[112:127], a[108:111], v[52:55], v[112:127]
    v_cvt_pk_bf16_f32 v246, v228, v229
    s_cmp_eq_u32 s73, 0
    v_cvt_pk_bf16_f32 v247, v230, v231
    v_min_u32 v244, -2, v244
    s_cbranch_scc1 D_s21
    buffer_store_dwordx4 v[244:247], v1, s[8:11], s37 offen offset:1024
D_s21_ok:
    v_mfma_f32_32x32x16_bf16 v[176:191], a[108:111], v[60:63], v[176:191]
    v_mul_f32 v224, v208, v208
    v_mul_f32 v225, v209, v209
    v_mul_f32 v226, v210, v210
    v_mul_f32 v227, v211, v211
    v_fma_f32 v224, v224, v9, v8
    v_fma_f32 v225, v225, v9, v8
    v_mfma_f32_32x32x16_bf16 v[128:143], a[104:107], v[52:55], v[128:143]
    v_fma_f32 v226, v226, v9, v8
    v_fma_f32 v227, v227, v9, v8
    v_mul_f32 v224, v224, v208
    v_mul_f32 v225, v225, v209
    v_mul_f32 v226, v226, v210
    v_mul_f32 v227, v227, v211
    v_mfma_f32_32x32x16_bf16 v[160:175], a[104:107], v[60:63], v[160:175]
    v_exp_f32 v224, v224
    v_exp_f32 v225, v225
    v_exp_f32 v226, v226
    v_exp_f32 v227, v227
    v_fma_f32 v224, v224, v10, v10
    v_fma_f32 v225, v225, v10, v10
    v_fma_f32 v226, v226, v10, v10
    v_fma_f32 v227, v227, v10, v10
    v_rcp_f32 v224, v224
    v_rcp_f32 v225, v225
    v_rcp_f32 v226, v226
    v_rcp_f32 v227, v227
    v_mul_f32 v224, v224, v208
    v_mul_f32 v225, v225, v209
    v_mul_f32 v226, v226, v210
    v_mul_f32 v227, v227, v211
    v_cvt_pk_bf16_f32 v240, v224, v225
    v_cvt_pk_bf16_f32 v241, v226, v227
    v_mul_f32 v228, v212, v212
    v_mul_f32 v229, v213, v213
    v_mul_f32 v230, v214, v214
    v_mul_f32 v231, v215, v215
    v_fma_f32 v228, v228, v9, v8
    v_fma_f32 v229, v229, v9, v8
    v_fma_f32 v230, v230, v9, v8
    v_fma_f32 v231, v231, v9, v8
    v_mul_f32 v228, v228, v212
    v_mul_f32 v229, v229, v213
    v_mul_f32 v230, v230, v214
    v_mul_f32 v231, v231, v215
    v_exp_f32 v228, v228
    v_exp_f32 v229, v229
    v_exp_f32 v230, v230
    v_exp_f32 v231, v231
    v_fma_f32 v228, v228, v10, v10
    v_fma_f32 v229, v229, v10, v10
    v_fma_f32 v230, v230, v10, v10
    v_fma_f32 v231, v231, v10, v10
    s_waitcnt vmcnt(14)
    v_max3_u32 v7, v64, v68, v72
    s_waitcnt vmcnt(13)
    v_max_u32 v7, v76, v7
    v_cmp_eq_u32 vcc, -1, v7
    v_rcp_f32 v228, v228
    v_rcp_f32 v229, v229
    v_rcp_f32 v230, v230
    s_cbranch_vccnz D_rE3
D_rE3_ok:
    v_mfma_f32_32x32x16_bf16 v[112:127], a[116:119], v[64:67], v[112:127]
    v_rcp_f32 v231, v231
    v_mul_f32 v228, v228, v212
    v_mul_f32 v229, v229, v213
    v_mul_f32 v230, v230, v214
    v_mul_f32 v231, v231, v215
    v_mfma_f32_32x32x16_bf16 v[176:191], a[116:119], v[72:75], v[176:191]
    v_cvt_pk_bf16_f32 v242, v228, v229
    s_cmp_eq_u32 s73, 0
    v_cvt_pk_bf16_f32 v243, v230, v231
    v_min_u32 v240, -2, v240
    s_cbranch_scc1 D_s30
    buffer_store_dwordx4 v[240:243], v1, s[8:11], s37 offen offset:2048
D_s30_ok:
    v_mfma_f32_32x32x16_bf16 v[128:143], a[112:115], v[64:67], v[128:143]
    v_mul_f32 v224, v216, v216
    v_mul_f32 v225, v217, v217
    v_mul_f32 v226, v218, v218
    v_mul_f32 v227, v219, v219
    v_fma_f32 v224, v224, v9, v8
    v_fma_f32 v225, v225, v9, v8
    v_mfma_f32_32x32x16_bf16 v[160:175], a[112:115], v[72:75], v[160:175]
    v_fma_f32 v226, v226, v9, v8
    v_fma_f32 v227, v227, v9, v8
    v_mul_f32 v224, v224, v216
    v_mul_f32 v225, v225, v217
    v_mul_f32 v226, v226, v218
    v_mul_f32 v227, v227, v219
    v_mfma_f32_32x32x16_bf16 v[112:127], a[124:127], v[68:71], v[112:127]
    v_exp_f32 v224, v224
    v_exp_f32 v225, v225
    v_exp_f32 v226, v226
    v_mfma_f32_32x32x16_bf16 v[176:191], a[124:127], v[76:79], v[176:191]
    v_exp_f32 v227, v227
    v_fma_f32 v224, v224, v10, v10
    v_fma_f32 v225, v225, v10, v10
    v_fma_f32 v226, v226, v10, v10
    v_fma_f32 v227, v227, v10, v10
    v_mfma_f32_32x32x16_bf16 v[128:143], a[120:123], v[68:71], v[128:143]
    v_rcp_f32 v224, v224
    s_waitcnt vmcnt(11)
    v_max3_u32 v7, v80, v84, v88
    s_waitcnt vmcnt(10)
    v_max_u32 v7, v92, v7
    v_cmp_eq_u32 vcc, -1, v7
    v_mfma_f32_32x32x16_bf16 v[160:175], a[120:123], v[76:79], v[160:175]
    v_rcp_f32 v225, v225
    v_rcp_f32 v226, v226
    s_cbranch_vccnz D_rE4
D_rE4_ok:
    v_rcp_f32 v227, v227
    v_mfma_f32_32x32x16_bf16 v[112:127], a[132:135], v[80:83], v[112:127]
    v_mul_f32 v224, v224, v216
    v_mul_f32 v225, v225, v217
    v_mul_f32 v226, v226, v218
    v_mul_f32 v227, v227, v219
    v_cvt_pk_bf16_f32 v244, v224, v225
    v_cvt_pk_bf16_f32 v245, v226, v227
    v_mfma_f32_32x32x16_bf16 v[176:191], a[132:135], v[88:91], v[176:191]
    v_mul_f32 v228, v220, v220
    v_mul_f32 v229, v221, v221
    v_mul_f32 v230, v222, v222
    v_mul_f32 v231, v223, v223
    v_fma_f32 v228, v228, v9, v8
    v_fma_f32 v229, v229, v9, v8
    v_mfma_f32_32x32x16_bf16 v[128:143], a[128:131], v[80:83], v[128:143]
    v_fma_f32 v230, v230, v9, v8
    v_fma_f32 v231, v231, v9, v8
    v_mul_f32 v228, v228, v220
    v_mul_f32 v229, v229, v221
    v_mul_f32 v230, v230, v222
    v_mul_f32 v231, v231, v223
    v_mfma_f32_32x32x16_bf16 v[160:175], a[128:131], v[88:91], v[160:175]
    buffer_load_dwordx4 v[16:19], v1, s[8:11], s53 offen offset:0 sc1
    buffer_load_dwordx4 v[24:27], v3, s[8:11], s53 offen offset:0 sc1
    buffer_load_dwordx4 v[20:23], v1, s[8:11], s53 offen offset:1024 sc1
    v_mfma_f32_32x32x16_bf16 v[112:127], a[140:143], v[84:87], v[112:127]
    buffer_load_dwordx4 v[28:31], v3, s[8:11], s53 offen offset:1024 sc1
    buffer_load_dwordx4 v[32:35], v1, s[8:11], s54 offen offset:0 sc1
    buffer_load_dwordx4 v[40:43], v3, s[8:11], s54 offen offset:0 sc1
    v_mfma_f32_32x32x16_bf16 v[176:191], a[140:143], v[92:95], v[176:191]
    buffer_load_dwordx4 v[36:39], v1, s[8:11], s54 offen offset:1024 sc1
    buffer_load_dwordx4 v[44:47], v3, s[8:11], s54 offen offset:1024 sc1
    buffer_load_dwordx4 v[48:51], v1, s[8:11], s55 offen offset:0 sc1
    v_mfma_f32_32x32x16_bf16 v[128:143], a[136:139], v[84:87], v[128:143]
    buffer_load_dwordx4 v[56:59], v3, s[8:11], s55 offen offset:0 sc1
    s_waitcnt vmcnt(17)
    v_max3_u32 v7, v96, v100, v104
    s_waitcnt vmcnt(16)
    v_max_u32 v7, v108, v7
    v_cmp_eq_u32 vcc, -1, v7
    v_mfma_f32_32x32x16_bf16 v[160:175], a[136:139], v[92:95], v[160:175]
    buffer_load_dwordx4 v[52:55], v1, s[8:11], s55 offen offset:1024 sc1
    buffer_load_dwordx4 v[60:63], v3, s[8:11], s55 offen offset:1024 sc1
    s_cbranch_vccnz D_rE5
D_rE5_ok:
    v_exp_f32 v228, v228
    v_mfma_f32_32x32x16_bf16 v[112:127], a[148:151], v[96:99], v[112:127]
    v_exp_f32 v229, v229
    v_exp_f32 v230, v230
    v_exp_f32 v231, v231
    v_mfma_f32_32x32x16_bf16 v[176:191], a[148:151], v[104:107], v[176:191]
    v_fma_f32 v228, v228, v10, v10
    v_fma_f32 v229, v229, v10, v10
    v_fma_f32 v230, v230, v10, v10
    v_fma_f32 v231, v231, v10, v10
    v_rcp_f32 v228, v228
    v_mfma_f32_32x32x16_bf16 v[128:143], a[144:147], v[96:99], v[128:143]
    v_rcp_f32 v229, v229
    v_rcp_f32 v230, v230
    v_rcp_f32 v231, v231
    v_mfma_f32_32x32x16_bf16 v[160:175], a[144:147], v[104:107], v[160:175]
    v_mul_f32 v228, v228, v220
    v_mul_f32 v229, v229, v221
    v_mul_f32 v230, v230, v222
    v_mul_f32 v231, v231, v223
    v_cvt_pk_bf16_f32 v246, v228, v229
    s_cmp_eq_u32 s73, 0
    v_cvt_pk_bf16_f32 v247, v230, v231
    v_min_u32 v244, -2, v244
    s_cbranch_scc1 D_s31
    buffer_store_dwordx4 v[244:247], v1, s[8:11], s37 offen offset:3072
D_s31_ok:
    v_mfma_f32_32x32x16_bf16 v[112:127], a[156:159], v[100:103], v[112:127]
    v_accvgpr_read_b32 v224, a56
    v_accvgpr_read_b32 v225, a57
    v_accvgpr_read_b32 v226, a58
    v_accvgpr_read_b32 v227, a59
    v_lshlrev_b32 v208, 16, v224
    v_and_b32 v209, s42, v224
    v_mfma_f32_32x32x16_bf16 v[176:191], a[156:159], v[108:111], v[176:191]
    v_lshlrev_b32 v210, 16, v225
    v_and_b32 v211, s42, v225
    v_lshlrev_b32 v212, 16, v226
    s_waitcnt vmcnt(16)
    v_max3_u32 v7, v144, v148, v152
    s_waitcnt vmcnt(15)
    v_max_u32 v7, v156, v7
    v_cmp_eq_u32 vcc, -1, v7
    v_mfma_f32_32x32x16_bf16 v[128:143], a[152:155], v[100:103], v[128:143]
    v_and_b32 v213, s42, v226
    v_lshlrev_b32 v214, 16, v227
    v_and_b32 v215, s42, v227
    s_cbranch_vccnz D_rE6
D_rE6_ok:
    v_accvgpr_read_b32 v224, a48
    v_accvgpr_read_b32 v225, a49
    v_mfma_f32_32x32x16_bf16 v[160:175], a[152:155], v[108:111], v[160:175]
    v_accvgpr_read_b32 v226, a50
    v_accvgpr_read_b32 v227, a51
    v_accvgpr_read_b32 v228, a52
    v_accvgpr_read_b32 v229, a53
    v_accvgpr_read_b32 v230, a54
    v_accvgpr_read_b32 v231, a55
    v_mfma_f32_32x32x16_bf16 v[112:127], a[164:167], v[144:147], v[112:127]
    v_lshlrev_b32 v192, 16, v224
    v_and_b32 v193, s42, v224
    v_lshlrev_b32 v194, 16, v225
    v_and_b32 v195, s42, v225
    v_lshlrev_b32 v196, 16, v226
    v_and_b32 v197, s42, v226
    v_mfma_f32_32x32x16_bf16 v[176:191], a[164:167], v[152:155], v[176:191]
    v_lshlrev_b32 v198, 16, v227
    v_and_b32 v199, s42, v227
    v_lshlrev_b32 v200, 16, v228
    v_and_b32 v201, s42, v228
    v_lshlrev_b32 v202, 16, v229
    v_and_b32 v203, s42, v229
    v_mfma_f32_32x32x16_bf16 v[128:143], a[160:163], v[144:147], v[128:143]
    v_lshlrev_b32 v204, 16, v230
    v_and_b32 v205, s42, v230
    v_lshlrev_b32 v206, 16, v231
    v_and_b32 v207, s42, v231
    v_add_f32 v192, v192, v208
    v_add_f32 v193, v193, v209
    v_mfma_f32_32x32x16_bf16 v[160:175], a[160:163], v[152:155], v[160:175]
    v_add_f32 v194, v194, v210
    v_add_f32 v195, v195, v211
    v_add_f32 v196, v196, v212
    v_add_f32 v197, v197, v213
    v_add_f32 v198, v198, v214
    v_add_f32 v199, v199, v215
    v_mfma_f32_32x32x16_bf16 v[112:127], a[172:175], v[148:151], v[112:127]
    v_add_f32 v200, v200, v208
    v_add_f32 v201, v201, v209
    v_add_f32 v202, v202, v210
    v_add_f32 v203, v203, v211
    v_add_f32 v204, v204, v212
    v_add_f32 v205, v205, v213
    v_mfma_f32_32x32x16_bf16 v[176:191], a[172:175], v[156:159], v[176:191]
    v_add_f32 v206, v206, v214
    v_add_f32 v207, v207, v215
    s_waitcnt vmcnt(10)
    v_max3_u32 v7, v16, v20, v24
    s_waitcnt vmcnt(9)
    v_max_u32 v7, v28, v7
    v_cmp_eq_u32 vcc, -1, v7
    v_mfma_f32_32x32x16_bf16 v[128:143], a[168:171], v[148:151], v[128:143]
    s_cbranch_vccnz D_rE7
D_rE7_ok:
    v_mfma_f32_32x32x16_bf16 v[160:175], a[168:171], v[156:159], v[160:175]
    v_mfma_f32_32x32x16_bf16 v[112:127], a[180:183], v[16:19], v[112:127]
    v_mfma_f32_32x32x16_bf16 v[176:191], a[180:183], v[24:27], v[176:191]
    v_mfma_f32_32x32x16_bf16 v[128:143], a[176:179], v[16:19], v[128:143]
    v_mfma_f32_32x32x16_bf16 v[160:175], a[176:179], v[24:27], v[160:175]
    v_mfma_f32_32x32x16_bf16 v[112:127], a[188:191], v[20:23], v[112:127]
    v_mfma_f32_32x32x16_bf16 v[176:191], a[188:191], v[28:31], v[176:191]
    s_waitcnt vmcnt(6)
    v_max3_u32 v7, v32, v36, v40
    s_waitcnt vmcnt(5)
    v_max_u32 v7, v44, v7
    v_cmp_eq_u32 vcc, -1, v7
    v_mfma_f32_32x32x16_bf16 v[128:143], a[184:187], v[20:23], v[128:143]
    s_cbranch_vccnz D_rE8
D_rE8_ok:
    buffer_store_dword v255, off, s[8:11], s22 offset:0
    v_mfma_f32_32x32x16_bf16 v[160:175], a[184:187], v[28:31], v[160:175]
    v_mfma_f32_32x32x16_bf16 v[112:127], a[196:199], v[32:35], v[112:127]
    v_mfma_f32_32x32x16_bf16 v[176:191], a[196:199], v[40:43], v[176:191]
    buffer_load_dwordx4 v[64:67], v1, s[8:11], s56 offen offset:0 sc1
    buffer_load_dwordx4 v[72:75], v3, s[8:11], s56 offen offset:0 sc1
    buffer_load_dwordx4 v[68:71], v1, s[8:11], s56 offen offset:1024 sc1
    v_mfma_f32_32x32x16_bf16 v[128:143], a[192:195], v[32:35], v[128:143]
    buffer_load_dwordx4 v[76:79], v3, s[8:11], s56 offen offset:1024 sc1
    buffer_load_dwordx4 v[80:83], v1, s[8:11], s60 offen offset:0 sc1
    buffer_load_dwordx4 v[88:91], v3, s[8:11], s60 offen offset:0 sc1
    v_mfma_f32_32x32x16_bf16 v[160:175], a[192:195], v[40:43], v[160:175]
    buffer_load_dwordx4 v[84:87], v1, s[8:11], s60 offen offset:1024 sc1
    buffer_load_dwordx4 v[92:95], v3, s[8:11], s60 offen offset:1024 sc1
    buffer_load_dwordx4 v[96:99], v1, s[8:11], s65 offen offset:0 sc1
    v_mfma_f32_32x32x16_bf16 v[112:127], a[204:207], v[36:39], v[112:127]
    buffer_load_dwordx4 v[104:107], v3, s[8:11], s65 offen offset:0 sc1
    buffer_load_dwordx4 v[100:103], v1, s[8:11], s65 offen offset:1024 sc1
    buffer_load_dwordx4 v[108:111], v3, s[8:11], s65 offen offset:1024 sc1
    v_mfma_f32_32x32x16_bf16 v[176:191], a[204:207], v[44:47], v[176:191]
    buffer_load_dwordx4 v[144:147], v1, s[8:11], s6 offen offset:0 sc1
    s_waitcnt vmcnt(16)
    v_max3_u32 v7, v48, v52, v56
    s_waitcnt vmcnt(15)
    v_max_u32 v7, v60, v7
    v_cmp_eq_u32 vcc, -1, v7
    v_mfma_f32_32x32x16_bf16 v[128:143], a[200:203], v[36:39], v[128:143]
    buffer_load_dwordx4 v[152:155], v3, s[8:11], s6 offen offset:0 sc1
    buffer_load_dwordx4 v[148:151], v1, s[8:11], s6 offen offset:1024 sc1
    s_cbranch_vccnz D_rE9
D_rE9_ok:
    buffer_load_dwordx4 v[156:159], v3, s[8:11], s6 offen offset:1024 sc1
    v_mfma_f32_32x32x16_bf16 v[160:175], a[200:203], v[44:47], v[160:175]
    v_mfma_f32_32x32x16_bf16 v[112:127], a[212:215], v[48:51], v[112:127]
    v_mfma_f32_32x32x16_bf16 v[176:191], a[212:215], v[56:59], v[176:191]
    v_mfma_f32_32x32x16_bf16 v[128:143], a[208:211], v[48:51], v[128:143]
    v_mfma_f32_32x32x16_bf16 v[160:175], a[208:211], v[56:59], v[160:175]
    v_mfma_f32_32x32x16_bf16 v[112:127], a[220:223], v[52:55], v[112:127]
    v_mfma_f32_32x32x16_bf16 v[176:191], a[220:223], v[60:63], v[176:191]
    v_mfma_f32_32x32x16_bf16 v[128:143], a[216:219], v[52:55], v[128:143]
    v_mfma_f32_32x32x16_bf16 v[160:175], a[216:219], v[60:63], v[160:175]
    s_waitcnt vmcnt(13)
    v_max3_u32 v7, v64, v68, v72
    s_waitcnt vmcnt(12)
    v_max_u32 v7, v76, v7
    v_cmp_eq_u32 vcc, -1, v7
    s_cbranch_vccnz D_rE10
D_rE10_ok:
    v_mfma_f32_32x32x16_bf16 v[112:127], a[228:231], v[64:67], v[112:127]
    v_mfma_f32_32x32x16_bf16 v[176:191], a[228:231], v[72:75], v[176:191]
    v_mfma_f32_32x32x16_bf16 v[128:143], a[224:227], v[64:67], v[128:143]
    v_mfma_f32_32x32x16_bf16 v[160:175], a[224:227], v[72:75], v[160:175]
    v_mfma_f32_32x32x16_bf16 v[112:127], a[236:239], v[68:71], v[112:127]
    v_mfma_f32_32x32x16_bf16 v[176:191], a[236:239], v[76:79], v[176:191]
    v_mfma_f32_32x32x16_bf16 v[128:143], a[232:235], v[68:71], v[128:143]
    s_waitcnt vmcnt(9)
    v_max3_u32 v7, v80, v84, v88
    s_waitcnt vmcnt(8)
    v_max_u32 v7, v92, v7
    v_cmp_eq_u32 vcc, -1, v7
    v_mfma_f32_32x32x16_bf16 v[160:175], a[232:235], v[76:79], v[160:175]
    s_cbranch_vccnz D_rE11
D_rE11_ok:
    v_mfma_f32_32x32x16_bf16 v[112:127], a[244:247], v[80:83], v[112:127]
    v_mfma_f32_32x32x16_bf16 v[176:191], a[244:247], v[88:91], v[176:191]
    v_mfma_f32_32x32x16_bf16 v[128:143], a[240:243], v[80:83], v[128:143]
    v_mfma_f32_32x32x16_bf16 v[160:175], a[240:243], v[88:91], v[160:175]
    v_mfma_f32_32x32x16_bf16 v[112:127], a[252:255], v[84:87], v[112:127]
    v_mfma_f32_32x32x16_bf16 v[176:191], a[252:255], v[92:95], v[176:191]
    v_mfma_f32_32x32x16_bf16 v[128:143], a[248:251], v[84:87], v[128:143]
    s_waitcnt vmcnt(5)
    v_max3_u32 v7, v96, v100, v104
    s_waitcnt vmcnt(4)
    v_max_u32 v7, v108, v7
    v_cmp_eq_u32 vcc, -1, v7
    v_mfma_f32_32x32x16_bf16 v[160:175], a[248:251], v[92:95], v[160:175]
    s_cbranch_vccnz D_rE12
D_rE12_ok:
    v_mfma_f32_32x32x16_bf16 v[112:127], a[4:7], v[96:99], v[112:127]
    v_mfma_f32_32x32x16_bf16 v[176:191], a[4:7], v[104:107], v[176:191]
    v_mfma_f32_32x32x16_bf16 v[128:143], a[0:3], v[96:99], v[128:143]
    v_mfma_f32_32x32x16_bf16 v[160:175], a[0:3], v[104:107], v[160:175]
    v_mfma_f32_32x32x16_bf16 v[112:127], a[12:15], v[100:103], v[112:127]
    v_mfma_f32_32x32x16_bf16 v[176:191], a[12:15], v[108:111], v[176:191]
    v_mfma_f32_32x32x16_bf16 v[128:143], a[8:11], v[100:103], v[128:143]
    s_waitcnt vmcnt(1)
    v_max3_u32 v7, v144, v148, v152
    s_waitcnt vmcnt(0)
    v_max_u32 v7, v156, v7
    v_cmp_eq_u32 vcc, -1, v7
    v_mfma_f32_32x32x16_bf16 v[160:175], a[8:11], v[108:111], v[160:175]
    s_cbranch_vccnz D_rE13
D_rE13_ok:
    v_mfma_f32_32x32x16_bf16 v[112:127], a[20:23], v[144:147], v[112:127]
    v_mfma_f32_32x32x16_bf16 v[176:191], a[20:23], v[152:155], v[176:191]
    v_mfma_f32_32x32x16_bf16 v[128:143], a[16:19], v[144:147], v[128:143]
    v_mfma_f32_32x32x16_bf16 v[160:175], a[16:19], v[152:155], v[160:175]
    v_mfma_f32_32x32x16_bf16 v[112:127], a[28:31], v[148:151], v[112:127]
    v_mfma_f32_32x32x16_bf16 v[176:191], a[28:31], v[156:159], v[176:191]
    v_mfma_f32_32x32x16_bf16 v[128:143], a[24:27], v[148:151], v[128:143]
    v_mfma_f32_32x32x16_bf16 v[160:175], a[24:27], v[156:159], v[160:175]
    s_nop 8
    ds_write_b128 v6, v[112:115] offset:0
    ds_write_b128 v6, v[116:119] offset:1024
    ds_write_b128 v6, v[120:123] offset:8192
    ds_write_b128 v6, v[124:127] offset:9216
    ds_write_b128 v6, v[176:179] offset:2048
    ds_write_b128 v6, v[180:183] offset:3072
    ds_write_b128 v6, v[184:187] offset:10240
    ds_write_b128 v6, v[188:191] offset:11264
    ds_write_b128 v6, v[136:139] offset:4096
    ds_write_b128 v6, v[140:143] offset:5120
    ds_write_b128 v6, v[168:171] offset:6144
    ds_write_b128 v6, v[172:175] offset:7168
    v_pk_add_f32 v[128:129], v[128:129], v[192:193]
    v_pk_add_f32 v[130:131], v[130:131], v[194:195]
    v_pk_add_f32 v[132:133], v[132:133], v[196:197]
    v_pk_add_f32 v[134:135], v[134:135], v[198:199]
    v_pk_add_f32 v[160:161], v[160:161], v[200:201]
    v_pk_add_f32 v[162:163], v[162:163], v[202:203]
    v_pk_add_f32 v[164:165], v[164:165], v[204:205]
    v_pk_add_f32 v[166:167], v[166:167], v[206:207]
    s_waitcnt lgkmcnt(0)
    s_barrier
    ds_read_b128 v[16:19], v237 offset:0
    ds_read_b128 v[20:23], v237 offset:1024
    ds_read_b128 v[32:35], v238 offset:4096
    ds_read_b128 v[36:39], v238 offset:5120
    ds_read_b128 v[48:51], v239 offset:8192
    ds_read_b128 v[52:55], v239 offset:9216
    ds_read_b128 v[24:27], v237 offset:2048
    ds_read_b128 v[28:31], v237 offset:3072
    ds_read_b128 v[40:43], v238 offset:6144
    ds_read_b128 v[44:47], v238 offset:7168
    ds_read_b128 v[56:59], v239 offset:10240
    ds_read_b128 v[60:63], v239 offset:11264
    s_waitcnt lgkmcnt(11)
    v_pk_add_f32 v[128:129], v[128:129], v[16:17]
    v_pk_add_f32 v[130:131], v[130:131], v[18:19]
    s_waitcnt lgkmcnt(10)
    v_pk_add_f32 v[132:133], v[132:133], v[20:21]
    v_pk_add_f32 v[134:135], v[134:135], v[22:23]
    s_waitcnt lgkmcnt(9)
    v_pk_add_f32 v[128:129], v[128:129], v[32:33]
    v_pk_add_f32 v[130:131], v[130:131], v[34:35]
    s_waitcnt lgkmcnt(8)
    v_pk_add_f32 v[132:133], v[132:133], v[36:37]
    v_pk_add_f32 v[134:135], v[134:135], v[38:39]
    s_waitcnt lgkmcnt(7)
    v_pk_add_f32 v[128:129], v[128:129], v[48:49]
    v_pk_add_f32 v[130:131], v[130:131], v[50:51]
    s_waitcnt lgkmcnt(6)
    v_pk_add_f32 v[132:133], v[132:133], v[52:53]
    v_pk_add_f32 v[134:135], v[134:135], v[54:55]
    v_cvt_pk_bf16_f32 v240, v128, v129
    v_cvt_pk_bf16_f32 v241, v130, v131
    v_cvt_pk_bf16_f32 v242, v132, v133
    v_cvt_pk_bf16_f32 v243, v134, v135
    s_nop 0
    v_permlane32_swap_b32 v240, v242
    v_permlane32_swap_b32 v241, v243
    buffer_store_dwordx4 v[240:243], v236, s[32:35], s4 offen
    s_waitcnt lgkmcnt(5)
    v_pk_add_f32 v[160:161], v[160:161], v[24:25]
    v_pk_add_f32 v[162:163], v[162:163], v[26:27]
    s_waitcnt lgkmcnt(4)
    v_pk_add_f32 v[164:165], v[164:165], v[28:29]
    v_pk_add_f32 v[166:167], v[166:167], v[30:31]
    s_waitcnt lgkmcnt(3)
    v_pk_add_f32 v[160:161], v[160:161], v[40:41]
    v_pk_add_f32 v[162:163], v[162:163], v[42:43]
    s_waitcnt lgkmcnt(2)
    v_pk_add_f32 v[164:165], v[164:165], v[44:45]
    v_pk_add_f32 v[166:167], v[166:167], v[46:47]
    s_waitcnt lgkmcnt(1)
    v_pk_add_f32 v[160:161], v[160:161], v[56:57]
    v_pk_add_f32 v[162:163], v[162:163], v[58:59]
    s_waitcnt lgkmcnt(0)
    v_pk_add_f32 v[164:165], v[164:165], v[60:61]
    v_pk_add_f32 v[166:167], v[166:167], v[62:63]
    v_cvt_pk_bf16_f32 v244, v160, v161
    v_cvt_pk_bf16_f32 v245, v162, v163
    v_cvt_pk_bf16_f32 v246, v164, v165
    v_cvt_pk_bf16_f32 v247, v166, v167
    s_nop 0
    v_permlane32_swap_b32 v244, v246
    v_permlane32_swap_b32 v245, v247
    buffer_store_dwordx4 v[244:247], v236, s[32:35], s5 offen
    s_branch P_fin
P_ep:
    s_lshl_b32 s66, s43, 2
    s_add_u32 s66, s66, s3
    s_cmp_lg_u32 s66, 112
    s_cbranch_scc1 P_nf
    s_and_b32 s66, s2, 7
    s_lshl_b32 s70, s66, 9
    s_add_u32 s71, s70, 0x1174000
    s_add_u32 s70, s70, 0x1172000
    v_lshlrev_b32 v16, 3, v0
    v_min_u32 v17, 440, v16
F_t:
    s_sub_u32 s41, s41, 1
    s_cbranch_scc1 P_nf
    buffer_load_dwordx2 v[20:21], v16, s[8:11], s70 offen sc1
    s_waitcnt vmcnt(0)
    v_subrev_u32 v22, s40, v20
    v_subrev_u32 v23, s40, v21
    v_max_u32 v22, v22, v23
    v_cmp_lt_u32 vcc, 7, v22
    s_cbranch_vccnz F_t
    v_xor_b32 v20, s74, v20
    v_xor_b32 v21, s74, v21
    v_or_b32 v20, v20, v21
    v_cmp_ne_u32 vcc, 0, v20
    s_cbranch_vccnz P_nf
    s_add_u32 s72, s71, 0
F_WB_E:
    s_sub_u32 s41, s41, 1
    s_cbranch_scc1 P_nf
    buffer_load_dwordx2 v[20:21], v17, s[8:11], s72 offen sc1
    s_waitcnt vmcnt(0)
    v_xor_b32 v20, s40, v20
    v_xor_b32 v21, s40, v21
    v_or_b32 v20, v20, v21
    v_cmp_ne_u32 vcc, 0, v20
    s_cbranch_vccnz F_WB_E
    buffer_wbl2 sc1
    s_waitcnt vmcnt(0)
P_nf:
    s_lshl_b32 s66, s2, 2
    s_add_u32 s66, s66, s3
    s_cmp_lg_u32 s66, 1020
    s_cbranch_scc1 P_fin
    s_mov_b32 s66, 0x1170000
    buffer_load_dwordx4 v[16:19], v1, s[8:11], s66 offen offset:0 sc1
    buffer_load_dwordx4 v[20:23], v1, s[8:11], s66 offen offset:1024 sc1
    buffer_load_dwordx4 v[24:27], v1, s[8:11], s66 offen offset:2048 sc1
    buffer_load_dwordx4 v[28:31], v1, s[8:11], s66 offen offset:3072 sc1
    s_waitcnt vmcnt(3)
    v_subrev_u32 v16, s40, v16
    v_subrev_u32 v17, s40, v17
    v_subrev_u32 v18, s40, v18
    v_subrev_u32 v19, s40, v19
    s_waitcnt vmcnt(2)
    v_subrev_u32 v20, s40, v20
    v_subrev_u32 v21, s40, v21
    v_subrev_u32 v22, s40, v22
    v_subrev_u32 v23, s40, v23
    s_waitcnt vmcnt(1)
    v_subrev_u32 v24, s40, v24
    v_subrev_u32 v25, s40, v25
    v_subrev_u32 v26, s40, v26
    v_subrev_u32 v27, s40, v27
    s_waitcnt vmcnt(0)
    v_subrev_u32 v28, s40, v28
    v_subrev_u32 v29, s40, v29
    v_subrev_u32 v30, s40, v30
    v_subrev_u32 v31, s40, v31
    v_max3_u32 v16, v16, v17, v18
    v_max3_u32 v16, v16, v19, v20
    v_max3_u32 v16, v16, v21, v22
    v_max3_u32 v16, v16, v23, v24
    v_max3_u32 v16, v16, v25, v26
    v_max3_u32 v16, v16, v27, v28
    v_max3_u32 v16, v16, v29, v30
    v_max_u32 v16, v16, v31
    v_cmp_lt_u32 vcc, 7, v16
    s_cbranch_vccnz B_ep
B_ep_ok:
    s_mov_b32 s66, 0x1173000
    buffer_store_dword v255, off, s[8:11], s66 sc1
    s_branch P_fin
P_fin:
P_end:
    s_endpgm
A_w2:
    s_sub_u32 s69, s69, 1
    s_cbranch_scc1 A_w2_x
    v_cmp_ne_u32 s[66:67], v193, v188
    s_nop 4
    s_and_b64 s[66:67], s[66:67], vcc
    s_cbranch_scc0 A_w2_p
    s_sub_u32 s41, s41, 1
    s_cbranch_scc1 A_w2_x
    s_mov_b32 s68, m0
    ds_read_b32 v210, v189 offset:24576
    ds_read_b32 v211, v189 offset:36864
    s_sub_u32 s70, s70, 1
    s_cbranch_scc0 A_w2_l
    s_mov_b32 s70, 0
    s_waitcnt vmcnt(0)
    buffer_wbl2 sc1
    s_waitcnt vmcnt(0)
A_w2_l:
    s_waitcnt lgkmcnt(0)
    v_cmp_ne_u32 vcc, s31, v210
    v_cmp_ne_u32 s[66:67], v193, v210
    s_nop 4
    s_and_b64 s[66:67], s[66:67], vcc
    s_cbranch_scc0 A_w2_2
    ds_write_b32 v189, v193 offset:24576
    s_add_u32 m0, s72, 24576
    s_add_u32 s67, s29, 24576
    s_waitcnt vmcnt(40) lgkmcnt(0)
    buffer_load_dwordx4 v1, s[8:11], s67 offen offset:0 sc1 lds
    buffer_load_dwordx4 v1, s[8:11], s67 offen offset:1024 sc1 lds
    buffer_load_dwordx4 v1, s[8:11], s67 offen offset:2048 sc1 lds
A_w2_2:
    v_cmp_ne_u32 vcc, s31, v211
    v_cmp_ne_u32 s[66:67], v193, v211
    s_nop 4
    s_and_b64 s[66:67], s[66:67], vcc
    s_cbranch_scc0 A_w2_3
    ds_write_b32 v189, v193 offset:36864
    s_add_u32 m0, s72, 36864
    s_add_u32 s67, s29, 36864
    s_waitcnt vmcnt(40) lgkmcnt(0)
    buffer_load_dwordx4 v1, s[8:11], s67 offen offset:0 sc1 lds
    buffer_load_dwordx4 v1, s[8:11], s67 offen offset:1024 sc1 lds
    buffer_load_dwordx4 v1, s[8:11], s67 offen offset:2048 sc1 lds
A_w2_3:
    s_mov_b32 m0, s68
    s_waitcnt vmcnt(0)
A_w2_p:
    ds_read_b32 v188, v189 offset:24576
    s_waitcnt lgkmcnt(0)
    v_cmp_ne_u32 vcc, s31, v188
    s_cbranch_vccnz A_w2
    s_branch A_w2_ok
A_w2_x:
    s_mov_b32 s41, 0
    s_mov_b32 s69, 0
    s_branch A_w2_ok
A_w3:
    s_sub_u32 s69, s69, 1
    s_cbranch_scc1 A_w3_x
    v_cmp_ne_u32 s[66:67], v193, v188
    s_nop 4
    s_and_b64 s[66:67], s[66:67], vcc
    s_cbranch_scc0 A_w3_p
    s_sub_u32 s41, s41, 1
    s_cbranch_scc1 A_w3_x
    s_mov_b32 s68, m0
    ds_read_b32 v211, v189 offset:36864
    s_sub_u32 s70, s70, 1
    s_cbranch_scc0 A_w3_l
    s_mov_b32 s70, 0
    s_waitcnt vmcnt(0)
    buffer_wbl2 sc1
    s_waitcnt vmcnt(0)
A_w3_l:
    s_waitcnt lgkmcnt(0)
    v_cmp_ne_u32 vcc, s31, v211
    v_cmp_ne_u32 s[66:67], v193, v211
    s_nop 4
    s_and_b64 s[66:67], s[66:67], vcc
    s_cbranch_scc0 A_w3_3
    ds_write_b32 v189, v193 offset:36864
    s_add_u32 m0, s72, 36864
    s_add_u32 s67, s29, 36864
    s_waitcnt vmcnt(40) lgkmcnt(0)
    buffer_load_dwordx4 v1, s[8:11], s67 offen offset:0 sc1 lds
    buffer_load_dwordx4 v1, s[8:11], s67 offen offset:1024 sc1 lds
    buffer_load_dwordx4 v1, s[8:11], s67 offen offset:2048 sc1 lds
A_w3_3:
    s_mov_b32 m0, s68
    s_waitcnt vmcnt(0)
A_w3_p:
    ds_read_b32 v188, v189 offset:36864
    s_waitcnt lgkmcnt(0)
    v_cmp_ne_u32 vcc, s31, v188
    s_cbranch_vccnz A_w3
    s_branch A_w3_ok
A_w3_x:
    s_mov_b32 s41, 0
    s_mov_b32 s69, 0
    s_branch A_w3_ok
A_w4:
    s_sub_u32 s69, s69, 1
    s_cbranch_scc1 A_w4_x
    v_cmp_ne_u32 s[66:67], v193, v188
    s_nop 4
    s_and_b64 s[66:67], s[66:67], vcc
    s_cbranch_scc0 A_w4_p
    s_sub_u32 s41, s41, 1
    s_cbranch_scc1 A_w4_x
    s_mov_b32 s68, m0
    ds_read_b32 v212, v189 offset:0
    s_sub_u32 s70, s70, 1
    s_cbranch_scc0 A_w4_l
    s_mov_b32 s70, 0
    s_waitcnt vmcnt(0)
    buffer_wbl2 sc1
    s_waitcnt vmcnt(0)
A_w4_l:
    s_waitcnt lgkmcnt(0)
    v_cmp_ne_u32 vcc, s31, v212
    v_cmp_ne_u32 s[66:67], v193, v212
    s_nop 4
    s_and_b64 s[66:67], s[66:67], vcc
    s_cbranch_scc0 A_w4_4
    ds_write_b32 v189, v193 offset:0
    s_add_u32 m0, s72, 0
    s_add_u32 s67, s29, 49152
    s_waitcnt vmcnt(40) lgkmcnt(0)
    buffer_load_dwordx4 v1, s[8:11], s67 offen offset:0 sc1 lds
    buffer_load_dwordx4 v1, s[8:11], s67 offen offset:1024 sc1 lds
    buffer_load_dwordx4 v1, s[8:11], s67 offen offset:2048 sc1 lds
A_w4_4:
    s_mov_b32 m0, s68
    s_waitcnt vmcnt(0)
A_w4_p:
    ds_read_b32 v188, v189 offset:0
    s_waitcnt lgkmcnt(0)
    v_cmp_ne_u32 vcc, s31, v188
    s_cbranch_vccnz A_w4
    s_branch A_w4_ok
A_w4_x:
    s_mov_b32 s41, 0
    s_mov_b32 s69, 0
    s_branch A_w4_ok
A_w5:
    s_sub_u32 s69, s69, 1
    s_cbranch_scc1 A_w5_x
    v_cmp_ne_u32 s[66:67], v193, v188
    s_nop 4
    s_and_b64 s[66:67], s[66:67], vcc
    s_cbranch_scc0 A_w5_p
    s_sub_u32 s41, s41, 1
    s_cbranch_scc1 A_w5_x
    s_mov_b32 s68, m0
    ds_read_b32 v213, v189 offset:12288
    s_sub_u32 s70, s70, 1
    s_cbranch_scc0 A_w5_l
    s_mov_b32 s70, 0
    s_waitcnt vmcnt(0)
    buffer_wbl2 sc1
    s_waitcnt vmcnt(0)
A_w5_l:
    s_waitcnt lgkmcnt(0)
    v_cmp_ne_u32 vcc, s31, v213
    v_cmp_ne_u32 s[66:67], v193, v213
    s_nop 4
    s_and_b64 s[66:67], s[66:67], vcc
    s_cbranch_scc0 A_w5_5
    ds_write_b32 v189, v193 offset:12288
    s_add_u32 m0, s72, 12288
    s_add_u32 s67, s29, 61440
    s_waitcnt vmcnt(40) lgkmcnt(0)
    buffer_load_dwordx4 v1, s[8:11], s67 offen offset:0 sc1 lds
    buffer_load_dwordx4 v1, s[8:11], s67 offen offset:1024 sc1 lds
    buffer_load_dwordx4 v1, s[8:11], s67 offen offset:2048 sc1 lds
A_w5_5:
    s_mov_b32 m0, s68
    s_waitcnt vmcnt(0)
A_w5_p:
    ds_read_b32 v188, v189 offset:12288
    s_waitcnt lgkmcnt(0)
    v_cmp_ne_u32 vcc, s31, v188
    s_cbranch_vccnz A_w5
    s_branch A_w5_ok
A_w5_x:
    s_mov_b32 s41, 0
    s_mov_b32 s69, 0
    s_branch A_w5_ok
A_w6:
    s_sub_u32 s69, s69, 1
    s_cbranch_scc1 A_w6_x
    v_cmp_ne_u32 s[66:67], v193, v188
    s_nop 4
    s_and_b64 s[66:67], s[66:67], vcc
    s_cbranch_scc0 A_w6_p
    s_sub_u32 s41, s41, 1
    s_cbranch_scc1 A_w6_x
    s_mov_b32 s68, m0
    ds_read_b32 v214, v189 offset:24576
    s_sub_u32 s70, s70, 1
    s_cbranch_scc0 A_w6_l
    s_mov_b32 s70, 0
    s_waitcnt vmcnt(0)
    buffer_wbl2 sc1
    s_waitcnt vmcnt(0)
A_w6_l:
    s_waitcnt lgkmcnt(0)
    v_cmp_ne_u32 vcc, s31, v214
    v_cmp_ne_u32 s[66:67], v193, v214
    s_nop 4
    s_and_b64 s[66:67], s[66:67], vcc
    s_cbranch_scc0 A_w6_6
    ds_write_b32 v189, v193 offset:24576
    s_add_u32 m0, s72, 24576
    s_add_u32 s67, s29, 73728
    s_waitcnt vmcnt(40) lgkmcnt(0)
    buffer_load_dwordx4 v1, s[8:11], s67 offen offset:0 sc1 lds
    buffer_load_dwordx4 v1, s[8:11], s67 offen offset:1024 sc1 lds
    buffer_load_dwordx4 v1, s[8:11], s67 offen offset:2048 sc1 lds
A_w6_6:
    s_mov_b32 m0, s68
    s_waitcnt vmcnt(0)
A_w6_p:
    ds_read_b32 v188, v189 offset:24576
    s_waitcnt lgkmcnt(0)
    v_cmp_ne_u32 vcc, s31, v188
    s_cbranch_vccnz A_w6
    s_branch A_w6_ok
A_w6_x:
    s_mov_b32 s41, 0
    s_mov_b32 s69, 0
    s_branch A_w6_ok
A_sk:
    buffer_store_dwordx4 v[176:179], v1, s[44:47], s48 offen offset:0 sc1
    buffer_store_dwordx4 v[180:183], v1, s[44:47], s48 offen offset:1024 sc1
    buffer_store_dwordx4 v[196:199], v204, s[8:11], s75 offen offset:0 sc1
    buffer_store_dwordx4 v[200:203], v204, s[8:11], s75 offen offset:1344 sc1
    s_branch A_sk_ok
A_sv:
    buffer_store_dwordx4 v[208:211], v1, s[44:47], s48 offen offset:2048 sc1
    buffer_store_dwordx4 v[212:215], v1, s[44:47], s48 offen offset:3072 sc1
    s_lshl_b32 s66, s65, 2
    s_add_u32 s66, s66, s3
    s_lshl_b32 s66, s66, 4
    s_add_u32 s66, s66, s49
    s_lshl_b32 s66, s66, 2
    s_add_u32 s66, s66, 0x1175000
    s_waitcnt vmcnt(0)
    buffer_store_dword v255, off, s[8:11], s66 sc1
    s_branch A_sv_ok
B_t1:
    s_sub_u32 s41, s41, 1
    s_cbranch_scc1 B_t1_x
    buffer_load_dword v232, v17, s[8:11], s30 offen sc1
    s_waitcnt vmcnt(0)
    v_subrev_u32 v233, s40, v232
    v_cmp_lt_u32 vcc, 7, v233
    s_cbranch_vccnz B_t1
    v_cmp_ne_u32 vcc, s73, v232
    s_add_u32 s66, s30, 20480
    s_cbranch_vccz B_t1_ok
B_t0:
    s_sub_u32 s41, s41, 1
    s_cbranch_scc1 B_t1_x
    buffer_load_dword v232, v17, s[8:11], s66 offen sc1
    s_waitcnt vmcnt(0)
    v_cmp_ne_u32 vcc, s40, v232
    s_cbranch_vccnz B_t0
    s_branch B_t1_ok
B_t1_x:
    s_mov_b32 s41, 0
    s_branch B_t1_ok
B_r0:
    s_sub_u32 s41, s41, 1
    s_cbranch_scc1 B_r0_x
    s_add_u32 s67, s49, 1
    s_and_b32 s67, s67, 15
    s_lshl_b32 s67, s67, 14
    buffer_load_dwordx4 v[184:187], v1, s[44:47], s67 offen offset:0 sc1
    buffer_load_dwordx4 v[188:191], v1, s[44:47], s67 offen offset:1024 sc1
    s_add_u32 s67, s49, 1
    s_and_b32 s67, s67, 15
    s_lshl_b32 s67, s67, 14
    buffer_load_dwordx4 v[216:219], v1, s[44:47], s67 offen offset:2048 sc1
    buffer_load_dwordx4 v[220:223], v1, s[44:47], s67 offen offset:3072 sc1
    s_add_u32 s67, s49, 2
    s_and_b32 s67, s67, 15
    s_lshl_b32 s67, s67, 14
    buffer_load_dwordx4 v[192:195], v1, s[44:47], s67 offen offset:0 sc1
    s_waitcnt vmcnt(0)
    v_max_u32 v7, v184, v188
    v_cmp_eq_u32 vcc, -1, v7
    s_cbranch_vccnz B_r0
    s_branch B_r0_ok
B_r0_x:
    s_mov_b32 s41, 0
    s_branch B_r0_ok
B_r1:
    s_sub_u32 s41, s41, 1
    s_cbranch_scc1 B_r1_x
    s_add_u32 s67, s49, 1
    s_and_b32 s67, s67, 15
    s_lshl_b32 s67, s67, 14
    buffer_load_dwordx4 v[216:219], v1, s[44:47], s67 offen offset:2048 sc1
    buffer_load_dwordx4 v[220:223], v1, s[44:47], s67 offen offset:3072 sc1
    s_add_u32 s67, s49, 2
    s_and_b32 s67, s67, 15
    s_lshl_b32 s67, s67, 14
    buffer_load_dwordx4 v[192:195], v1, s[44:47], s67 offen offset:0 sc1
    buffer_load_dwordx4 v[196:199], v1, s[44:47], s67 offen offset:1024 sc1
    s_add_u32 s67, s49, 2
    s_and_b32 s67, s67, 15
    s_lshl_b32 s67, s67, 14
    buffer_load_dwordx4 v[224:227], v1, s[44:47], s67 offen offset:2048 sc1
    buffer_load_dwordx4 v[228:231], v1, s[44:47], s67 offen offset:3072 sc1
    s_waitcnt vmcnt(0)
    v_max3_u32 v7, v216, v220, v192
    v_max_u32 v7, v196, v7
    v_cmp_eq_u32 vcc, -1, v7
    s_cbranch_vccnz B_r1
    s_branch B_r1_ok
B_r1_x:
    s_mov_b32 s41, 0
    s_branch B_r1_ok
B_r2:
    s_sub_u32 s41, s41, 1
    s_cbranch_scc1 B_r2_x
    s_add_u32 s67, s49, 2
    s_and_b32 s67, s67, 15
    s_lshl_b32 s67, s67, 14
    buffer_load_dwordx4 v[224:227], v1, s[44:47], s67 offen offset:2048 sc1
    buffer_load_dwordx4 v[228:231], v1, s[44:47], s67 offen offset:3072 sc1
    s_add_u32 s67, s49, 3
    s_and_b32 s67, s67, 15
    s_lshl_b32 s67, s67, 14
    buffer_load_dwordx4 v[200:203], v1, s[44:47], s67 offen offset:0 sc1
    buffer_load_dwordx4 v[204:207], v1, s[44:47], s67 offen offset:1024 sc1
    s_add_u32 s67, s49, 3
    s_and_b32 s67, s67, 15
    s_lshl_b32 s67, s67, 14
    buffer_load_dwordx4 v[32:35], v1, s[44:47], s67 offen offset:2048 sc1
    buffer_load_dwordx4 v[36:39], v1, s[44:47], s67 offen offset:3072 sc1
    s_add_u32 s67, s49, 4
    s_and_b32 s67, s67, 15
    s_lshl_b32 s67, s67, 14
    buffer_load_dwordx4 v[16:19], v1, s[44:47], s67 offen offset:0 sc1
    buffer_load_dwordx4 v[20:23], v1, s[44:47], s67 offen offset:1024 sc1
    s_add_u32 s67, s49, 4
    s_and_b32 s67, s67, 15
    s_lshl_b32 s67, s67, 14
    buffer_load_dwordx4 v[40:43], v1, s[44:47], s67 offen offset:2048 sc1
    buffer_load_dwordx4 v[44:47], v1, s[44:47], s67 offen offset:3072 sc1
    s_waitcnt vmcnt(0)
    v_max3_u32 v7, v224, v228, v200
    v_max_u32 v7, v204, v7
    v_cmp_eq_u32 vcc, -1, v7
    s_cbranch_vccnz B_r2
    s_branch B_r2_ok
B_r2_x:
    s_mov_b32 s41, 0
    s_branch B_r2_ok
B_r3:
    s_sub_u32 s41, s41, 1
    s_cbranch_scc1 B_r3_x
    s_add_u32 s67, s49, 3
    s_and_b32 s67, s67, 15
    s_lshl_b32 s67, s67, 14
    buffer_load_dwordx4 v[32:35], v1, s[44:47], s67 offen offset:2048 sc1
    buffer_load_dwordx4 v[36:39], v1, s[44:47], s67 offen offset:3072 sc1
    s_add_u32 s67, s49, 4
    s_and_b32 s67, s67, 15
    s_lshl_b32 s67, s67, 14
    buffer_load_dwordx4 v[16:19], v1, s[44:47], s67 offen offset:0 sc1
    buffer_load_dwordx4 v[20:23], v1, s[44:47], s67 offen offset:1024 sc1
    s_add_u32 s67, s49, 4
    s_and_b32 s67, s67, 15
    s_lshl_b32 s67, s67, 14
    buffer_load_dwordx4 v[40:43], v1, s[44:47], s67 offen offset:2048 sc1
    buffer_load_dwordx4 v[44:47], v1, s[44:47], s67 offen offset:3072 sc1
    s_add_u32 s67, s49, 5
    s_and_b32 s67, s67, 15
    s_lshl_b32 s67, s67, 14
    buffer_load_dwordx4 v[24:27], v1, s[44:47], s67 offen offset:0 sc1
    buffer_load_dwordx4 v[28:31], v1, s[44:47], s67 offen offset:1024 sc1
    s_add_u32 s67, s49, 5
    s_and_b32 s67, s67, 15
    s_lshl_b32 s67, s67, 14
    buffer_load_dwordx4 v[244:247], v1, s[44:47], s67 offen offset:2048 sc1
    buffer_load_dwordx4 v[248:251], v1, s[44:47], s67 offen offset:3072 sc1
    s_waitcnt vmcnt(0)
    v_max3_u32 v7, v32, v36, v16
    v_max_u32 v7, v20, v7
    v_cmp_eq_u32 vcc, -1, v7
    s_cbranch_vccnz B_r3
    s_branch B_r3_ok
B_r3_x:
    s_mov_b32 s41, 0
    s_branch B_r3_ok
B_r4:
    s_sub_u32 s41, s41, 1
    s_cbranch_scc1 B_r4_x
    s_add_u32 s67, s49, 4
    s_and_b32 s67, s67, 15
    s_lshl_b32 s67, s67, 14
    buffer_load_dwordx4 v[40:43], v1, s[44:47], s67 offen offset:2048 sc1
    buffer_load_dwordx4 v[44:47], v1, s[44:47], s67 offen offset:3072 sc1
    s_add_u32 s67, s49, 5
    s_and_b32 s67, s67, 15
    s_lshl_b32 s67, s67, 14
    buffer_load_dwordx4 v[24:27], v1, s[44:47], s67 offen offset:0 sc1
    buffer_load_dwordx4 v[28:31], v1, s[44:47], s67 offen offset:1024 sc1
    s_add_u32 s67, s49, 5
    s_and_b32 s67, s67, 15
    s_lshl_b32 s67, s67, 14
    buffer_load_dwordx4 v[244:247], v1, s[44:47], s67 offen offset:2048 sc1
    buffer_load_dwordx4 v[248:251], v1, s[44:47], s67 offen offset:3072 sc1
    s_add_u32 s67, s49, 6
    s_and_b32 s67, s67, 15
    s_lshl_b32 s67, s67, 14
    buffer_load_dwordx4 v[176:179], v1, s[44:47], s67 offen offset:0 sc1
    buffer_load_dwordx4 v[180:183], v1, s[44:47], s67 offen offset:1024 sc1
    s_add_u32 s67, s49, 6
    s_and_b32 s67, s67, 15
    s_lshl_b32 s67, s67, 14
    buffer_load_dwordx4 v[208:211], v1, s[44:47], s67 offen offset:2048 sc1
    buffer_load_dwordx4 v[212:215], v1, s[44:47], s67 offen offset:3072 sc1
    s_waitcnt vmcnt(0)
    v_max3_u32 v7, v40, v44, v24
    v_max_u32 v7, v28, v7
    v_cmp_eq_u32 vcc, -1, v7
    s_cbranch_vccnz B_r4
    s_branch B_r4_ok
B_r4_x:
    s_mov_b32 s41, 0
    s_branch B_r4_ok
B_r5:
    s_sub_u32 s41, s41, 1
    s_cbranch_scc1 B_r5_x
    s_add_u32 s67, s49, 5
    s_and_b32 s67, s67, 15
    s_lshl_b32 s67, s67, 14
    buffer_load_dwordx4 v[244:247], v1, s[44:47], s67 offen offset:2048 sc1
    buffer_load_dwordx4 v[248:251], v1, s[44:47], s67 offen offset:3072 sc1
    s_add_u32 s67, s49, 6
    s_and_b32 s67, s67, 15
    s_lshl_b32 s67, s67, 14
    buffer_load_dwordx4 v[176:179], v1, s[44:47], s67 offen offset:0 sc1
    buffer_load_dwordx4 v[180:183], v1, s[44:47], s67 offen offset:1024 sc1
    s_add_u32 s67, s49, 6
    s_and_b32 s67, s67, 15
    s_lshl_b32 s67, s67, 14
    buffer_load_dwordx4 v[208:211], v1, s[44:47], s67 offen offset:2048 sc1
    buffer_load_dwordx4 v[212:215], v1, s[44:47], s67 offen offset:3072 sc1
    s_add_u32 s67, s49, 7
    s_and_b32 s67, s67, 15
    s_lshl_b32 s67, s67, 14
    buffer_load_dwordx4 v[184:187], v1, s[44:47], s67 offen offset:0 sc1
    buffer_load_dwordx4 v[188:191], v1, s[44:47], s67 offen offset:1024 sc1
    s_add_u32 s67, s49, 7
    s_and_b32 s67, s67, 15
    s_lshl_b32 s67, s67, 14
    buffer_load_dwordx4 v[216:219], v1, s[44:47], s67 offen offset:2048 sc1
    buffer_load_dwordx4 v[220:223], v1, s[44:47], s67 offen offset:3072 sc1
    s_waitcnt vmcnt(0)
    v_max3_u32 v7, v244, v248, v176
    v_max_u32 v7, v180, v7
    v_cmp_eq_u32 vcc, -1, v7
    s_cbranch_vccnz B_r5
    s_branch B_r5_ok
B_r5_x:
    s_mov_b32 s41, 0
    s_branch B_r5_ok
B_r6:
    s_sub_u32 s41, s41, 1
    s_cbranch_scc1 B_r6_x
    s_add_u32 s67, s49, 6
    s_and_b32 s67, s67, 15
    s_lshl_b32 s67, s67, 14
    buffer_load_dwordx4 v[208:211], v1, s[44:47], s67 offen offset:2048 sc1
    buffer_load_dwordx4 v[212:215], v1, s[44:47], s67 offen offset:3072 sc1
    s_add_u32 s67, s49, 7
    s_and_b32 s67, s67, 15
    s_lshl_b32 s67, s67, 14
    buffer_load_dwordx4 v[184:187], v1, s[44:47], s67 offen offset:0 sc1
    buffer_load_dwordx4 v[188:191], v1, s[44:47], s67 offen offset:1024 sc1
    s_add_u32 s67, s49, 7
    s_and_b32 s67, s67, 15
    s_lshl_b32 s67, s67, 14
    buffer_load_dwordx4 v[216:219], v1, s[44:47], s67 offen offset:2048 sc1
    buffer_load_dwordx4 v[220:223], v1, s[44:47], s67 offen offset:3072 sc1
    s_add_u32 s67, s49, 8
    s_and_b32 s67, s67, 15
    s_lshl_b32 s67, s67, 14
    buffer_load_dwordx4 v[192:195], v1, s[44:47], s67 offen offset:0 sc1
    buffer_load_dwordx4 v[196:199], v1, s[44:47], s67 offen offset:1024 sc1
    s_add_u32 s67, s49, 8
    s_and_b32 s67, s67, 15
    s_lshl_b32 s67, s67, 14
    buffer_load_dwordx4 v[224:227], v1, s[44:47], s67 offen offset:2048 sc1
    buffer_load_dwordx4 v[228:231], v1, s[44:47], s67 offen offset:3072 sc1
    s_waitcnt vmcnt(0)
    v_max3_u32 v7, v208, v212, v184
    v_max_u32 v7, v188, v7
    v_cmp_eq_u32 vcc, -1, v7
    s_cbranch_vccnz B_r6
    s_branch B_r6_ok
B_r6_x:
    s_mov_b32 s41, 0
    s_branch B_r6_ok
B_r7:
    s_sub_u32 s41, s41, 1
    s_cbranch_scc1 B_r7_x
    s_add_u32 s67, s49, 7
    s_and_b32 s67, s67, 15
    s_lshl_b32 s67, s67, 14
    buffer_load_dwordx4 v[216:219], v1, s[44:47], s67 offen offset:2048 sc1
    buffer_load_dwordx4 v[220:223], v1, s[44:47], s67 offen offset:3072 sc1
    s_add_u32 s67, s49, 8
    s_and_b32 s67, s67, 15
    s_lshl_b32 s67, s67, 14
    buffer_load_dwordx4 v[192:195], v1, s[44:47], s67 offen offset:0 sc1
    buffer_load_dwordx4 v[196:199], v1, s[44:47], s67 offen offset:1024 sc1
    s_add_u32 s67, s49, 8
    s_and_b32 s67, s67, 15
    s_lshl_b32 s67, s67, 14
    buffer_load_dwordx4 v[224:227], v1, s[44:47], s67 offen offset:2048 sc1
    buffer_load_dwordx4 v[228:231], v1, s[44:47], s67 offen offset:3072 sc1
    s_add_u32 s67, s49, 9
    s_and_b32 s67, s67, 15
    s_lshl_b32 s67, s67, 14
    buffer_load_dwordx4 v[200:203], v1, s[44:47], s67 offen offset:0 sc1
    buffer_load_dwordx4 v[204:207], v1, s[44:47], s67 offen offset:1024 sc1
    s_add_u32 s67, s49, 9
    s_and_b32 s67, s67, 15
    s_lshl_b32 s67, s67, 14
    buffer_load_dwordx4 v[32:35], v1, s[44:47], s67 offen offset:2048 sc1
    buffer_load_dwordx4 v[36:39], v1, s[44:47], s67 offen offset:3072 sc1
    s_waitcnt vmcnt(0)
    v_max3_u32 v7, v216, v220, v192
    v_max_u32 v7, v196, v7
    v_cmp_eq_u32 vcc, -1, v7
    s_cbranch_vccnz B_r7
    s_branch B_r7_ok
B_r7_x:
    s_mov_b32 s41, 0
    s_branch B_r7_ok
B_r8:
    s_sub_u32 s41, s41, 1
    s_cbranch_scc1 B_r8_x
    s_add_u32 s67, s49, 8
    s_and_b32 s67, s67, 15
    s_lshl_b32 s67, s67, 14
    buffer_load_dwordx4 v[224:227], v1, s[44:47], s67 offen offset:2048 sc1
    buffer_load_dwordx4 v[228:231], v1, s[44:47], s67 offen offset:3072 sc1
    s_add_u32 s67, s49, 9
    s_and_b32 s67, s67, 15
    s_lshl_b32 s67, s67, 14
    buffer_load_dwordx4 v[200:203], v1, s[44:47], s67 offen offset:0 sc1
    buffer_load_dwordx4 v[204:207], v1, s[44:47], s67 offen offset:1024 sc1
    s_add_u32 s67, s49, 9
    s_and_b32 s67, s67, 15
    s_lshl_b32 s67, s67, 14
    buffer_load_dwordx4 v[32:35], v1, s[44:47], s67 offen offset:2048 sc1
    buffer_load_dwordx4 v[36:39], v1, s[44:47], s67 offen offset:3072 sc1
    s_add_u32 s67, s49, 10
    s_and_b32 s67, s67, 15
    s_lshl_b32 s67, s67, 14
    buffer_load_dwordx4 v[16:19], v1, s[44:47], s67 offen offset:0 sc1
    buffer_load_dwordx4 v[20:23], v1, s[44:47], s67 offen offset:1024 sc1
    s_add_u32 s67, s49, 10
    s_and_b32 s67, s67, 15
    s_lshl_b32 s67, s67, 14
    buffer_load_dwordx4 v[40:43], v1, s[44:47], s67 offen offset:2048 sc1
    buffer_load_dwordx4 v[44:47], v1, s[44:47], s67 offen offset:3072 sc1
    s_waitcnt vmcnt(0)
    v_max3_u32 v7, v224, v228, v200
    v_max_u32 v7, v204, v7
    v_cmp_eq_u32 vcc, -1, v7
    s_cbranch_vccnz B_r8
    s_branch B_r8_ok
B_r8_x:
    s_mov_b32 s41, 0
    s_branch B_r8_ok
B_r9:
    s_sub_u32 s41, s41, 1
    s_cbranch_scc1 B_r9_x
    s_add_u32 s67, s49, 9
    s_and_b32 s67, s67, 15
    s_lshl_b32 s67, s67, 14
    buffer_load_dwordx4 v[32:35], v1, s[44:47], s67 offen offset:2048 sc1
    buffer_load_dwordx4 v[36:39], v1, s[44:47], s67 offen offset:3072 sc1
    s_add_u32 s67, s49, 10
    s_and_b32 s67, s67, 15
    s_lshl_b32 s67, s67, 14
    buffer_load_dwordx4 v[16:19], v1, s[44:47], s67 offen offset:0 sc1
    buffer_load_dwordx4 v[20:23], v1, s[44:47], s67 offen offset:1024 sc1
    s_add_u32 s67, s49, 10
    s_and_b32 s67, s67, 15
    s_lshl_b32 s67, s67, 14
    buffer_load_dwordx4 v[40:43], v1, s[44:47], s67 offen offset:2048 sc1
    buffer_load_dwordx4 v[44:47], v1, s[44:47], s67 offen offset:3072 sc1
    s_add_u32 s67, s49, 11
    s_and_b32 s67, s67, 15
    s_lshl_b32 s67, s67, 14
    buffer_load_dwordx4 v[24:27], v1, s[44:47], s67 offen offset:0 sc1
    buffer_load_dwordx4 v[28:31], v1, s[44:47], s67 offen offset:1024 sc1
    s_add_u32 s67, s49, 11
    s_and_b32 s67, s67, 15
    s_lshl_b32 s67, s67, 14
    buffer_load_dwordx4 v[244:247], v1, s[44:47], s67 offen offset:2048 sc1
    buffer_load_dwordx4 v[248:251], v1, s[44:47], s67 offen offset:3072 sc1
    s_waitcnt vmcnt(0)
    v_max3_u32 v7, v32, v36, v16
    v_max_u32 v7, v20, v7
    v_cmp_eq_u32 vcc, -1, v7
    s_cbranch_vccnz B_r9
    s_branch B_r9_ok
B_r9_x:
    s_mov_b32 s41, 0
    s_branch B_r9_ok
B_r10:
    s_sub_u32 s41, s41, 1
    s_cbranch_scc1 B_r10_x
    s_add_u32 s67, s49, 10
    s_and_b32 s67, s67, 15
    s_lshl_b32 s67, s67, 14
    buffer_load_dwordx4 v[40:43], v1, s[44:47], s67 offen offset:2048 sc1
    buffer_load_dwordx4 v[44:47], v1, s[44:47], s67 offen offset:3072 sc1
    s_add_u32 s67, s49, 11
    s_and_b32 s67, s67, 15
    s_lshl_b32 s67, s67, 14
    buffer_load_dwordx4 v[24:27], v1, s[44:47], s67 offen offset:0 sc1
    buffer_load_dwordx4 v[28:31], v1, s[44:47], s67 offen offset:1024 sc1
    s_add_u32 s67, s49, 11
    s_and_b32 s67, s67, 15
    s_lshl_b32 s67, s67, 14
    buffer_load_dwordx4 v[244:247], v1, s[44:47], s67 offen offset:2048 sc1
    buffer_load_dwordx4 v[248:251], v1, s[44:47], s67 offen offset:3072 sc1
    s_add_u32 s67, s49, 12
    s_and_b32 s67, s67, 15
    s_lshl_b32 s67, s67, 14
    buffer_load_dwordx4 v[176:179], v1, s[44:47], s67 offen offset:0 sc1
    buffer_load_dwordx4 v[180:183], v1, s[44:47], s67 offen offset:1024 sc1
    s_add_u32 s67, s49, 12
    s_and_b32 s67, s67, 15
    s_lshl_b32 s67, s67, 14
    buffer_load_dwordx4 v[208:211], v1, s[44:47], s67 offen offset:2048 sc1
    buffer_load_dwordx4 v[212:215], v1, s[44:47], s67 offen offset:3072 sc1
    s_waitcnt vmcnt(0)
    v_max3_u32 v7, v40, v44, v24
    v_max_u32 v7, v28, v7
    v_cmp_eq_u32 vcc, -1, v7
    s_cbranch_vccnz B_r10
    s_branch B_r10_ok
B_r10_x:
    s_mov_b32 s41, 0
    s_branch B_r10_ok
B_r11:
    s_sub_u32 s41, s41, 1
    s_cbranch_scc1 B_r11_x
    s_add_u32 s67, s49, 11
    s_and_b32 s67, s67, 15
    s_lshl_b32 s67, s67, 14
    buffer_load_dwordx4 v[244:247], v1, s[44:47], s67 offen offset:2048 sc1
    buffer_load_dwordx4 v[248:251], v1, s[44:47], s67 offen offset:3072 sc1
    s_add_u32 s67, s49, 12
    s_and_b32 s67, s67, 15
    s_lshl_b32 s67, s67, 14
    buffer_load_dwordx4 v[176:179], v1, s[44:47], s67 offen offset:0 sc1
    buffer_load_dwordx4 v[180:183], v1, s[44:47], s67 offen offset:1024 sc1
    s_add_u32 s67, s49, 12
    s_and_b32 s67, s67, 15
    s_lshl_b32 s67, s67, 14
    buffer_load_dwordx4 v[208:211], v1, s[44:47], s67 offen offset:2048 sc1
    buffer_load_dwordx4 v[212:215], v1, s[44:47], s67 offen offset:3072 sc1
    s_add_u32 s67, s49, 13
    s_and_b32 s67, s67, 15
    s_lshl_b32 s67, s67, 14
    buffer_load_dwordx4 v[184:187], v1, s[44:47], s67 offen offset:0 sc1
    buffer_load_dwordx4 v[188:191], v1, s[44:47], s67 offen offset:1024 sc1
    s_add_u32 s67, s49, 13
    s_and_b32 s67, s67, 15
    s_lshl_b32 s67, s67, 14
    buffer_load_dwordx4 v[216:219], v1, s[44:47], s67 offen offset:2048 sc1
    buffer_load_dwordx4 v[220:223], v1, s[44:47], s67 offen offset:3072 sc1
    s_add_u32 s67, s49, 14
    s_and_b32 s67, s67, 15
    s_lshl_b32 s67, s67, 14
    buffer_load_dwordx4 v[192:195], v1, s[44:47], s67 offen offset:0 sc1
    buffer_load_dwordx4 v[196:199], v1, s[44:47], s67 offen offset:1024 sc1
    s_waitcnt vmcnt(0)
    v_max3_u32 v7, v244, v248, v176
    v_max_u32 v7, v180, v7
    v_cmp_eq_u32 vcc, -1, v7
    s_cbranch_vccnz B_r11
    s_branch B_r11_ok
B_r11_x:
    s_mov_b32 s41, 0
    s_branch B_r11_ok
B_r12:
    s_sub_u32 s41, s41, 1
    s_cbranch_scc1 B_r12_x
    s_add_u32 s67, s49, 12
    s_and_b32 s67, s67, 15
    s_lshl_b32 s67, s67, 14
    buffer_load_dwordx4 v[208:211], v1, s[44:47], s67 offen offset:2048 sc1
    buffer_load_dwordx4 v[212:215], v1, s[44:47], s67 offen offset:3072 sc1
    s_add_u32 s67, s49, 13
    s_and_b32 s67, s67, 15
    s_lshl_b32 s67, s67, 14
    buffer_load_dwordx4 v[184:187], v1, s[44:47], s67 offen offset:0 sc1
    buffer_load_dwordx4 v[188:191], v1, s[44:47], s67 offen offset:1024 sc1
    s_add_u32 s67, s49, 13
    s_and_b32 s67, s67, 15
    s_lshl_b32 s67, s67, 14
    buffer_load_dwordx4 v[216:219], v1, s[44:47], s67 offen offset:2048 sc1
    buffer_load_dwordx4 v[220:223], v1, s[44:47], s67 offen offset:3072 sc1
    s_add_u32 s67, s49, 14
    s_and_b32 s67, s67, 15
    s_lshl_b32 s67, s67, 14
    buffer_load_dwordx4 v[192:195], v1, s[44:47], s67 offen offset:0 sc1
    buffer_load_dwordx4 v[196:199], v1, s[44:47], s67 offen offset:1024 sc1
    s_add_u32 s67, s49, 14
    s_and_b32 s67, s67, 15
    s_lshl_b32 s67, s67, 14
    buffer_load_dwordx4 v[224:227], v1, s[44:47], s67 offen offset:2048 sc1
    buffer_load_dwordx4 v[228:231], v1, s[44:47], s67 offen offset:3072 sc1
    s_add_u32 s67, s49, 15
    s_and_b32 s67, s67, 15
    s_lshl_b32 s67, s67, 14
    buffer_load_dwordx4 v[200:203], v1, s[44:47], s67 offen offset:0 sc1
    buffer_load_dwordx4 v[204:207], v1, s[44:47], s67 offen offset:1024 sc1
    s_add_u32 s67, s49, 15
    s_and_b32 s67, s67, 15
    s_lshl_b32 s67, s67, 14
    buffer_load_dwordx4 v[32:35], v1, s[44:47], s67 offen offset:2048 sc1
    buffer_load_dwordx4 v[36:39], v1, s[44:47], s67 offen offset:3072 sc1
    s_waitcnt vmcnt(0)
    v_max3_u32 v7, v208, v212, v184
    v_max_u32 v7, v188, v7
    v_cmp_eq_u32 vcc, -1, v7
    s_cbranch_vccnz B_r12
    s_branch B_r12_ok
B_r12_x:
    s_mov_b32 s41, 0
    s_branch B_r12_ok
B_r13:
    s_sub_u32 s41, s41, 1
    s_cbranch_scc1 B_r13_x
    s_add_u32 s67, s49, 13
    s_and_b32 s67, s67, 15
    s_lshl_b32 s67, s67, 14
    buffer_load_dwordx4 v[216:219], v1, s[44:47], s67 offen offset:2048 sc1
    buffer_load_dwordx4 v[220:223], v1, s[44:47], s67 offen offset:3072 sc1
    s_add_u32 s67, s49, 14
    s_and_b32 s67, s67, 15
    s_lshl_b32 s67, s67, 14
    buffer_load_dwordx4 v[192:195], v1, s[44:47], s67 offen offset:0 sc1
    buffer_load_dwordx4 v[196:199], v1, s[44:47], s67 offen offset:1024 sc1
    s_add_u32 s67, s49, 14
    s_and_b32 s67, s67, 15
    s_lshl_b32 s67, s67, 14
    buffer_load_dwordx4 v[224:227], v1, s[44:47], s67 offen offset:2048 sc1
    buffer_load_dwordx4 v[228:231], v1, s[44:47], s67 offen offset:3072 sc1
    s_add_u32 s67, s49, 15
    s_and_b32 s67, s67, 15
    s_lshl_b32 s67, s67, 14
    buffer_load_dwordx4 v[200:203], v1, s[44:47], s67 offen offset:0 sc1
    buffer_load_dwordx4 v[204:207], v1, s[44:47], s67 offen offset:1024 sc1
    s_add_u32 s67, s49, 15
    s_and_b32 s67, s67, 15
    s_lshl_b32 s67, s67, 14
    buffer_load_dwordx4 v[32:35], v1, s[44:47], s67 offen offset:2048 sc1
    buffer_load_dwordx4 v[36:39], v1, s[44:47], s67 offen offset:3072 sc1
    s_waitcnt vmcnt(0)
    v_max3_u32 v7, v216, v220, v192
    v_max_u32 v7, v196, v7
    v_cmp_eq_u32 vcc, -1, v7
    s_cbranch_vccnz B_r13
    s_branch B_r13_ok
B_r13_x:
    s_mov_b32 s41, 0
    s_branch B_r13_ok
B_r14:
    s_sub_u32 s41, s41, 1
    s_cbranch_scc1 B_r14_x
    s_add_u32 s67, s49, 14
    s_and_b32 s67, s67, 15
    s_lshl_b32 s67, s67, 14
    buffer_load_dwordx4 v[224:227], v1, s[44:47], s67 offen offset:2048 sc1
    buffer_load_dwordx4 v[228:231], v1, s[44:47], s67 offen offset:3072 sc1
    s_add_u32 s67, s49, 15
    s_and_b32 s67, s67, 15
    s_lshl_b32 s67, s67, 14
    buffer_load_dwordx4 v[200:203], v1, s[44:47], s67 offen offset:0 sc1
    buffer_load_dwordx4 v[204:207], v1, s[44:47], s67 offen offset:1024 sc1
    s_add_u32 s67, s49, 15
    s_and_b32 s67, s67, 15
    s_lshl_b32 s67, s67, 14
    buffer_load_dwordx4 v[32:35], v1, s[44:47], s67 offen offset:2048 sc1
    buffer_load_dwordx4 v[36:39], v1, s[44:47], s67 offen offset:3072 sc1
    s_waitcnt vmcnt(0)
    v_max3_u32 v7, v224, v228, v200
    v_max_u32 v7, v204, v7
    v_cmp_eq_u32 vcc, -1, v7
    s_cbranch_vccnz B_r14
    s_branch B_r14_ok
B_r14_x:
    s_mov_b32 s41, 0
    s_branch B_r14_ok
B_r15:
    s_sub_u32 s41, s41, 1
    s_cbranch_scc1 B_r15_x
    s_add_u32 s67, s49, 15
    s_and_b32 s67, s67, 15
    s_lshl_b32 s67, s67, 14
    buffer_load_dwordx4 v[32:35], v1, s[44:47], s67 offen offset:2048 sc1
    buffer_load_dwordx4 v[36:39], v1, s[44:47], s67 offen offset:3072 sc1
    s_waitcnt vmcnt(0)
    v_max_u32 v7, v32, v36
    v_cmp_eq_u32 vcc, -1, v7
    s_cbranch_vccnz B_r15
    s_branch B_r15_ok
B_r15_x:
    s_mov_b32 s41, 0
    s_branch B_r15_ok
C_t2:
    s_sub_u32 s41, s41, 1
    s_cbranch_scc1 C_t2_x
    v_and_b32 v17, 15, v0
    v_lshlrev_b32 v17, 2, v17
    buffer_load_dword v16, v17, s[8:11], s6 offen sc1
    s_waitcnt vmcnt(0)
    v_cmp_ne_u32 vcc, s40, v16
    s_cbranch_vccnz C_t2
    s_branch C_t2_ok
C_t2_x:
    s_mov_b32 s41, 0
    s_branch C_t2_ok
C_r0:
    s_sub_u32 s41, s41, 1
    s_cbranch_scc1 C_r0_x
    buffer_load_dwordx4 v[16:19], v1, s[8:11], s28 offen offset:0 sc1
    buffer_load_dwordx4 v[20:23], v1, s[8:11], s28 offen offset:1024 sc1
    buffer_load_dwordx4 v[24:27], v1, s[8:11], s30 offen offset:0 sc1
    buffer_load_dwordx4 v[28:31], v1, s[8:11], s30 offen offset:1024 sc1
    buffer_load_dwordx4 v[32:35], v1, s[8:11], s28 offen offset:2048 sc1
    buffer_load_dwordx4 v[36:39], v1, s[8:11], s28 offen offset:3072 sc1
    buffer_load_dwordx4 v[40:43], v1, s[8:11], s30 offen offset:2048 sc1
    buffer_load_dwordx4 v[44:47], v1, s[8:11], s30 offen offset:3072 sc1
    buffer_load_dwordx4 v[48:51], v1, s[8:11], s29 offen offset:0 sc1
    buffer_load_dwordx4 v[52:55], v1, s[8:11], s29 offen offset:1024 sc1
    buffer_load_dwordx4 v[56:59], v1, s[8:11], s31 offen offset:0 sc1
    buffer_load_dwordx4 v[60:63], v1, s[8:11], s31 offen offset:1024 sc1
    s_waitcnt vmcnt(0)
    v_max3_u32 v7, v16, v20, v24
    v_max_u32 v7, v28, v7
    v_cmp_eq_u32 vcc, -1, v7
    s_cbranch_vccnz C_r0
    s_branch C_r0_ok
C_r0_x:
    s_mov_b32 s41, 0
    s_branch C_r0_ok
C_r1:
    s_sub_u32 s41, s41, 1
    s_cbranch_scc1 C_r1_x
    buffer_load_dwordx4 v[32:35], v1, s[8:11], s28 offen offset:2048 sc1
    buffer_load_dwordx4 v[36:39], v1, s[8:11], s28 offen offset:3072 sc1
    buffer_load_dwordx4 v[40:43], v1, s[8:11], s30 offen offset:2048 sc1
    buffer_load_dwordx4 v[44:47], v1, s[8:11], s30 offen offset:3072 sc1
    buffer_load_dwordx4 v[48:51], v1, s[8:11], s29 offen offset:0 sc1
    buffer_load_dwordx4 v[52:55], v1, s[8:11], s29 offen offset:1024 sc1
    buffer_load_dwordx4 v[56:59], v1, s[8:11], s31 offen offset:0 sc1
    buffer_load_dwordx4 v[60:63], v1, s[8:11], s31 offen offset:1024 sc1
    buffer_load_dwordx4 v[64:67], v1, s[8:11], s29 offen offset:2048 sc1
    buffer_load_dwordx4 v[68:71], v1, s[8:11], s29 offen offset:3072 sc1
    buffer_load_dwordx4 v[72:75], v1, s[8:11], s31 offen offset:2048 sc1
    s_waitcnt vmcnt(0)
    v_max3_u32 v7, v32, v36, v40
    v_max_u32 v7, v44, v7
    v_cmp_eq_u32 vcc, -1, v7
    s_cbranch_vccnz C_r1
    s_branch C_r1_ok
C_r1_x:
    s_mov_b32 s41, 0
    s_branch C_r1_ok
C_r2:
    s_sub_u32 s41, s41, 1
    s_cbranch_scc1 C_r2_x
    buffer_load_dwordx4 v[48:51], v1, s[8:11], s29 offen offset:0 sc1
    buffer_load_dwordx4 v[52:55], v1, s[8:11], s29 offen offset:1024 sc1
    buffer_load_dwordx4 v[56:59], v1, s[8:11], s31 offen offset:0 sc1
    buffer_load_dwordx4 v[60:63], v1, s[8:11], s31 offen offset:1024 sc1
    buffer_load_dwordx4 v[64:67], v1, s[8:11], s29 offen offset:2048 sc1
    buffer_load_dwordx4 v[68:71], v1, s[8:11], s29 offen offset:3072 sc1
    buffer_load_dwordx4 v[72:75], v1, s[8:11], s31 offen offset:2048 sc1
    buffer_load_dwordx4 v[76:79], v1, s[8:11], s31 offen offset:3072 sc1
    s_waitcnt vmcnt(0)
    v_max3_u32 v7, v48, v52, v56
    v_max_u32 v7, v60, v7
    v_cmp_eq_u32 vcc, -1, v7
    s_cbranch_vccnz C_r2
    s_branch C_r2_ok
C_r2_x:
    s_mov_b32 s41, 0
    s_branch C_r2_ok
C_r3:
    s_sub_u32 s41, s41, 1
    s_cbranch_scc1 C_r3_x
    buffer_load_dwordx4 v[64:67], v1, s[8:11], s29 offen offset:2048 sc1
    buffer_load_dwordx4 v[68:71], v1, s[8:11], s29 offen offset:3072 sc1
    buffer_load_dwordx4 v[72:75], v1, s[8:11], s31 offen offset:2048 sc1
    buffer_load_dwordx4 v[76:79], v1, s[8:11], s31 offen offset:3072 sc1
    s_waitcnt vmcnt(0)
    v_max3_u32 v7, v64, v68, v72
    v_max_u32 v7, v76, v7
    v_cmp_eq_u32 vcc, -1, v7
    s_cbranch_vccnz C_r3
    s_branch C_r3_ok
C_r3_x:
    s_mov_b32 s41, 0
    s_branch C_r3_ok
C_t3:
    s_sub_u32 s41, s41, 1
    s_cbranch_scc1 C_t3_x
    buffer_load_dwordx2 v[240:241], v242, s[8:11], s20 offen sc1
    s_waitcnt vmcnt(0)
    v_xor_b32 v220, s74, v240
    v_xor_b32 v221, s74, v241
    v_or_b32 v220, v220, v221
    v_cmp_ne_u32 vcc, 0, v220
    v_subrev_u32 v220, s40, v240
    v_subrev_u32 v221, s40, v241
    v_max_u32 v220, v220, v221
    s_cmp_eq_u64 vcc, 0
    s_cselect_b32 s73, 1, 0
    v_cmp_lt_u32 vcc, 7, v220
    s_cbranch_vccnz C_t3
    s_branch C_t3_ok
C_t3_x:
    s_mov_b32 s41, 0
    s_branch C_t3_ok
C_sh0:
    buffer_store_dwordx4 v[244:247], v1, s[8:11], s57 offen sc1
    s_branch C_sh0_ok
C_sh1:
    buffer_store_dwordx4 v[248:251], v1, s[8:11], s21 offen sc1
    s_branch C_sh1_ok
C_ss:
    buffer_store_dwordx2 v[224:225], v12, s[8:11], s59 offen sc1
    s_branch C_ss_ok
D_rH0:
    s_sub_u32 s41, s41, 1
    s_cbranch_scc1 D_rH0_x
    buffer_load_dwordx4 v[16:19], v1, s[8:11], s12 offen offset:0 sc1
    buffer_load_dwordx4 v[20:23], v1, s[8:11], s12 offen offset:1024 sc1
    buffer_load_dwordx4 v[24:27], v1, s[8:11], s12 offen offset:2048 sc1
    buffer_load_dwordx4 v[28:31], v1, s[8:11], s12 offen offset:3072 sc1
    buffer_load_dwordx4 v[32:35], v1, s[8:11], s13 offen offset:0 sc1
    buffer_load_dwordx4 v[36:39], v1, s[8:11], s13 offen offset:1024 sc1
    buffer_load_dwordx4 v[40:43], v1, s[8:11], s13 offen offset:2048 sc1
    buffer_load_dwordx4 v[44:47], v1, s[8:11], s13 offen offset:3072 sc1
    buffer_load_dwordx4 v[48:51], v1, s[8:11], s14 offen offset:0 sc1
    buffer_load_dwordx4 v[52:55], v1, s[8:11], s14 offen offset:1024 sc1
    buffer_load_dwordx4 v[56:59], v1, s[8:11], s14 offen offset:2048 sc1
    buffer_load_dwordx4 v[60:63], v1, s[8:11], s14 offen offset:3072 sc1
    buffer_load_dwordx4 v[64:67], v1, s[8:11], s15 offen offset:0 sc1
    s_waitcnt vmcnt(0)
    v_max_u32 v7, v16, v20
    v_cmp_eq_u32 vcc, -1, v7
    s_cbranch_vccnz D_rH0
    s_branch D_rH0_ok
D_rH0_x:
    s_mov_b32 s41, 0
    s_branch D_rH0_ok
D_rH1:
    s_sub_u32 s41, s41, 1
    s_cbranch_scc1 D_rH1_x
    buffer_load_dwordx4 v[24:27], v1, s[8:11], s12 offen offset:2048 sc1
    buffer_load_dwordx4 v[28:31], v1, s[8:11], s12 offen offset:3072 sc1
    buffer_load_dwordx4 v[32:35], v1, s[8:11], s13 offen offset:0 sc1
    buffer_load_dwordx4 v[36:39], v1, s[8:11], s13 offen offset:1024 sc1
    buffer_load_dwordx4 v[40:43], v1, s[8:11], s13 offen offset:2048 sc1
    buffer_load_dwordx4 v[44:47], v1, s[8:11], s13 offen offset:3072 sc1
    buffer_load_dwordx4 v[48:51], v1, s[8:11], s14 offen offset:0 sc1
    buffer_load_dwordx4 v[52:55], v1, s[8:11], s14 offen offset:1024 sc1
    buffer_load_dwordx4 v[56:59], v1, s[8:11], s14 offen offset:2048 sc1
    buffer_load_dwordx4 v[60:63], v1, s[8:11], s14 offen offset:3072 sc1
    buffer_load_dwordx4 v[64:67], v1, s[8:11], s15 offen offset:0 sc1
    buffer_load_dwordx4 v[68:71], v1, s[8:11], s15 offen offset:1024 sc1
    buffer_load_dwordx4 v[72:75], v1, s[8:11], s15 offen offset:2048 sc1
    s_waitcnt vmcnt(0)
    v_max_u32 v7, v24, v28
    v_cmp_eq_u32 vcc, -1, v7
    s_cbranch_vccnz D_rH1
    s_branch D_rH1_ok
D_rH1_x:
    s_mov_b32 s41, 0
    s_branch D_rH1_ok
D_rH2:
    s_sub_u32 s41, s41, 1
    s_cbranch_scc1 D_rH2_x
    buffer_load_dwordx4 v[32:35], v1, s[8:11], s13 offen offset:0 sc1
    buffer_load_dwordx4 v[36:39], v1, s[8:11], s13 offen offset:1024 sc1
    buffer_load_dwordx4 v[40:43], v1, s[8:11], s13 offen offset:2048 sc1
    buffer_load_dwordx4 v[44:47], v1, s[8:11], s13 offen offset:3072 sc1
    buffer_load_dwordx4 v[48:51], v1, s[8:11], s14 offen offset:0 sc1
    buffer_load_dwordx4 v[52:55], v1, s[8:11], s14 offen offset:1024 sc1
    buffer_load_dwordx4 v[56:59], v1, s[8:11], s14 offen offset:2048 sc1
    buffer_load_dwordx4 v[60:63], v1, s[8:11], s14 offen offset:3072 sc1
    buffer_load_dwordx4 v[64:67], v1, s[8:11], s15 offen offset:0 sc1
    buffer_load_dwordx4 v[68:71], v1, s[8:11], s15 offen offset:1024 sc1
    buffer_load_dwordx4 v[72:75], v1, s[8:11], s15 offen offset:2048 sc1
    buffer_load_dwordx4 v[76:79], v1, s[8:11], s15 offen offset:3072 sc1
    buffer_load_dwordx4 v[80:83], v1, s[8:11], s16 offen offset:0 sc1
    s_waitcnt vmcnt(0)
    v_max_u32 v7, v32, v36
    v_cmp_eq_u32 vcc, -1, v7
    s_cbranch_vccnz D_rH2
    s_branch D_rH2_ok
D_rH2_x:
    s_mov_b32 s41, 0
    s_branch D_rH2_ok
D_rH3:
    s_sub_u32 s41, s41, 1
    s_cbranch_scc1 D_rH3_x
    buffer_load_dwordx4 v[40:43], v1, s[8:11], s13 offen offset:2048 sc1
    buffer_load_dwordx4 v[44:47], v1, s[8:11], s13 offen offset:3072 sc1
    buffer_load_dwordx4 v[48:51], v1, s[8:11], s14 offen offset:0 sc1
    buffer_load_dwordx4 v[52:55], v1, s[8:11], s14 offen offset:1024 sc1
    buffer_load_dwordx4 v[56:59], v1, s[8:11], s14 offen offset:2048 sc1
    buffer_load_dwordx4 v[60:63], v1, s[8:11], s14 offen offset:3072 sc1
    buffer_load_dwordx4 v[64:67], v1, s[8:11], s15 offen offset:0 sc1
    buffer_load_dwordx4 v[68:71], v1, s[8:11], s15 offen offset:1024 sc1
    buffer_load_dwordx4 v[72:75], v1, s[8:11], s15 offen offset:2048 sc1
    buffer_load_dwordx4 v[76:79], v1, s[8:11], s15 offen offset:3072 sc1
    buffer_load_dwordx4 v[80:83], v1, s[8:11], s16 offen offset:0 sc1
    buffer_load_dwordx4 v[84:87], v1, s[8:11], s16 offen offset:1024 sc1
    buffer_load_dwordx4 v[88:91], v1, s[8:11], s16 offen offset:2048 sc1
    s_waitcnt vmcnt(0)
    v_max_u32 v7, v40, v44
    v_cmp_eq_u32 vcc, -1, v7
    s_cbranch_vccnz D_rH3
    s_branch D_rH3_ok
D_rH3_x:
    s_mov_b32 s41, 0
    s_branch D_rH3_ok
D_rH4:
    s_sub_u32 s41, s41, 1
    s_cbranch_scc1 D_rH4_x
    buffer_load_dwordx4 v[48:51], v1, s[8:11], s14 offen offset:0 sc1
    buffer_load_dwordx4 v[52:55], v1, s[8:11], s14 offen offset:1024 sc1
    buffer_load_dwordx4 v[56:59], v1, s[8:11], s14 offen offset:2048 sc1
    buffer_load_dwordx4 v[60:63], v1, s[8:11], s14 offen offset:3072 sc1
    buffer_load_dwordx4 v[64:67], v1, s[8:11], s15 offen offset:0 sc1
    buffer_load_dwordx4 v[68:71], v1, s[8:11], s15 offen offset:1024 sc1
    buffer_load_dwordx4 v[72:75], v1, s[8:11], s15 offen offset:2048 sc1
    buffer_load_dwordx4 v[76:79], v1, s[8:11], s15 offen offset:3072 sc1
    buffer_load_dwordx4 v[80:83], v1, s[8:11], s16 offen offset:0 sc1
    buffer_load_dwordx4 v[84:87], v1, s[8:11], s16 offen offset:1024 sc1
    buffer_load_dwordx4 v[88:91], v1, s[8:11], s16 offen offset:2048 sc1
    buffer_load_dwordx4 v[92:95], v1, s[8:11], s16 offen offset:3072 sc1
    buffer_load_dwordx4 v[192:195], v243, s[8:11], s36 offen offset:0 sc1
    buffer_load_dwordx4 v[196:199], v243, s[8:11], s36 offen offset:16 sc1
    buffer_load_dwordx4 v[96:99], v1, s[8:11], s17 offen offset:0 sc1
    s_waitcnt vmcnt(0)
    v_max_u32 v7, v48, v52
    v_cmp_eq_u32 vcc, -1, v7
    s_cbranch_vccnz D_rH4
    s_branch D_rH4_ok
D_rH4_x:
    s_mov_b32 s41, 0
    s_branch D_rH4_ok
D_rH5:
    s_sub_u32 s41, s41, 1
    s_cbranch_scc1 D_rH5_x
    buffer_load_dwordx4 v[56:59], v1, s[8:11], s14 offen offset:2048 sc1
    buffer_load_dwordx4 v[60:63], v1, s[8:11], s14 offen offset:3072 sc1
    buffer_load_dwordx4 v[64:67], v1, s[8:11], s15 offen offset:0 sc1
    buffer_load_dwordx4 v[68:71], v1, s[8:11], s15 offen offset:1024 sc1
    buffer_load_dwordx4 v[72:75], v1, s[8:11], s15 offen offset:2048 sc1
    buffer_load_dwordx4 v[76:79], v1, s[8:11], s15 offen offset:3072 sc1
    buffer_load_dwordx4 v[80:83], v1, s[8:11], s16 offen offset:0 sc1
    buffer_load_dwordx4 v[84:87], v1, s[8:11], s16 offen offset:1024 sc1
    buffer_load_dwordx4 v[88:91], v1, s[8:11], s16 offen offset:2048 sc1
    buffer_load_dwordx4 v[92:95], v1, s[8:11], s16 offen offset:3072 sc1
    buffer_load_dwordx4 v[192:195], v243, s[8:11], s36 offen offset:0 sc1
    buffer_load_dwordx4 v[196:199], v243, s[8:11], s36 offen offset:16 sc1
    buffer_load_dwordx4 v[96:99], v1, s[8:11], s17 offen offset:0 sc1
    buffer_load_dwordx4 v[100:103], v1, s[8:11], s17 offen offset:1024 sc1
    buffer_load_dwordx4 v[104:107], v1, s[8:11], s17 offen offset:2048 sc1
    s_waitcnt vmcnt(0)
    v_max_u32 v7, v56, v60
    v_cmp_eq_u32 vcc, -1, v7
    s_cbranch_vccnz D_rH5
    s_branch D_rH5_ok
D_rH5_x:
    s_mov_b32 s41, 0
    s_branch D_rH5_ok
D_rH6:
    s_sub_u32 s41, s41, 1
    s_cbranch_scc1 D_rH6_x
    buffer_load_dwordx4 v[64:67], v1, s[8:11], s15 offen offset:0 sc1
    buffer_load_dwordx4 v[68:71], v1, s[8:11], s15 offen offset:1024 sc1
    buffer_load_dwordx4 v[72:75], v1, s[8:11], s15 offen offset:2048 sc1
    buffer_load_dwordx4 v[76:79], v1, s[8:11], s15 offen offset:3072 sc1
    buffer_load_dwordx4 v[80:83], v1, s[8:11], s16 offen offset:0 sc1
    buffer_load_dwordx4 v[84:87], v1, s[8:11], s16 offen offset:1024 sc1
    buffer_load_dwordx4 v[88:91], v1, s[8:11], s16 offen offset:2048 sc1
    buffer_load_dwordx4 v[92:95], v1, s[8:11], s16 offen offset:3072 sc1
    buffer_load_dwordx4 v[192:195], v243, s[8:11], s36 offen offset:0 sc1
    buffer_load_dwordx4 v[196:199], v243, s[8:11], s36 offen offset:16 sc1
    buffer_load_dwordx4 v[96:99], v1, s[8:11], s17 offen offset:0 sc1
    buffer_load_dwordx4 v[100:103], v1, s[8:11], s17 offen offset:1024 sc1
    buffer_load_dwordx4 v[104:107], v1, s[8:11], s17 offen offset:2048 sc1
    buffer_load_dwordx4 v[108:111], v1, s[8:11], s17 offen offset:3072 sc1
    buffer_load_dwordx4 v[112:115], v1, s[8:11], s18 offen offset:0 sc1
    s_waitcnt vmcnt(0)
    v_max_u32 v7, v64, v68
    v_cmp_eq_u32 vcc, -1, v7
    s_cbranch_vccnz D_rH6
    s_branch D_rH6_ok
D_rH6_x:
    s_mov_b32 s41, 0
    s_branch D_rH6_ok
D_rH7:
    s_sub_u32 s41, s41, 1
    s_cbranch_scc1 D_rH7_x
    buffer_load_dwordx4 v[72:75], v1, s[8:11], s15 offen offset:2048 sc1
    buffer_load_dwordx4 v[76:79], v1, s[8:11], s15 offen offset:3072 sc1
    buffer_load_dwordx4 v[80:83], v1, s[8:11], s16 offen offset:0 sc1
    buffer_load_dwordx4 v[84:87], v1, s[8:11], s16 offen offset:1024 sc1
    buffer_load_dwordx4 v[88:91], v1, s[8:11], s16 offen offset:2048 sc1
    buffer_load_dwordx4 v[92:95], v1, s[8:11], s16 offen offset:3072 sc1
    buffer_load_dwordx4 v[192:195], v243, s[8:11], s36 offen offset:0 sc1
    buffer_load_dwordx4 v[196:199], v243, s[8:11], s36 offen offset:16 sc1
    buffer_load_dwordx4 v[96:99], v1, s[8:11], s17 offen offset:0 sc1
    buffer_load_dwordx4 v[100:103], v1, s[8:11], s17 offen offset:1024 sc1
    buffer_load_dwordx4 v[104:107], v1, s[8:11], s17 offen offset:2048 sc1
    buffer_load_dwordx4 v[108:111], v1, s[8:11], s17 offen offset:3072 sc1
    buffer_load_dwordx4 v[112:115], v1, s[8:11], s18 offen offset:0 sc1
    buffer_load_dwordx4 v[116:119], v1, s[8:11], s18 offen offset:1024 sc1
    buffer_load_dwordx4 v[120:123], v1, s[8:11], s18 offen offset:2048 sc1
    s_waitcnt vmcnt(0)
    v_max_u32 v7, v72, v76
    v_cmp_eq_u32 vcc, -1, v7
    s_cbranch_vccnz D_rH7
    s_branch D_rH7_ok
D_rH7_x:
    s_mov_b32 s41, 0
    s_branch D_rH7_ok
D_rH8:
    s_sub_u32 s41, s41, 1
    s_cbranch_scc1 D_rH8_x
    buffer_load_dwordx4 v[80:83], v1, s[8:11], s16 offen offset:0 sc1
    buffer_load_dwordx4 v[84:87], v1, s[8:11], s16 offen offset:1024 sc1
    buffer_load_dwordx4 v[88:91], v1, s[8:11], s16 offen offset:2048 sc1
    buffer_load_dwordx4 v[92:95], v1, s[8:11], s16 offen offset:3072 sc1
    buffer_load_dwordx4 v[192:195], v243, s[8:11], s36 offen offset:0 sc1
    buffer_load_dwordx4 v[196:199], v243, s[8:11], s36 offen offset:16 sc1
    buffer_load_dwordx4 v[96:99], v1, s[8:11], s17 offen offset:0 sc1
    buffer_load_dwordx4 v[100:103], v1, s[8:11], s17 offen offset:1024 sc1
    buffer_load_dwordx4 v[104:107], v1, s[8:11], s17 offen offset:2048 sc1
    buffer_load_dwordx4 v[108:111], v1, s[8:11], s17 offen offset:3072 sc1
    buffer_load_dwordx4 v[112:115], v1, s[8:11], s18 offen offset:0 sc1
    buffer_load_dwordx4 v[116:119], v1, s[8:11], s18 offen offset:1024 sc1
    buffer_load_dwordx4 v[120:123], v1, s[8:11], s18 offen offset:2048 sc1
    buffer_load_dwordx4 v[124:127], v1, s[8:11], s18 offen offset:3072 sc1
    s_waitcnt vmcnt(0)
    v_max_u32 v7, v80, v84
    v_cmp_eq_u32 vcc, -1, v7
    s_cbranch_vccnz D_rH8
    s_branch D_rH8_ok
D_rH8_x:
    s_mov_b32 s41, 0
    s_branch D_rH8_ok
D_rH9:
    s_sub_u32 s41, s41, 1
    s_cbranch_scc1 D_rH9_x
    buffer_load_dwordx4 v[88:91], v1, s[8:11], s16 offen offset:2048 sc1
    buffer_load_dwordx4 v[92:95], v1, s[8:11], s16 offen offset:3072 sc1
    buffer_load_dwordx4 v[192:195], v243, s[8:11], s36 offen offset:0 sc1
    buffer_load_dwordx4 v[196:199], v243, s[8:11], s36 offen offset:16 sc1
    buffer_load_dwordx4 v[96:99], v1, s[8:11], s17 offen offset:0 sc1
    buffer_load_dwordx4 v[100:103], v1, s[8:11], s17 offen offset:1024 sc1
    buffer_load_dwordx4 v[104:107], v1, s[8:11], s17 offen offset:2048 sc1
    buffer_load_dwordx4 v[108:111], v1, s[8:11], s17 offen offset:3072 sc1
    buffer_load_dwordx4 v[112:115], v1, s[8:11], s18 offen offset:0 sc1
    buffer_load_dwordx4 v[116:119], v1, s[8:11], s18 offen offset:1024 sc1
    buffer_load_dwordx4 v[120:123], v1, s[8:11], s18 offen offset:2048 sc1
    buffer_load_dwordx4 v[124:127], v1, s[8:11], s18 offen offset:3072 sc1
    s_waitcnt vmcnt(0)
    v_max_u32 v7, v88, v92
    v_cmp_eq_u32 vcc, -1, v7
    s_cbranch_vccnz D_rH9
    s_branch D_rH9_ok
D_rH9_x:
    s_mov_b32 s41, 0
    s_branch D_rH9_ok
D_rH10:
    s_sub_u32 s41, s41, 1
    s_cbranch_scc1 D_rH10_x
    buffer_load_dwordx4 v[192:195], v243, s[8:11], s36 offen offset:0 sc1
    buffer_load_dwordx4 v[196:199], v243, s[8:11], s36 offen offset:16 sc1
    buffer_load_dwordx4 v[96:99], v1, s[8:11], s17 offen offset:0 sc1
    buffer_load_dwordx4 v[100:103], v1, s[8:11], s17 offen offset:1024 sc1
    buffer_load_dwordx4 v[104:107], v1, s[8:11], s17 offen offset:2048 sc1
    buffer_load_dwordx4 v[108:111], v1, s[8:11], s17 offen offset:3072 sc1
    buffer_load_dwordx4 v[112:115], v1, s[8:11], s18 offen offset:0 sc1
    buffer_load_dwordx4 v[116:119], v1, s[8:11], s18 offen offset:1024 sc1
    buffer_load_dwordx4 v[120:123], v1, s[8:11], s18 offen offset:2048 sc1
    buffer_load_dwordx4 v[124:127], v1, s[8:11], s18 offen offset:3072 sc1
    s_waitcnt vmcnt(0)
    v_max_u32 v7, v96, v100
    v_cmp_eq_u32 vcc, -1, v7
    s_cbranch_vccnz D_rH10
    s_branch D_rH10_ok
D_rH10_x:
    s_mov_b32 s41, 0
    s_branch D_rH10_ok
D_rS0:
    s_sub_u32 s41, s41, 1
    s_cbranch_scc1 D_rS0_x
    buffer_load_dwordx4 v[192:195], v243, s[8:11], s36 offen offset:0 sc1
    buffer_load_dwordx4 v[196:199], v243, s[8:11], s36 offen offset:16 sc1
    buffer_load_dwordx4 v[104:107], v1, s[8:11], s17 offen offset:2048 sc1
    buffer_load_dwordx4 v[108:111], v1, s[8:11], s17 offen offset:3072 sc1
    buffer_load_dwordx4 v[112:115], v1, s[8:11], s18 offen offset:0 sc1
    buffer_load_dwordx4 v[116:119], v1, s[8:11], s18 offen offset:1024 sc1
    buffer_load_dwordx4 v[120:123], v1, s[8:11], s18 offen offset:2048 sc1
    buffer_load_dwordx4 v[124:127], v1, s[8:11], s18 offen offset:3072 sc1
    s_waitcnt vmcnt(0)
    s_mov_b32 exec_lo, 0
    v_mov_b32 v198, 0
    v_mov_b32 v199, 0
    s_mov_b32 exec_lo, -1
    v_max3_u32 v7, v192, v194, v196
    v_max_u32 v7, v198, v7
    v_cmp_eq_u32 vcc, -1, v7
    s_cbranch_vccnz D_rS0
    s_branch D_rS0_ok
D_rS0_x:
    s_mov_b32 s41, 0
    s_branch D_rS0_ok
D_rH11:
    s_sub_u32 s41, s41, 1
    s_cbranch_scc1 D_rH11_x
    buffer_load_dwordx4 v[104:107], v1, s[8:11], s17 offen offset:2048 sc1
    buffer_load_dwordx4 v[108:111], v1, s[8:11], s17 offen offset:3072 sc1
    buffer_load_dwordx4 v[112:115], v1, s[8:11], s18 offen offset:0 sc1
    buffer_load_dwordx4 v[116:119], v1, s[8:11], s18 offen offset:1024 sc1
    buffer_load_dwordx4 v[120:123], v1, s[8:11], s18 offen offset:2048 sc1
    buffer_load_dwordx4 v[124:127], v1, s[8:11], s18 offen offset:3072 sc1
    s_waitcnt vmcnt(0)
    v_max_u32 v7, v104, v108
    v_cmp_eq_u32 vcc, -1, v7
    s_cbranch_vccnz D_rH11
    s_branch D_rH11_ok
D_rH11_x:
    s_mov_b32 s41, 0
    s_branch D_rH11_ok
D_rH12:
    s_sub_u32 s41, s41, 1
    s_cbranch_scc1 D_rH12_x
    buffer_load_dwordx4 v[112:115], v1, s[8:11], s18 offen offset:0 sc1
    buffer_load_dwordx4 v[116:119], v1, s[8:11], s18 offen offset:1024 sc1
    buffer_load_dwordx4 v[120:123], v1, s[8:11], s18 offen offset:2048 sc1
    buffer_load_dwordx4 v[124:127], v1, s[8:11], s18 offen offset:3072 sc1
    s_waitcnt vmcnt(0)
    v_max_u32 v7, v112, v116
    v_cmp_eq_u32 vcc, -1, v7
    s_cbranch_vccnz D_rH12
    s_branch D_rH12_ok
D_rH12_x:
    s_mov_b32 s41, 0
    s_branch D_rH12_ok
D_rH13:
    s_sub_u32 s41, s41, 1
    s_cbranch_scc1 D_rH13_x
    buffer_load_dwordx4 v[120:123], v1, s[8:11], s18 offen offset:2048 sc1
    buffer_load_dwordx4 v[124:127], v1, s[8:11], s18 offen offset:3072 sc1
    s_waitcnt vmcnt(0)
    v_max_u32 v7, v120, v124
    v_cmp_eq_u32 vcc, -1, v7
    s_cbranch_vccnz D_rH13
    s_branch D_rH13_ok
D_rH13_x:
    s_mov_b32 s41, 0
    s_branch D_rH13_ok
D_s10:
    buffer_store_dwordx4 v[240:243], v1, s[8:11], s58 offen offset:2048 sc1
    s_branch D_s10_ok
D_s11:
    buffer_store_dwordx4 v[244:247], v1, s[8:11], s58 offen offset:3072 sc1
    s_branch D_s11_ok
D_rE0:
    s_sub_u32 s41, s41, 1
    s_cbranch_scc1 D_rE0_x
    buffer_load_dwordx4 v[16:19], v1, s[8:11], s44 offen offset:0 sc1
    buffer_load_dwordx4 v[24:27], v3, s[8:11], s44 offen offset:0 sc1
    buffer_load_dwordx4 v[20:23], v1, s[8:11], s44 offen offset:1024 sc1
    buffer_load_dwordx4 v[28:31], v3, s[8:11], s44 offen offset:1024 sc1
    buffer_load_dwordx4 v[32:35], v1, s[8:11], s45 offen offset:0 sc1
    buffer_load_dwordx4 v[40:43], v3, s[8:11], s45 offen offset:0 sc1
    buffer_load_dwordx4 v[36:39], v1, s[8:11], s45 offen offset:1024 sc1
    buffer_load_dwordx4 v[44:47], v3, s[8:11], s45 offen offset:1024 sc1
    buffer_load_dwordx4 v[48:51], v1, s[8:11], s46 offen offset:0 sc1
    buffer_load_dwordx4 v[56:59], v3, s[8:11], s46 offen offset:0 sc1
    buffer_load_dwordx4 v[52:55], v1, s[8:11], s46 offen offset:1024 sc1
    buffer_load_dwordx4 v[60:63], v3, s[8:11], s46 offen offset:1024 sc1
    s_waitcnt vmcnt(0)
    v_max3_u32 v7, v16, v20, v24
    v_max_u32 v7, v28, v7
    v_cmp_eq_u32 vcc, -1, v7
    s_cbranch_vccnz D_rE0
    s_branch D_rE0_ok
D_rE0_x:
    s_mov_b32 s41, 0
    s_branch D_rE0_ok
D_s20:
    buffer_store_dwordx4 v[240:243], v1, s[8:11], s37 offen offset:0 sc1
    s_branch D_s20_ok
D_rE1:
    s_sub_u32 s41, s41, 1
    s_cbranch_scc1 D_rE1_x
    buffer_load_dwordx4 v[32:35], v1, s[8:11], s45 offen offset:0 sc1
    buffer_load_dwordx4 v[40:43], v3, s[8:11], s45 offen offset:0 sc1
    buffer_load_dwordx4 v[36:39], v1, s[8:11], s45 offen offset:1024 sc1
    buffer_load_dwordx4 v[44:47], v3, s[8:11], s45 offen offset:1024 sc1
    buffer_load_dwordx4 v[48:51], v1, s[8:11], s46 offen offset:0 sc1
    buffer_load_dwordx4 v[56:59], v3, s[8:11], s46 offen offset:0 sc1
    buffer_load_dwordx4 v[52:55], v1, s[8:11], s46 offen offset:1024 sc1
    buffer_load_dwordx4 v[60:63], v3, s[8:11], s46 offen offset:1024 sc1
    s_waitcnt vmcnt(0)
    v_max3_u32 v7, v32, v36, v40
    v_max_u32 v7, v44, v7
    v_cmp_eq_u32 vcc, -1, v7
    s_cbranch_vccnz D_rE1
    s_branch D_rE1_ok
D_rE1_x:
    s_mov_b32 s41, 0
    s_branch D_rE1_ok
D_rE2:
    s_sub_u32 s41, s41, 1
    s_cbranch_scc1 D_rE2_x
    buffer_load_dwordx4 v[48:51], v1, s[8:11], s46 offen offset:0 sc1
    buffer_load_dwordx4 v[56:59], v3, s[8:11], s46 offen offset:0 sc1
    buffer_load_dwordx4 v[52:55], v1, s[8:11], s46 offen offset:1024 sc1
    buffer_load_dwordx4 v[60:63], v3, s[8:11], s46 offen offset:1024 sc1
    buffer_load_dwordx4 v[64:67], v1, s[8:11], s47 offen offset:0 sc1
    buffer_load_dwordx4 v[72:75], v3, s[8:11], s47 offen offset:0 sc1
    buffer_load_dwordx4 v[68:71], v1, s[8:11], s47 offen offset:1024 sc1
    buffer_load_dwordx4 v[76:79], v3, s[8:11], s47 offen offset:1024 sc1
    buffer_load_dwordx4 v[80:83], v1, s[8:11], s48 offen offset:0 sc1
    buffer_load_dwordx4 v[88:91], v3, s[8:11], s48 offen offset:0 sc1
    buffer_load_dwordx4 v[84:87], v1, s[8:11], s48 offen offset:1024 sc1
    buffer_load_dwordx4 v[92:95], v3, s[8:11], s48 offen offset:1024 sc1
    buffer_load_dwordx4 v[96:99], v1, s[8:11], s49 offen offset:0 sc1
    buffer_load_dwordx4 v[104:107], v3, s[8:11], s49 offen offset:0 sc1
    buffer_load_dwordx4 v[100:103], v1, s[8:11], s49 offen offset:1024 sc1
    s_waitcnt vmcnt(0)
    v_max3_u32 v7, v48, v52, v56
    v_max_u32 v7, v60, v7
    v_cmp_eq_u32 vcc, -1, v7
    s_cbranch_vccnz D_rE2
    s_branch D_rE2_ok
D_rE2_x:
    s_mov_b32 s41, 0
    s_branch D_rE2_ok
D_s21:
    buffer_store_dwordx4 v[244:247], v1, s[8:11], s37 offen offset:1024 sc1
    s_branch D_s21_ok
D_rE3:
    s_sub_u32 s41, s41, 1
    s_cbranch_scc1 D_rE3_x
    buffer_load_dwordx4 v[64:67], v1, s[8:11], s47 offen offset:0 sc1
    buffer_load_dwordx4 v[72:75], v3, s[8:11], s47 offen offset:0 sc1
    buffer_load_dwordx4 v[68:71], v1, s[8:11], s47 offen offset:1024 sc1
    buffer_load_dwordx4 v[76:79], v3, s[8:11], s47 offen offset:1024 sc1
    buffer_load_dwordx4 v[80:83], v1, s[8:11], s48 offen offset:0 sc1
    buffer_load_dwordx4 v[88:91], v3, s[8:11], s48 offen offset:0 sc1
    buffer_load_dwordx4 v[84:87], v1, s[8:11], s48 offen offset:1024 sc1
    buffer_load_dwordx4 v[92:95], v3, s[8:11], s48 offen offset:1024 sc1
    buffer_load_dwordx4 v[96:99], v1, s[8:11], s49 offen offset:0 sc1
    buffer_load_dwordx4 v[104:107], v3, s[8:11], s49 offen offset:0 sc1
    buffer_load_dwordx4 v[100:103], v1, s[8:11], s49 offen offset:1024 sc1
    buffer_load_dwordx4 v[108:111], v3, s[8:11], s49 offen offset:1024 sc1
    buffer_load_dwordx4 v[144:147], v1, s[8:11], s50 offen offset:0 sc1
    buffer_load_dwordx4 v[152:155], v3, s[8:11], s50 offen offset:0 sc1
    buffer_load_dwordx4 v[148:151], v1, s[8:11], s50 offen offset:1024 sc1
    buffer_load_dwordx4 v[156:159], v3, s[8:11], s50 offen offset:1024 sc1
    s_waitcnt vmcnt(0)
    v_max3_u32 v7, v64, v68, v72
    v_max_u32 v7, v76, v7
    v_cmp_eq_u32 vcc, -1, v7
    s_cbranch_vccnz D_rE3
    s_branch D_rE3_ok
D_rE3_x:
    s_mov_b32 s41, 0
    s_branch D_rE3_ok
D_s30:
    buffer_store_dwordx4 v[240:243], v1, s[8:11], s37 offen offset:2048 sc1
    s_branch D_s30_ok
D_rE4:
    s_sub_u32 s41, s41, 1
    s_cbranch_scc1 D_rE4_x
    buffer_load_dwordx4 v[80:83], v1, s[8:11], s48 offen offset:0 sc1
    buffer_load_dwordx4 v[88:91], v3, s[8:11], s48 offen offset:0 sc1
    buffer_load_dwordx4 v[84:87], v1, s[8:11], s48 offen offset:1024 sc1
    buffer_load_dwordx4 v[92:95], v3, s[8:11], s48 offen offset:1024 sc1
    buffer_load_dwordx4 v[96:99], v1, s[8:11], s49 offen offset:0 sc1
    buffer_load_dwordx4 v[104:107], v3, s[8:11], s49 offen offset:0 sc1
    buffer_load_dwordx4 v[100:103], v1, s[8:11], s49 offen offset:1024 sc1
    buffer_load_dwordx4 v[108:111], v3, s[8:11], s49 offen offset:1024 sc1
    buffer_load_dwordx4 v[144:147], v1, s[8:11], s50 offen offset:0 sc1
    buffer_load_dwordx4 v[152:155], v3, s[8:11], s50 offen offset:0 sc1
    buffer_load_dwordx4 v[148:151], v1, s[8:11], s50 offen offset:1024 sc1
    buffer_load_dwordx4 v[156:159], v3, s[8:11], s50 offen offset:1024 sc1
    s_waitcnt vmcnt(0)
    v_max3_u32 v7, v80, v84, v88
    v_max_u32 v7, v92, v7
    v_cmp_eq_u32 vcc, -1, v7
    s_cbranch_vccnz D_rE4
    s_branch D_rE4_ok
D_rE4_x:
    s_mov_b32 s41, 0
    s_branch D_rE4_ok
D_rE5:
    s_sub_u32 s41, s41, 1
    s_cbranch_scc1 D_rE5_x
    buffer_load_dwordx4 v[96:99], v1, s[8:11], s49 offen offset:0 sc1
    buffer_load_dwordx4 v[104:107], v3, s[8:11], s49 offen offset:0 sc1
    buffer_load_dwordx4 v[100:103], v1, s[8:11], s49 offen offset:1024 sc1
    buffer_load_dwordx4 v[108:111], v3, s[8:11], s49 offen offset:1024 sc1
    buffer_load_dwordx4 v[144:147], v1, s[8:11], s50 offen offset:0 sc1
    buffer_load_dwordx4 v[152:155], v3, s[8:11], s50 offen offset:0 sc1
    buffer_load_dwordx4 v[148:151], v1, s[8:11], s50 offen offset:1024 sc1
    buffer_load_dwordx4 v[156:159], v3, s[8:11], s50 offen offset:1024 sc1
    buffer_load_dwordx4 v[16:19], v1, s[8:11], s53 offen offset:0 sc1
    buffer_load_dwordx4 v[24:27], v3, s[8:11], s53 offen offset:0 sc1
    buffer_load_dwordx4 v[20:23], v1, s[8:11], s53 offen offset:1024 sc1
    buffer_load_dwordx4 v[28:31], v3, s[8:11], s53 offen offset:1024 sc1
    buffer_load_dwordx4 v[32:35], v1, s[8:11], s54 offen offset:0 sc1
    buffer_load_dwordx4 v[40:43], v3, s[8:11], s54 offen offset:0 sc1
    buffer_load_dwordx4 v[36:39], v1, s[8:11], s54 offen offset:1024 sc1
    buffer_load_dwordx4 v[44:47], v3, s[8:11], s54 offen offset:1024 sc1
    buffer_load_dwordx4 v[48:51], v1, s[8:11], s55 offen offset:0 sc1
    buffer_load_dwordx4 v[56:59], v3, s[8:11], s55 offen offset:0 sc1
    buffer_load_dwordx4 v[52:55], v1, s[8:11], s55 offen offset:1024 sc1
    buffer_load_dwordx4 v[60:63], v3, s[8:11], s55 offen offset:1024 sc1
    s_waitcnt vmcnt(0)
    v_max3_u32 v7, v96, v100, v104
    v_max_u32 v7, v108, v7
    v_cmp_eq_u32 vcc, -1, v7
    s_cbranch_vccnz D_rE5
    s_branch D_rE5_ok
D_rE5_x:
    s_mov_b32 s41, 0
    s_branch D_rE5_ok
D_s31:
    buffer_store_dwordx4 v[244:247], v1, s[8:11], s37 offen offset:3072 sc1
    s_branch D_s31_ok
D_rE6:
    s_sub_u32 s41, s41, 1
    s_cbranch_scc1 D_rE6_x
    buffer_load_dwordx4 v[144:147], v1, s[8:11], s50 offen offset:0 sc1
    buffer_load_dwordx4 v[152:155], v3, s[8:11], s50 offen offset:0 sc1
    buffer_load_dwordx4 v[148:151], v1, s[8:11], s50 offen offset:1024 sc1
    buffer_load_dwordx4 v[156:159], v3, s[8:11], s50 offen offset:1024 sc1
    buffer_load_dwordx4 v[16:19], v1, s[8:11], s53 offen offset:0 sc1
    buffer_load_dwordx4 v[24:27], v3, s[8:11], s53 offen offset:0 sc1
    buffer_load_dwordx4 v[20:23], v1, s[8:11], s53 offen offset:1024 sc1
    buffer_load_dwordx4 v[28:31], v3, s[8:11], s53 offen offset:1024 sc1
    buffer_load_dwordx4 v[32:35], v1, s[8:11], s54 offen offset:0 sc1
    buffer_load_dwordx4 v[40:43], v3, s[8:11], s54 offen offset:0 sc1
    buffer_load_dwordx4 v[36:39], v1, s[8:11], s54 offen offset:1024 sc1
    buffer_load_dwordx4 v[44:47], v3, s[8:11], s54 offen offset:1024 sc1
    buffer_load_dwordx4 v[48:51], v1, s[8:11], s55 offen offset:0 sc1
    buffer_load_dwordx4 v[56:59], v3, s[8:11], s55 offen offset:0 sc1
    buffer_load_dwordx4 v[52:55], v1, s[8:11], s55 offen offset:1024 sc1
    buffer_load_dwordx4 v[60:63], v3, s[8:11], s55 offen offset:1024 sc1
    s_waitcnt vmcnt(0)
    v_max3_u32 v7, v144, v148, v152
    v_max_u32 v7, v156, v7
    v_cmp_eq_u32 vcc, -1, v7
    s_cbranch_vccnz D_rE6
    s_branch D_rE6_ok
D_rE6_x:
    s_mov_b32 s41, 0
    s_branch D_rE6_ok
D_rE7:
    s_sub_u32 s41, s41, 1
    s_cbranch_scc1 D_rE7_x
    buffer_load_dwordx4 v[16:19], v1, s[8:11], s53 offen offset:0 sc1
    buffer_load_dwordx4 v[24:27], v3, s[8:11], s53 offen offset:0 sc1
    buffer_load_dwordx4 v[20:23], v1, s[8:11], s53 offen offset:1024 sc1
    buffer_load_dwordx4 v[28:31], v3, s[8:11], s53 offen offset:1024 sc1
    buffer_load_dwordx4 v[32:35], v1, s[8:11], s54 offen offset:0 sc1
    buffer_load_dwordx4 v[40:43], v3, s[8:11], s54 offen offset:0 sc1
    buffer_load_dwordx4 v[36:39], v1, s[8:11], s54 offen offset:1024 sc1
    buffer_load_dwordx4 v[44:47], v3, s[8:11], s54 offen offset:1024 sc1
    buffer_load_dwordx4 v[48:51], v1, s[8:11], s55 offen offset:0 sc1
    buffer_load_dwordx4 v[56:59], v3, s[8:11], s55 offen offset:0 sc1
    buffer_load_dwordx4 v[52:55], v1, s[8:11], s55 offen offset:1024 sc1
    buffer_load_dwordx4 v[60:63], v3, s[8:11], s55 offen offset:1024 sc1
    s_waitcnt vmcnt(0)
    v_max3_u32 v7, v16, v20, v24
    v_max_u32 v7, v28, v7
    v_cmp_eq_u32 vcc, -1, v7
    s_cbranch_vccnz D_rE7
    s_branch D_rE7_ok
D_rE7_x:
    s_mov_b32 s41, 0
    s_branch D_rE7_ok
D_rE8:
    s_sub_u32 s41, s41, 1
    s_cbranch_scc1 D_rE8_x
    buffer_load_dwordx4 v[32:35], v1, s[8:11], s54 offen offset:0 sc1
    buffer_load_dwordx4 v[40:43], v3, s[8:11], s54 offen offset:0 sc1
    buffer_load_dwordx4 v[36:39], v1, s[8:11], s54 offen offset:1024 sc1
    buffer_load_dwordx4 v[44:47], v3, s[8:11], s54 offen offset:1024 sc1
    buffer_load_dwordx4 v[48:51], v1, s[8:11], s55 offen offset:0 sc1
    buffer_load_dwordx4 v[56:59], v3, s[8:11], s55 offen offset:0 sc1
    buffer_load_dwordx4 v[52:55], v1, s[8:11], s55 offen offset:1024 sc1
    buffer_load_dwordx4 v[60:63], v3, s[8:11], s55 offen offset:1024 sc1
    s_waitcnt vmcnt(0)
    v_max3_u32 v7, v32, v36, v40
    v_max_u32 v7, v44, v7
    v_cmp_eq_u32 vcc, -1, v7
    s_cbranch_vccnz D_rE8
    s_branch D_rE8_ok
D_rE8_x:
    s_mov_b32 s41, 0
    s_branch D_rE8_ok
D_rE9:
    s_sub_u32 s41, s41, 1
    s_cbranch_scc1 D_rE9_x
    buffer_load_dwordx4 v[48:51], v1, s[8:11], s55 offen offset:0 sc1
    buffer_load_dwordx4 v[56:59], v3, s[8:11], s55 offen offset:0 sc1
    buffer_load_dwordx4 v[52:55], v1, s[8:11], s55 offen offset:1024 sc1
    buffer_load_dwordx4 v[60:63], v3, s[8:11], s55 offen offset:1024 sc1
    buffer_load_dwordx4 v[64:67], v1, s[8:11], s56 offen offset:0 sc1
    buffer_load_dwordx4 v[72:75], v3, s[8:11], s56 offen offset:0 sc1
    buffer_load_dwordx4 v[68:71], v1, s[8:11], s56 offen offset:1024 sc1
    buffer_load_dwordx4 v[76:79], v3, s[8:11], s56 offen offset:1024 sc1
    buffer_load_dwordx4 v[80:83], v1, s[8:11], s60 offen offset:0 sc1
    buffer_load_dwordx4 v[88:91], v3, s[8:11], s60 offen offset:0 sc1
    buffer_load_dwordx4 v[84:87], v1, s[8:11], s60 offen offset:1024 sc1
    buffer_load_dwordx4 v[92:95], v3, s[8:11], s60 offen offset:1024 sc1
    buffer_load_dwordx4 v[96:99], v1, s[8:11], s65 offen offset:0 sc1
    buffer_load_dwordx4 v[104:107], v3, s[8:11], s65 offen offset:0 sc1
    buffer_load_dwordx4 v[100:103], v1, s[8:11], s65 offen offset:1024 sc1
    buffer_load_dwordx4 v[108:111], v3, s[8:11], s65 offen offset:1024 sc1
    buffer_load_dwordx4 v[144:147], v1, s[8:11], s6 offen offset:0 sc1
    buffer_load_dwordx4 v[152:155], v3, s[8:11], s6 offen offset:0 sc1
    buffer_load_dwordx4 v[148:151], v1, s[8:11], s6 offen offset:1024 sc1
    s_waitcnt vmcnt(0)
    v_max3_u32 v7, v48, v52, v56
    v_max_u32 v7, v60, v7
    v_cmp_eq_u32 vcc, -1, v7
    s_cbranch_vccnz D_rE9
    s_branch D_rE9_ok
D_rE9_x:
    s_mov_b32 s41, 0
    s_branch D_rE9_ok
D_rE10:
    s_sub_u32 s41, s41, 1
    s_cbranch_scc1 D_rE10_x
    buffer_load_dwordx4 v[64:67], v1, s[8:11], s56 offen offset:0 sc1
    buffer_load_dwordx4 v[72:75], v3, s[8:11], s56 offen offset:0 sc1
    buffer_load_dwordx4 v[68:71], v1, s[8:11], s56 offen offset:1024 sc1
    buffer_load_dwordx4 v[76:79], v3, s[8:11], s56 offen offset:1024 sc1
    buffer_load_dwordx4 v[80:83], v1, s[8:11], s60 offen offset:0 sc1
    buffer_load_dwordx4 v[88:91], v3, s[8:11], s60 offen offset:0 sc1
    buffer_load_dwordx4 v[84:87], v1, s[8:11], s60 offen offset:1024 sc1
    buffer_load_dwordx4 v[92:95], v3, s[8:11], s60 offen offset:1024 sc1
    buffer_load_dwordx4 v[96:99], v1, s[8:11], s65 offen offset:0 sc1
    buffer_load_dwordx4 v[104:107], v3, s[8:11], s65 offen offset:0 sc1
    buffer_load_dwordx4 v[100:103], v1, s[8:11], s65 offen offset:1024 sc1
    buffer_load_dwordx4 v[108:111], v3, s[8:11], s65 offen offset:1024 sc1
    buffer_load_dwordx4 v[144:147], v1, s[8:11], s6 offen offset:0 sc1
    buffer_load_dwordx4 v[152:155], v3, s[8:11], s6 offen offset:0 sc1
    buffer_load_dwordx4 v[148:151], v1, s[8:11], s6 offen offset:1024 sc1
    buffer_load_dwordx4 v[156:159], v3, s[8:11], s6 offen offset:1024 sc1
    s_waitcnt vmcnt(0)
    v_max3_u32 v7, v64, v68, v72
    v_max_u32 v7, v76, v7
    v_cmp_eq_u32 vcc, -1, v7
    s_cbranch_vccnz D_rE10
    s_branch D_rE10_ok
D_rE10_x:
    s_mov_b32 s41, 0
    s_branch D_rE10_ok
D_rE11:
    s_sub_u32 s41, s41, 1
    s_cbranch_scc1 D_rE11_x
    buffer_load_dwordx4 v[80:83], v1, s[8:11], s60 offen offset:0 sc1
    buffer_load_dwordx4 v[88:91], v3, s[8:11], s60 offen offset:0 sc1
    buffer_load_dwordx4 v[84:87], v1, s[8:11], s60 offen offset:1024 sc1
    buffer_load_dwordx4 v[92:95], v3, s[8:11], s60 offen offset:1024 sc1
    buffer_load_dwordx4 v[96:99], v1, s[8:11], s65 offen offset:0 sc1
    buffer_load_dwordx4 v[104:107], v3, s[8:11], s65 offen offset:0 sc1
    buffer_load_dwordx4 v[100:103], v1, s[8:11], s65 offen offset:1024 sc1
    buffer_load_dwordx4 v[108:111], v3, s[8:11], s65 offen offset:1024 sc1
    buffer_load_dwordx4 v[144:147], v1, s[8:11], s6 offen offset:0 sc1
    buffer_load_dwordx4 v[152:155], v3, s[8:11], s6 offen offset:0 sc1
    buffer_load_dwordx4 v[148:151], v1, s[8:11], s6 offen offset:1024 sc1
    buffer_load_dwordx4 v[156:159], v3, s[8:11], s6 offen offset:1024 sc1
    s_waitcnt vmcnt(0)
    v_max3_u32 v7, v80, v84, v88
    v_max_u32 v7, v92, v7
    v_cmp_eq_u32 vcc, -1, v7
    s_cbranch_vccnz D_rE11
    s_branch D_rE11_ok
D_rE11_x:
    s_mov_b32 s41, 0
    s_branch D_rE11_ok
D_rE12:
    s_sub_u32 s41, s41, 1
    s_cbranch_scc1 D_rE12_x
    buffer_load_dwordx4 v[96:99], v1, s[8:11], s65 offen offset:0 sc1
    buffer_load_dwordx4 v[104:107], v3, s[8:11], s65 offen offset:0 sc1
    buffer_load_dwordx4 v[100:103], v1, s[8:11], s65 offen offset:1024 sc1
    buffer_load_dwordx4 v[108:111], v3, s[8:11], s65 offen offset:1024 sc1
    buffer_load_dwordx4 v[144:147], v1, s[8:11], s6 offen offset:0 sc1
    buffer_load_dwordx4 v[152:155], v3, s[8:11], s6 offen offset:0 sc1
    buffer_load_dwordx4 v[148:151], v1, s[8:11], s6 offen offset:1024 sc1
    buffer_load_dwordx4 v[156:159], v3, s[8:11], s6 offen offset:1024 sc1
    s_waitcnt vmcnt(0)
    v_max3_u32 v7, v96, v100, v104
    v_max_u32 v7, v108, v7
    v_cmp_eq_u32 vcc, -1, v7
    s_cbranch_vccnz D_rE12
    s_branch D_rE12_ok
D_rE12_x:
    s_mov_b32 s41, 0
    s_branch D_rE12_ok
D_rE13:
    s_sub_u32 s41, s41, 1
    s_cbranch_scc1 D_rE13_x
    buffer_load_dwordx4 v[144:147], v1, s[8:11], s6 offen offset:0 sc1
    buffer_load_dwordx4 v[152:155], v3, s[8:11], s6 offen offset:0 sc1
    buffer_load_dwordx4 v[148:151], v1, s[8:11], s6 offen offset:1024 sc1
    buffer_load_dwordx4 v[156:159], v3, s[8:11], s6 offen offset:1024 sc1
    s_waitcnt vmcnt(0)
    v_max3_u32 v7, v144, v148, v152
    v_max_u32 v7, v156, v7
    v_cmp_eq_u32 vcc, -1, v7
    s_cbranch_vccnz D_rE13
    s_branch D_rE13_ok
D_rE13_x:
    s_mov_b32 s41, 0
    s_branch D_rE13_ok
B_ep:
    s_sub_u32 s41, s41, 1
    s_cbranch_scc1 B_ep_x
    s_mov_b32 s66, 0x1170000
    buffer_load_dwordx4 v[16:19], v1, s[8:11], s66 offen offset:0 sc1
    buffer_load_dwordx4 v[20:23], v1, s[8:11], s66 offen offset:1024 sc1
    buffer_load_dwordx4 v[24:27], v1, s[8:11], s66 offen offset:2048 sc1
    buffer_load_dwordx4 v[28:31], v1, s[8:11], s66 offen offset:3072 sc1
    s_waitcnt vmcnt(0)
    v_subrev_u32 v16, s40, v16
    v_subrev_u32 v17, s40, v17
    v_subrev_u32 v18, s40, v18
    v_subrev_u32 v19, s40, v19
    v_subrev_u32 v20, s40, v20
    v_subrev_u32 v21, s40, v21
    v_subrev_u32 v22, s40, v22
    v_subrev_u32 v23, s40, v23
    v_subrev_u32 v24, s40, v24
    v_subrev_u32 v25, s40, v25
    v_subrev_u32 v26, s40, v26
    v_subrev_u32 v27, s40, v27
    v_subrev_u32 v28, s40, v28
    v_subrev_u32 v29, s40, v29
    v_subrev_u32 v30, s40, v30
    v_subrev_u32 v31, s40, v31
    v_max3_u32 v16, v16, v17, v18
    v_max3_u32 v16, v16, v19, v20
    v_max3_u32 v16, v16, v21, v22
    v_max3_u32 v16, v16, v23, v24
    v_max3_u32 v16, v16, v25, v26
    v_max3_u32 v16, v16, v27, v28
    v_max3_u32 v16, v16, v29, v30
    v_max_u32 v16, v16, v31
    v_cmp_lt_u32 vcc, 7, v16
    s_cbranch_vccnz B_ep
    s_branch B_ep_ok
B_ep_x:
    s_mov_b32 s41, 0
    s_branch B_ep_ok
B_slow:
    s_waitcnt vmcnt(0) lgkmcnt(0)
    s_lshl_b32 s66, s65, 18
    s_add_u32 s66, s66, 0x200000
    s_mov_b32 s67, 64
    v_mov_b32 v192, 0xff7fffff
    v_accvgpr_read_b32 v200, a232
    v_accvgpr_read_b32 v201, a233
    v_accvgpr_read_b32 v202, a234
    v_accvgpr_read_b32 v203, a235
    v_accvgpr_read_b32 v204, a236
    v_accvgpr_read_b32 v205, a237
    v_accvgpr_read_b32 v206, a238
    v_accvgpr_read_b32 v207, a239
    v_mov_b32 v96, 0
    v_mov_b32 v97, 0
    v_mov_b32 v98, 0
    v_mov_b32 v99, 0
    v_mov_b32 v100, 0
    v_mov_b32 v101, 0
    v_mov_b32 v102, 0
    v_mov_b32 v103, 0
    v_mov_b32 v104, 0
    v_mov_b32 v105, 0
    v_mov_b32 v106, 0
    v_mov_b32 v107, 0
    v_mov_b32 v108, 0
    v_mov_b32 v109, 0
    v_mov_b32 v110, 0
    v_mov_b32 v111, 0
    s_waitcnt vmcnt(0)
B_slow_loop:
    buffer_load_dwordx4 v[24:27], v1, s[8:11], s66 offen offset:0 sc1
    buffer_load_dwordx4 v[28:31], v1, s[8:11], s66 offen offset:1024 sc1
    buffer_load_dwordx4 v[208:211], v1, s[8:11], s66 offen offset:2048 sc1
    buffer_load_dwordx4 v[212:215], v1, s[8:11], s66 offen offset:3072 sc1
    s_add_u32 s66, s66, 4096
    s_waitcnt vmcnt(0)
    v_mfma_f32_32x32x16_bf16 v[128:143], v[24:27], v[200:203], 0
    v_mfma_f32_32x32x16_bf16 v[128:143], v[28:31], v[204:207], v[128:143]
    s_nop 11
    v_max3_f32 v193, v128, v129, v192
    v_max3_f32 v193, v130, v131, v193
    v_max3_f32 v193, v132, v133, v193
    v_max3_f32 v193, v134, v135, v193
    v_max3_f32 v193, v136, v137, v193
    v_max3_f32 v193, v138, v139, v193
    v_max3_f32 v193, v140, v141, v193
    v_max3_f32 v193, v142, v143, v193
    v_mov_b32 v194, v193
    s_nop 1
    v_permlane32_swap_b32 v194, v193
    v_max_f32 v193, v194, v193
    v_sub_f32 v194, v192, v193
    v_exp_f32 v194, v194
    v_mov_b32 v192, v193
    v_sub_f32 v128, v128, v192
    v_sub_f32 v129, v129, v192
    v_sub_f32 v130, v130, v192
    v_sub_f32 v131, v131, v192
    v_sub_f32 v132, v132, v192
    v_sub_f32 v133, v133, v192
    v_sub_f32 v134, v134, v192
    v_sub_f32 v135, v135, v192
    v_sub_f32 v136, v136, v192
    v_sub_f32 v137, v137, v192
    v_sub_f32 v138, v138, v192
    v_sub_f32 v139, v139, v192
    v_sub_f32 v140, v140, v192
    v_sub_f32 v141, v141, v192
    v_sub_f32 v142, v142, v192
    v_sub_f32 v143, v143, v192
    v_exp_f32 v144, v128
    v_exp_f32 v145, v129
    v_exp_f32 v146, v130
    v_exp_f32 v147, v131
    v_exp_f32 v148, v132
    v_exp_f32 v149, v133
    v_exp_f32 v150, v134
    v_exp_f32 v151, v135
    v_exp_f32 v152, v136
    v_exp_f32 v153, v137
    v_exp_f32 v154, v138
    v_exp_f32 v155, v139
    v_exp_f32 v156, v140
    v_exp_f32 v157, v141
    v_exp_f32 v158, v142
    v_exp_f32 v159, v143
    v_mul_f32 v96, v96, v194
    v_mul_f32 v97, v97, v194
    v_mul_f32 v98, v98, v194
    v_mul_f32 v99, v99, v194
    v_mul_f32 v100, v100, v194
    v_mul_f32 v101, v101, v194
    v_mul_f32 v102, v102, v194
    v_mul_f32 v103, v103, v194
    v_mul_f32 v104, v104, v194
    v_mul_f32 v105, v105, v194
    v_mul_f32 v106, v106, v194
    v_mul_f32 v107, v107, v194
    v_mul_f32 v108, v108, v194
    v_mul_f32 v109, v109, v194
    v_mul_f32 v110, v110, v194
    v_mul_f32 v111, v111, v194
    v_cvt_pk_bf16_f32 v168, v144, v145
    v_cvt_pk_bf16_f32 v169, v146, v147
    v_cvt_pk_bf16_f32 v170, v148, v149
    v_cvt_pk_bf16_f32 v171, v150, v151
    v_cvt_pk_bf16_f32 v172, v152, v153
    v_cvt_pk_bf16_f32 v173, v154, v155
    v_cvt_pk_bf16_f32 v174, v156, v157
    v_cvt_pk_bf16_f32 v175, v158, v159
    v_mfma_f32_32x32x16_bf16 v[96:111], v[208:211], v[168:171], v[96:111]
    s_nop 0
    v_mfma_f32_32x32x16_bf16 v[96:111], v[212:215], v[172:175], v[96:111]
    s_nop 15
    s_sub_u32 s67, s67, 1
    s_cmp_lg_u32 s67, 0
    s_cbranch_scc1 B_slow_loop
    v_mov_b32 v196, v108
    v_mov_b32 v197, v108
    s_nop 1
    v_permlane32_swap_b32 v196, v197
    v_rcp_f32 v198, v197
    s_nop 1
    s_branch B_fin
code_end:
    s_endpgm
.fill 300, 4, 0xbf800000
    s_endpgm
.section .rodata,"a"
.p2align 6
.amdhsa_kernel sequential_preLN__softmax_full_mha__dense_activation_gelu__prompt_kernel
  .amdhsa_next_free_vgpr 512
  .amdhsa_next_free_sgpr 102
  .amdhsa_accum_offset 256
  .amdhsa_group_segment_fixed_size 0
  .amdhsa_kernarg_size 88
  .amdhsa_user_sgpr_count 2
  .amdhsa_user_sgpr_kernarg_segment_ptr 1
  .amdhsa_system_sgpr_workgroup_id_x 1
.end_amdhsa_kernel
```
